```python
import torch

def _softmax(x, axis=-1):
    return torch.softmax(x, dim=axis)
def _gelu(x):
    return torch.nn.functional.gelu(x, approximate="tanh")
def _silu(x):
    return torch.nn.functional.silu(x)
def _sigmoid(x):
    return torch.sigmoid(x)
def _layernorm(x, axis=-1, eps=1e-5):
    m = x.mean(dim=axis, keepdim=True)
    v = x.var(dim=axis, keepdim=True, unbiased=False)
    return (x - m) / torch.sqrt(v + eps)
def _scatter_add(tgt, idx, src, axis=0):
    return tgt.clone().index_add_(axis, idx, src)
def _segment_sum(src, seg, n):
    out = torch.zeros((n,) + src.shape[1:], dtype=src.dtype)
    return out.index_add_(0, seg, src)
def _pad(x, pw):
    flat = tuple(v for pair in reversed(pw) for v in pair)
    return torch.nn.functional.pad(x, flat)

kernel_name = 'gated_mix__softmax_full_mha__glu_gated_glu__prompt'

def setup_inputs():

    _w = (lambda a: (lambda t: t.to(torch.bfloat16) if t.is_floating_point() else t)(torch.as_tensor(a)))
    def _A_setup():
        B, S, D = 1, 2048, 640
        return {
            "x": _w((lambda *s: torch.randn(*s, dtype=torch.bfloat16) * 0.05)(B, S, D)),
            "wqkv": _w((lambda *s: torch.randn(*s, dtype=torch.bfloat16) * 0.8)(D, 3 * D)),
            "wo": _w((lambda *s: torch.randn(*s, dtype=torch.bfloat16) * 0.1)(D, D)),
        }
    _A_in = _A_setup()

    def _B_setup():
        B, S, D, F = 1, 2048, 640, 1728
        return {
            "x": _w((lambda *s: torch.randn(*s, dtype=torch.bfloat16) * 0.05)(B, S, D)),
            "w_gate": _w((lambda *s: torch.randn(*s, dtype=torch.bfloat16) * 0.8)(D, F)),
            "w_up": _w((lambda *s: torch.randn(*s, dtype=torch.bfloat16) * 0.05)(D, F)),
            "w_down": _w((lambda *s: torch.randn(*s, dtype=torch.bfloat16) * 0.05)(F, D)),
        }
    _B_in = _B_setup()

    return {
        "A_x": _A_in["x"],
        "A_wqkv": _A_in["wqkv"],
        "A_wo": _A_in["wo"],
        "B_x": _B_in["x"],
        "B_w_gate": _B_in["w_gate"],
        "B_w_up": _B_in["w_up"],
        "B_w_down": _B_in["w_down"],
        "gate_w": _w((lambda *s: torch.randn(*s, dtype=torch.bfloat16) * 0.05)(640) * 16.0),
    }

def reference(A_x, A_wqkv, A_wo, B_x, B_w_gate, B_w_up, B_w_down, gate_w):
    def _A_ref(x, wqkv, wo):
        B, S, D = x.shape
        H = 32; Dh = D // H
        qkv = (lambda x, *d: x.permute(*d))((x @ wqkv).reshape(B, S, 3, H, Dh), 2, 0, 3, 1, 4)
        q, k, v = qkv[0], qkv[1], qkv[2]
        scale = Dh ** -0.5
        scores = torch.einsum("bhqd,bhkd->bhqk", q, k) * scale
        p = _softmax(scores, axis=-1)
        o = torch.einsum("bhqk,bhkd->bhqd", p, v)
        return (lambda x, *d: x.permute(*d))(o, 0, 2, 1, 3).reshape(B, S, D) @ wo

    def _B_ref(x, w_gate, w_up, w_down):
        g = torch.einsum("bsd,df->bsf", x, w_gate)
        u = torch.einsum("bsd,df->bsf", x, w_up)
        h = _sigmoid(g) * u
        return torch.einsum("bsf,fd->bsd", h, w_down)

    x = A_x
    g = _sigmoid((x * gate_w).sum(-1, keepdims=True))
    a = _A_ref(x, A_wqkv, A_wo)
    b = _B_ref(x, B_w_gate, B_w_up, B_w_down)
    return g * a + (1 - g) * b
```

```asm
; @launch grid=(256,1,1) block=(512,1,1) lds=163840
.amdgcn_target "amdgcn-amd-amdhsa--gfx950"
.text
.globl gated_mix__softmax_full_mha__glu_gated_glu__prompt_kernel
.p2align 8
.type gated_mix__softmax_full_mha__glu_gated_glu__prompt_kernel,@function
gated_mix__softmax_full_mha__glu_gated_glu__prompt_kernel:
    s_cmp_ge_u32 s2, 256
    s_cbranch_scc1 L_gated_mix__softmax_full_mha__glu_gated_glu__prompt_end_1
    s_load_dwordx16 s[36:51], s[0:1], 0
    s_load_dwordx4 s[52:55], s[0:1], 64
    s_load_dwordx2 s[56:57], s[0:1], 80
    s_getpc_b64 s[58:59]
L_pc0:
    s_lshl_b32 s22, s2, 4
    s_add_u32 s22, s22, L_tab-L_pc0
    s_add_u32 s22, s58, s22
    s_addc_u32 s23, s59, 0
    s_load_dwordx4 s[60:63], s[22:23], 0
    v_lshlrev_b32 v1, 7, v0
    v_min_u32 v1, L_tab-L_pc0, v1
    global_load_dword v15, v1, s[58:59]
    v_lshrrev_b32 v1, 6, v0
    v_and_b32 v0, 63, v0
    v_readfirstlane_b32 s3, v1
    s_mov_b32 s10, 2621440
    s_mov_b32 s11, 0x20000
    s_mov_b32 s18, 27262976
    s_mov_b32 s19, 0x20000
    s_mov_b32 s15, 0x20000
    s_cmp_lt_u32 s3, 4
    s_cbranch_scc1 L_gated_mix__softmax_full_mha__glu_gated_glu__prompt_co_2
    s_sub_u32 s22, s3, 4
    s_setprio 2
    v_lshrrev_b32 v1, 3, v0
    s_lshl_b32 s23, s22, 3
    v_add_u32 v1, s23, v1
    v_mul_u32_u24 v1, 1280, v1
    s_and_b32 s23, s22, 1
    s_lshl_b32 s23, s23, 2
    v_lshrrev_b32 v2, 4, v0
    v_add_u32 v6, s23, v2
    v_and_b32 v3, 7, v0
    v_xor_b32 v6, v6, v3
    v_lshl_add_u32 v4, v6, 4, v1
    s_and_b32 s23, s22, 1
    s_mul_i32 s23, s23, 110592
    s_movk_i32 s24, 3264
    s_mul_i32 s25, s22, 61440
    s_movk_i32 s26, 3520
    v_add_u32 v1, 0, v0
    v_mul_u32_u24 v2, 1366, v1
    v_lshrrev_b32 v2, 14, v2
    v_lshl_add_u32 v1, v1, 4, s23
    v_mad_u32_u24 v5, v2, s24, v1
    v_lshlrev_b32 v2, 2, v2
    v_and_b32 v2, 32, v2
    v_xor_b32 v5, v5, v2
    v_add_u32 v1, 64, v0
    v_mul_u32_u24 v2, 1366, v1
    v_lshrrev_b32 v2, 14, v2
    v_lshl_add_u32 v1, v1, 4, s23
    v_mad_u32_u24 v6, v2, s24, v1
    v_lshlrev_b32 v2, 2, v2
    v_and_b32 v2, 32, v2
    v_xor_b32 v6, v6, v2
    v_add_u32 v1, 128, v0
    v_mul_u32_u24 v2, 1366, v1
    v_lshrrev_b32 v2, 14, v2
    v_lshl_add_u32 v1, v1, 4, s23
    v_mad_u32_u24 v7, v2, s24, v1
    v_lshlrev_b32 v2, 2, v2
    v_and_b32 v2, 32, v2
    v_xor_b32 v7, v7, v2
    v_add_u32 v1, 0, v0
    v_mul_u32_u24 v2, 1639, v1
    v_lshrrev_b32 v2, 15, v2
    v_lshl_add_u32 v1, v1, 4, s25
    v_mad_u32_u24 v8, v2, s26, v1
    v_lshlrev_b32 v2, 2, v2
    v_and_b32 v2, 32, v2
    v_xor_b32 v8, v8, v2
    v_add_u32 v1, 64, v0
    v_mul_u32_u24 v2, 1639, v1
    v_lshrrev_b32 v2, 15, v2
    v_lshl_add_u32 v1, v1, 4, s25
    v_mad_u32_u24 v9, v2, s26, v1
    v_lshlrev_b32 v2, 2, v2
    v_and_b32 v2, 32, v2
    v_xor_b32 v9, v9, v2
    v_add_u32 v1, 128, v0
    v_mul_u32_u24 v2, 1639, v1
    v_lshrrev_b32 v2, 15, v2
    v_lshl_add_u32 v1, v1, 4, s25
    v_mad_u32_u24 v10, v2, s26, v1
    v_lshlrev_b32 v2, 2, v2
    v_and_b32 v2, 32, v2
    v_xor_b32 v10, v10, v2
    v_add_u32 v1, 192, v0
    v_mul_u32_u24 v2, 1639, v1
    v_lshrrev_b32 v2, 15, v2
    v_lshl_add_u32 v1, v1, 4, s25
    v_mad_u32_u24 v11, v2, s26, v1
    v_lshlrev_b32 v2, 2, v2
    v_and_b32 v2, 32, v2
    v_xor_b32 v11, v11, v2
    v_add_u32 v1, 256, v0
    v_mul_u32_u24 v2, 1639, v1
    v_lshrrev_b32 v2, 15, v2
    v_lshl_add_u32 v1, v1, 4, s25
    v_mad_u32_u24 v12, v2, s26, v1
    v_lshlrev_b32 v2, 2, v2
    v_and_b32 v2, 32, v2
    v_xor_b32 v12, v12, v2
    s_lshl_b32 s24, s22, 10
    s_mov_b32 s32, 0
    s_mov_b32 s33, 98304
    s_waitcnt lgkmcnt(0)
    s_mov_b32 s8, s36
    s_mov_b32 s9, s37
    s_mov_b32 s16, s56
    s_mov_b32 s17, s57
    s_cmp_eq_u32 s60, 4
    s_cbranch_scc1 L_gated_mix__softmax_full_mha__glu_gated_glu__prompt_sp_4
    s_mul_i32 s26, s62, 327680
    s_and_b32 s34, s63, 0xff
    s_lshl_b32 s23, s34, 7
    s_add_u32 s26, s26, s23
    s_mov_b32 s35, s34
    s_cmp_lg_u32 s60, 0
    s_cbranch_scc1 L_gated_mix__softmax_full_mha__glu_gated_glu__prompt_ldq_6
    s_cmp_ge_u32 s22, 2
    s_cselect_b32 s12, s46, s44
    s_cselect_b32 s13, s47, s45
    s_cselect_b32 s25, 12288, 0
    s_mov_b32 s14, 2211840
    s_and_b32 s23, s22, 1
    s_mul_i32 s23, s23, 6144
    s_add_u32 s25, s25, s23
    s_mul_i32 s27, s61, 192
    s_mul_i32 s23, s35, 221184
    s_add_u32 s27, s27, s23
    s_mov_b32 s21, 0
L_gated_mix__softmax_full_mha__glu_gated_glu__prompt_ll_8:
    s_add_u32 s28, s33, s25
    s_add_u32 m0, s28, 0
    s_nop 0
    buffer_load_dwordx4 v5, s[12:15], s27 offen  lds
    s_add_u32 m0, s28, 1024
    s_nop 0
    buffer_load_dwordx4 v6, s[12:15], s27 offen  lds
    s_add_u32 m0, s28, 2048
    s_nop 0
    buffer_load_dwordx4 v7, s[12:15], s27 offen  lds
    s_add_u32 m0, s28, 3072
    s_add_u32 s30, s27, 55296
    buffer_load_dwordx4 v5, s[12:15], s30 offen  lds
    s_add_u32 m0, s28, 4096
    s_nop 0
    buffer_load_dwordx4 v6, s[12:15], s30 offen  lds
    s_add_u32 m0, s28, 5120
    s_nop 0
    buffer_load_dwordx4 v7, s[12:15], s30 offen  lds
    s_add_u32 s35, s35, 1
    s_cmp_eq_u32 s35, 10
    s_cselect_b32 s35, 0, s35
    s_cselect_b32 s23, -9, 1
    s_mul_i32 s23, s23, 221184
    s_add_u32 s27, s27, s23
    s_xor_b32 s33, s33, 24576
    s_cmp_eq_u32 s21, 1
    s_cbranch_scc0 L_gated_mix__softmax_full_mha__glu_gated_glu__prompt_l1_9
    s_waitcnt vmcnt(6)
    s_barrier
    s_add_u32 s28, s32, s24
    s_add_u32 m0, s28, 0
    s_add_u32 s30, s26, 0
    buffer_load_dwordx4 v4, s[8:11], s30 offen  lds
    s_add_u32 m0, s28, 4096
    s_add_u32 s30, s26, 40960
    buffer_load_dwordx4 v4, s[8:11], s30 offen  lds
    s_add_u32 m0, s28, 8192
    s_add_u32 s30, s26, 81920
    buffer_load_dwordx4 v4, s[8:11], s30 offen  lds
    s_add_u32 m0, s28, 12288
    s_add_u32 s30, s26, 122880
    buffer_load_dwordx4 v4, s[8:11], s30 offen  lds
    s_add_u32 m0, s28, 16384
    s_add_u32 s30, s26, 163840
    buffer_load_dwordx4 v4, s[8:11], s30 offen  lds
    s_add_u32 m0, s28, 20480
    s_add_u32 s30, s26, 204800
    buffer_load_dwordx4 v4, s[8:11], s30 offen  lds
    s_add_u32 m0, s28, 24576
    s_add_u32 s30, s26, 245760
    buffer_load_dwordx4 v4, s[8:11], s30 offen  lds
    s_add_u32 m0, s28, 28672
    s_add_u32 s30, s26, 286720
    buffer_load_dwordx4 v4, s[8:11], s30 offen  lds
    s_add_u32 s34, s34, 1
    s_cmp_eq_u32 s34, 10
    s_cselect_b32 s34, 0, s34
    s_cselect_b32 s23, -9, 1
    s_lshl_b32 s23, s23, 7
    s_add_u32 s26, s26, s23
    s_add_u32 s32, s32, 32768
    s_cmp_eq_u32 s32, 98304
    s_cselect_b32 s32, 0, s32
L_gated_mix__softmax_full_mha__glu_gated_glu__prompt_l1_9:
    s_cmp_eq_u32 s21, 9
    s_cbranch_scc1 L_gated_mix__softmax_full_mha__glu_gated_glu__prompt_l3_11
    s_add_u32 s28, s32, s24
    s_add_u32 m0, s28, 0
    s_add_u32 s30, s26, 0
    buffer_load_dwordx4 v4, s[8:11], s30 offen  lds
    s_add_u32 m0, s28, 4096
    s_add_u32 s30, s26, 40960
    buffer_load_dwordx4 v4, s[8:11], s30 offen  lds
    s_add_u32 m0, s28, 8192
    s_add_u32 s30, s26, 81920
    buffer_load_dwordx4 v4, s[8:11], s30 offen  lds
    s_add_u32 m0, s28, 12288
    s_add_u32 s30, s26, 122880
    buffer_load_dwordx4 v4, s[8:11], s30 offen  lds
    s_add_u32 m0, s28, 16384
    s_add_u32 s30, s26, 163840
    buffer_load_dwordx4 v4, s[8:11], s30 offen  lds
    s_add_u32 m0, s28, 20480
    s_add_u32 s30, s26, 204800
    buffer_load_dwordx4 v4, s[8:11], s30 offen  lds
    s_add_u32 m0, s28, 24576
    s_add_u32 s30, s26, 245760
    buffer_load_dwordx4 v4, s[8:11], s30 offen  lds
    s_add_u32 m0, s28, 28672
    s_add_u32 s30, s26, 286720
    buffer_load_dwordx4 v4, s[8:11], s30 offen  lds
    s_add_u32 s34, s34, 1
    s_cmp_eq_u32 s34, 10
    s_cselect_b32 s34, 0, s34
    s_cselect_b32 s23, -9, 1
    s_lshl_b32 s23, s23, 7
    s_add_u32 s26, s26, s23
    s_add_u32 s32, s32, 32768
    s_cmp_eq_u32 s32, 98304
    s_cselect_b32 s32, 0, s32
    s_cmp_eq_u32 s21, 0
    s_cbranch_scc1 L_gated_mix__softmax_full_mha__glu_gated_glu__prompt_l2_10
    s_waitcnt vmcnt(8)
    s_barrier
L_gated_mix__softmax_full_mha__glu_gated_glu__prompt_l2_10:
    s_add_u32 s21, s21, 1
    s_branch L_gated_mix__softmax_full_mha__glu_gated_glu__prompt_ll_8
L_gated_mix__softmax_full_mha__glu_gated_glu__prompt_l3_11:
    s_setprio 0
    s_lshl_b32 s23, s22, 13
    s_add_u32 s23, s23, L_epi-L_pc0
    v_lshl_add_u32 v3, v0, 7, s23
    v_min_u32 v3, L_tab-L_pc0, v3
    global_load_dword v15, v3, s[58:59]
    s_waitcnt vmcnt(1)
    s_barrier
    s_cmp_lg_u32 s3, 4
    s_cbranch_scc1 L_gated_mix__softmax_full_mha__glu_gated_glu__prompt_wc_12
    v_mov_b32 v13, 0
    s_mov_b64 exec, 1
    s_mov_b32 s21, 400000
    s_branch L_gated_mix__softmax_full_mha__glu_gated_glu__prompt_p1_14
L_gated_mix__softmax_full_mha__glu_gated_glu__prompt_pl_13:
    s_sleep 4
L_gated_mix__softmax_full_mha__glu_gated_glu__prompt_p1_14:
    global_load_dword v3, v13, s[54:55] offset:128 sc1
    s_sub_u32 s21, s21, 1
    s_waitcnt vmcnt(0)
    v_cmp_ne_u32 vcc, 1, v3
    s_cselect_b64 exec, 0, exec
    s_and_b64 vcc, vcc, exec
    s_cbranch_scc1 L_gated_mix__softmax_full_mha__glu_gated_glu__prompt_pl_13
    s_mov_b64 exec, -1
L_gated_mix__softmax_full_mha__glu_gated_glu__prompt_wc_12:
    s_branch L_gated_mix__softmax_full_mha__glu_gated_glu__prompt_lddone_7
L_gated_mix__softmax_full_mha__glu_gated_glu__prompt_ldq_6:
    s_mov_b32 s12, s38
    s_mov_b32 s13, s39
    s_mov_b32 s14, 2457600
    s_mul_i32 s25, s22, 5120
    s_mul_i32 s27, s61, 320
    s_mul_i32 s23, s35, 245760
    s_add_u32 s27, s27, s23
    s_mov_b32 s21, 0
L_gated_mix__softmax_full_mha__glu_gated_glu__prompt_ll_15:
    s_add_u32 s28, s33, s25
    s_add_u32 m0, s28, 0
    s_nop 0
    buffer_load_dwordx4 v8, s[12:15], s27 offen  lds
    s_add_u32 m0, s28, 1024
    s_nop 0
    buffer_load_dwordx4 v9, s[12:15], s27 offen  lds
    s_add_u32 m0, s28, 2048
    s_nop 0
    buffer_load_dwordx4 v10, s[12:15], s27 offen  lds
    s_add_u32 m0, s28, 3072
    s_nop 0
    buffer_load_dwordx4 v11, s[12:15], s27 offen  lds
    s_add_u32 m0, s28, 4096
    s_nop 0
    buffer_load_dwordx4 v12, s[12:15], s27 offen  lds
    s_add_u32 s35, s35, 1
    s_cmp_eq_u32 s35, 10
    s_cselect_b32 s35, 0, s35
    s_cselect_b32 s23, -9, 1
    s_mul_i32 s23, s23, 245760
    s_add_u32 s27, s27, s23
    s_xor_b32 s33, s33, 24576
    s_cmp_eq_u32 s21, 1
    s_cbranch_scc0 L_gated_mix__softmax_full_mha__glu_gated_glu__prompt_l1_16
    s_waitcnt vmcnt(5)
    s_barrier
    s_add_u32 s28, s32, s24
    s_add_u32 m0, s28, 0
    s_add_u32 s30, s26, 0
    buffer_load_dwordx4 v4, s[8:11], s30 offen  lds
    s_add_u32 m0, s28, 4096
    s_add_u32 s30, s26, 40960
    buffer_load_dwordx4 v4, s[8:11], s30 offen  lds
    s_add_u32 m0, s28, 8192
    s_add_u32 s30, s26, 81920
    buffer_load_dwordx4 v4, s[8:11], s30 offen  lds
    s_add_u32 m0, s28, 12288
    s_add_u32 s30, s26, 122880
    buffer_load_dwordx4 v4, s[8:11], s30 offen  lds
    s_add_u32 m0, s28, 16384
    s_add_u32 s30, s26, 163840
    buffer_load_dwordx4 v4, s[8:11], s30 offen  lds
    s_add_u32 m0, s28, 20480
    s_add_u32 s30, s26, 204800
    buffer_load_dwordx4 v4, s[8:11], s30 offen  lds
    s_add_u32 m0, s28, 24576
    s_add_u32 s30, s26, 245760
    buffer_load_dwordx4 v4, s[8:11], s30 offen  lds
    s_add_u32 m0, s28, 28672
    s_add_u32 s30, s26, 286720
    buffer_load_dwordx4 v4, s[8:11], s30 offen  lds
    s_add_u32 s34, s34, 1
    s_cmp_eq_u32 s34, 10
    s_cselect_b32 s34, 0, s34
    s_cselect_b32 s23, -9, 1
    s_lshl_b32 s23, s23, 7
    s_add_u32 s26, s26, s23
    s_add_u32 s32, s32, 32768
    s_cmp_eq_u32 s32, 98304
    s_cselect_b32 s32, 0, s32
L_gated_mix__softmax_full_mha__glu_gated_glu__prompt_l1_16:
    s_cmp_eq_u32 s21, 9
    s_cbranch_scc1 L_gated_mix__softmax_full_mha__glu_gated_glu__prompt_l3_18
    s_add_u32 s28, s32, s24
    s_add_u32 m0, s28, 0
    s_add_u32 s30, s26, 0
    buffer_load_dwordx4 v4, s[8:11], s30 offen  lds
    s_add_u32 m0, s28, 4096
    s_add_u32 s30, s26, 40960
    buffer_load_dwordx4 v4, s[8:11], s30 offen  lds
    s_add_u32 m0, s28, 8192
    s_add_u32 s30, s26, 81920
    buffer_load_dwordx4 v4, s[8:11], s30 offen  lds
    s_add_u32 m0, s28, 12288
    s_add_u32 s30, s26, 122880
    buffer_load_dwordx4 v4, s[8:11], s30 offen  lds
    s_add_u32 m0, s28, 16384
    s_add_u32 s30, s26, 163840
    buffer_load_dwordx4 v4, s[8:11], s30 offen  lds
    s_add_u32 m0, s28, 20480
    s_add_u32 s30, s26, 204800
    buffer_load_dwordx4 v4, s[8:11], s30 offen  lds
    s_add_u32 m0, s28, 24576
    s_add_u32 s30, s26, 245760
    buffer_load_dwordx4 v4, s[8:11], s30 offen  lds
    s_add_u32 m0, s28, 28672
    s_add_u32 s30, s26, 286720
    buffer_load_dwordx4 v4, s[8:11], s30 offen  lds
    s_add_u32 s34, s34, 1
    s_cmp_eq_u32 s34, 10
    s_cselect_b32 s34, 0, s34
    s_cselect_b32 s23, -9, 1
    s_lshl_b32 s23, s23, 7
    s_add_u32 s26, s26, s23
    s_add_u32 s32, s32, 32768
    s_cmp_eq_u32 s32, 98304
    s_cselect_b32 s32, 0, s32
    s_cmp_eq_u32 s21, 0
    s_cbranch_scc1 L_gated_mix__softmax_full_mha__glu_gated_glu__prompt_l2_17
    s_waitcnt vmcnt(8)
    s_barrier
L_gated_mix__softmax_full_mha__glu_gated_glu__prompt_l2_17:
    s_add_u32 s21, s21, 1
    s_branch L_gated_mix__softmax_full_mha__glu_gated_glu__prompt_ll_15
L_gated_mix__softmax_full_mha__glu_gated_glu__prompt_l3_18:
    s_setprio 0
    s_lshl_b32 s23, s22, 13
    s_add_u32 s23, s23, L_epi-L_pc0
    v_lshl_add_u32 v3, v0, 7, s23
    v_min_u32 v3, L_tab-L_pc0, v3
    global_load_dword v15, v3, s[58:59]
    s_waitcnt vmcnt(1)
    s_barrier
    s_cmp_lg_u32 s3, 4
    s_cbranch_scc1 L_gated_mix__softmax_full_mha__glu_gated_glu__prompt_wc_19
    v_mov_b32 v13, 0
    s_mov_b64 exec, 1
    s_mov_b32 s21, 400000
    s_branch L_gated_mix__softmax_full_mha__glu_gated_glu__prompt_p1_21
L_gated_mix__softmax_full_mha__glu_gated_glu__prompt_pl_20:
    s_sleep 4
L_gated_mix__softmax_full_mha__glu_gated_glu__prompt_p1_21:
    global_load_dword v3, v13, s[54:55] offset:128 sc1
    s_sub_u32 s21, s21, 1
    s_waitcnt vmcnt(0)
    v_cmp_ne_u32 vcc, 1, v3
    s_cselect_b64 exec, 0, exec
    s_and_b64 vcc, vcc, exec
    s_cbranch_scc1 L_gated_mix__softmax_full_mha__glu_gated_glu__prompt_pl_20
    s_mov_b64 exec, -1
L_gated_mix__softmax_full_mha__glu_gated_glu__prompt_wc_19:
    s_barrier
    s_cmp_lg_u32 s22, 0
    s_cbranch_scc1 L_gated_mix__softmax_full_mha__glu_gated_glu__prompt_na_22
    s_cmp_eq_u32 s60, 3
    s_cselect_b32 s23, 12, s61
    s_lshl_b32 s23, s23, 3
    s_add_u32 s23, s23, s62
    s_lshl_b32 s23, s23, 7
    s_add_u32 s23, s23, 26279936
    v_mov_b32 v3, 1
    v_mov_b32 v24, 0
    s_mov_b64 exec, 1
    buffer_store_dword v3, v24, s[16:19], s23 offen sc1
    s_mov_b64 exec, -1
L_gated_mix__softmax_full_mha__glu_gated_glu__prompt_na_22:
L_gated_mix__softmax_full_mha__glu_gated_glu__prompt_lddone_7:
L_gated_mix__softmax_full_mha__glu_gated_glu__prompt_early_5:
    s_lshr_b32 s77, s63, 8
    s_cmp_ge_u32 s77, 185
    s_cbranch_scc1 L_gated_mix__softmax_full_mha__glu_gated_glu__prompt_nj_23
    s_mul_i32 s64, s77, 1772
    s_lshr_b32 s64, s64, 16
    s_mul_i32 s23, s64, 37
    s_sub_u32 s76, s77, s23
    s_lshl_b32 s76, s76, 2
    s_and_b32 s23, s3, 3
    s_add_u32 s76, s76, s23
    s_lshl_b32 s31, s23, 12
    s_add_u32 s31, s31, 98304
    s_mov_b32 s75, 0x20000
    v_lshlrev_b32 v24, 4, v0
    v_lshrrev_b32 v2, 4, v0
    v_bfe_u32 v3, v0, 2, 2
    v_xor_b32 v26, v2, v3
    v_lshlrev_b32 v26, 6, v26
    v_and_b32 v27, 3, v0
    v_lshl_add_u32 v26, v27, 4, v26
    v_mul_u32_u24 v2, 1280, v2
    v_add_u32 v25, v2, v26
    v_lshrrev_b32 v1, 5, v0
    v_lshlrev_b32 v1, 10, v1
    v_lshl_add_u32 v1, v3, 8, v1
    v_bfe_u32 v2, v0, 4, 1
    v_lshl_add_u32 v1, v2, 5, v1
    v_lshl_add_u32 v1, v27, 3, v1
    v_add_u32 v1, s31, v1
    v_xor_b32 v2, 0, v3
    v_lshl_add_u32 v20, v2, 6, v1
    v_xor_b32 v2, 1, v3
    v_lshl_add_u32 v21, v2, 6, v1
    v_xor_b32 v2, 2, v3
    v_lshl_add_u32 v22, v2, 6, v1
    v_xor_b32 v2, 3, v3
    v_lshl_add_u32 v23, v2, 6, v1
    s_nop 0
    s_lshl_b32 s65, s76, 4
    s_movk_i32 s66, 5120
    s_movk_i32 s67, 10240
    s_mov_b32 s72, s48
    s_mov_b32 s73, s49
    s_mov_b32 s74, 2211840
    s_sub_u32 s30, s76, 108
    s_mul_i32 s23, s30, 205
    s_lshr_b32 s23, s23, 10
    s_mul_i32 s28, s23, 5
    s_sub_u32 s30, s30, s28
    s_and_b32 s28, s23, 1
    s_lshl_b32 s28, s28, 2
    s_add_u32 s28, s28, s30
    s_lshl_b32 s28, s28, 2
    s_lshr_b32 s29, s23, 1
    s_add_u32 s28, s28, s29
    s_mul_i32 s28, s28, 20
    s_mul_i32 s23, s23, 80
    s_add_u32 s23, s23, 16
    s_cmp_ge_u32 s76, 108
    s_cselect_b32 s65, s28, s65
    s_cselect_b32 s72, s40, s72
    s_cselect_b32 s73, s41, s73
    s_cselect_b32 s74, 819200, s74
    s_cselect_b32 s30, s30, 0
    s_cmp_eq_u32 s30, 4
    s_cselect_b32 s65, s23, s65
    s_cselect_b32 s66, 51200, s66
    s_cselect_b32 s67, 25600, s67
    s_mul_i32 s65, s65, 1280
    s_lshl_b32 s23, s64, 8
    s_add_u32 s65, s65, s23
    s_add_u32 m0, s31, 0
    s_add_u32 s30, s65, s66
    buffer_load_dwordx4 v25, s[72:75], s65 offen lds
    s_add_u32 m0, s31, 1024
    s_add_u32 s65, s65, s67
    buffer_load_dwordx4 v25, s[72:75], s30 offen lds
    s_add_u32 m0, s31, 2048
    s_add_u32 s30, s65, s66
    buffer_load_dwordx4 v25, s[72:75], s65 offen lds
    s_add_u32 m0, s31, 3072
    s_mul_i32 s23, s64, 592
    buffer_load_dwordx4 v25, s[72:75], s30 offen lds
    s_add_u32 s23, s23, s76
    s_lshl_b32 s23, s23, 10
    s_add_u32 s43, s23, 23068672
    s_waitcnt vmcnt(0)
    ds_read_b64_tr_b16 v[64:65], v20
    ds_read_b64_tr_b16 v[66:67], v20 offset:2048
    ds_read_b64_tr_b16 v[68:69], v21
    ds_read_b64_tr_b16 v[70:71], v21 offset:2048
    ds_read_b64_tr_b16 v[72:73], v22
    ds_read_b64_tr_b16 v[74:75], v22 offset:2048
    ds_read_b64_tr_b16 v[76:77], v23
    ds_read_b64_tr_b16 v[78:79], v23 offset:2048
    s_waitcnt lgkmcnt(0)
    buffer_store_dwordx4 v[64:67], v24, s[16:19], s43 offen sc1
    s_add_u32 s43, s43, 151552
    buffer_store_dwordx4 v[68:71], v24, s[16:19], s43 offen sc1
    s_add_u32 s43, s43, 151552
    buffer_store_dwordx4 v[72:75], v24, s[16:19], s43 offen sc1
    s_add_u32 s43, s43, 151552
    buffer_store_dwordx4 v[76:79], v24, s[16:19], s43 offen sc1
    s_add_u32 s43, s43, 151552
L_gated_mix__softmax_full_mha__glu_gated_glu__prompt_nj_23:
    s_and_b32 s4, s2, 7
    s_lshl_b32 s4, s4, 2
    s_lshr_b32 s23, s2, 6
    s_add_u32 s4, s4, s23
    s_bfe_u32 s26, s2, 0x30003
    s_lshl_b32 s26, s26, 3
    s_and_b32 s6, s3, 3
    s_lshr_b32 s7, s3, 2
    s_lshl_b32 s5, s6, 1
    s_add_u32 s5, s5, s26
    s_lshr_b32 s23, s4, 3
    s_lshl_b32 s23, s23, 1
    s_add_u32 s26, s26, s23
    s_and_b32 s23, s4, 1
    s_add_u32 s26, s26, s23
    s_xor_b32 s27, s26, 1
    s_bfe_u32 s79, s4, 0x20001
    s_mul_i32 s79, s79, 5
    s_mul_i32 s23, s23, 3
    s_add_u32 s78, s79, s23
    s_add_u32 s79, s79, 2
    s_mul_i32 s70, s4, 163840
    s_add_u32 s70, s70, 4194304
    s_lshl_b32 s23, s7, 5
    s_add_u32 s23, s23, s6
    s_mul_i32 s74, s23, 2560
    s_add_u32 s74, s74, s70
    s_add_u32 s74, s74, s56
    s_addc_u32 s75, s57, 0
    s_lshl_b32 s71, s4, 6
    s_add_u32 s71, s71, s5
    s_mul_i32 s71, s71, 1280
    s_add_u32 s71, s71, 0
    s_mul_i32 s72, s3, 2608
    s_add_u32 s72, s72, 32768
    s_mov_b32 s64, -1
    s_mov_b32 s65, 0
    s_mov_b32 s68, 0x3f803f80
    s_mov_b32 s69, 0x00003f80
    s_lshr_b32 s23, s6, 1
    s_and_b32 s22, s6, 1
    s_lshl_b32 s31, s23, 5
    s_add_u32 s31, s31, s22
    s_add_u32 s31, s31, 30
    s_mul_i32 s31, s31, 2560
    s_add_u32 s76, s31, s70
    s_add_u32 s76, s76, s56
    s_addc_u32 s77, s57, 0
    s_lshl_b32 s73, s23, 2
    s_add_u32 s73, s73, s22
    s_mul_i32 s73, s73, 2608
    s_add_u32 s73, s73, 74496
    v_lshlrev_b32 v8, 4, v0
    v_mul_u32_u24 v3, 2608, v0
    v_mov_b32 v4, s68
    v_mov_b32 v5, s68
    v_mov_b32 v6, s68
    v_mov_b32 v7, s68
    v_mov_b32 v10, s68
    v_mov_b32 v11, s69
    v_mov_b32 v12, 0
    v_mov_b32 v13, 0
    v_mov_b32 v16, 0
    v_mov_b32 v17, 0
    v_mov_b32 v18, 0
    v_mov_b32 v19, 0
    s_mov_b64 exec, 0xffffff
    ds_write_b128 v3, v[4:7] offset:35328
    ds_write_b128 v3, v[10:13] offset:35344
    ds_write_b128 v3, v[16:19] offset:35360
    s_mov_b64 exec, -1
    v_and_b32 v1, 31, v0
    v_lshrrev_b32 v2, 5, v0
    v_lshlrev_b32 v8, 4, v0
    s_mul_i32 s23, s7, 10432
    s_add_u32 s23, s23, 32768
    s_add_u32 s22, s23, 2576
    v_add_u32 v4, s23, v8
    s_add_u32 s31, s23, 1024
    v_lshl_add_u32 v5, v1, 3, s31
    v_cmp_eq_u32 vcc, 0, v2
    v_mov_b32 v3, s22
    s_add_u32 s31, s23, 1280
    v_and_b32 v12, 3, v1
    v_cndmask_b32 v5, v3, v5, vcc
    v_lshl_add_u32 v12, v12, 4, s31
    v_lshl_add_u32 v12, v2, 6, v12
    v_lshrrev_b32 v13, 2, v1
    v_lshl_add_u32 v6, v13, 7, v12
    v_cmp_lt_u32 vcc, 20, v1
    v_subrev_u32 v12, 16, v3
    v_add_u32 v13, 16, v3
    v_cndmask_b32 v3, v12, v13, vcc
    v_cmp_gt_u32 vcc, 20, v1
    v_add_u32 v7, 640, v6
    v_mov_b32 v9, 0xdddddddd
    v_cndmask_b32 v6, v3, v6, vcc
    v_cndmask_b32 v7, v3, v7, vcc
    v_lshlrev_b32 v12, 3, v0
    v_mov_b32 v24, 0
    v_mov_b32 v25, 0
    v_mov_b32 v26, 0
    v_mov_b32 v27, 0
    v_lshlrev_b32 v14, 7, v0
    s_lshl_b32 s32, s62, 5
    s_add_u32 s32, s32, s61
    s_lshl_b32 s32, s32, 7
    s_add_u32 s32, s32, 26214400
    s_add_u32 s34, s5, s7
    s_lshl_b32 s34, s34, 7
    s_add_u32 s34, s34, 22020096
    s_and_b32 s35, s26, -2
    s_lshl_b32 s35, s35, 7
    s_add_u32 s35, s35, 22020096
    s_lshr_b32 s33, s26, 3
    s_lshl_b32 s33, s33, 12
    s_add_u32 s33, s33, 26214400
    s_mov_b32 s8, s52
    s_mov_b32 s9, s53
    s_mul_i32 s31, s6, 14
    s_mul_i32 s22, s6, 13
    s_add_u32 s22, s22, 56
    s_cmp_eq_u32 s7, 0
    s_cselect_b32 s31, s31, s22
    s_add_u32 s31, s31, 4
    s_min_u32 s22, s78, s79
    s_lshr_b32 s22, s22, 2
    s_mul_i32 s22, s22, 4736
    s_add_u32 s22, s22, 26244864
    v_cmp_gt_u32 vcc, 18, v0
    v_add_u32 v168, s22, v14
    v_add_u32 v160, s33, v14
    v_cndmask_b32 v168, v168, v160, vcc
    s_add_u32 s22, s78, 1
    s_max_u32 s22, s22, s79
    s_lshr_b32 s22, s22, 2
    s_mul_i32 s22, s22, 4736
    s_add_u32 s38, s22, 26244864
    s_mov_b32 s40, 0xfffc0000
    s_mov_b32 s41, 0x007fffff
    s_mov_b32 s66, -1
    s_mov_b32 s67, 0x007fffff
    v_mov_b32 v169, 1
    s_mul_i32 s44, s26, 108
    s_add_u32 s44, s44, s31
    s_lshl_b32 s44, s44, 10
    s_add_u32 s44, s44, 10485760
    s_add_u32 s44, s44, s56
    s_addc_u32 s45, s57, 0
    s_mul_i32 s46, s27, 108
    s_add_u32 s46, s46, s31
    s_lshl_b32 s46, s46, 10
    s_add_u32 s46, s46, 10485760
    s_add_u32 s46, s46, s56
    s_addc_u32 s47, s57, 0
    s_mul_i32 s48, s78, 148
    s_add_u32 s48, s48, s31
    s_lshl_b32 s48, s48, 10
    s_add_u32 s48, s48, 23068672
    s_add_u32 s48, s48, s56
    s_addc_u32 s49, s57, 0
    s_mul_i32 s50, s78, 148
    s_add_u32 s50, s50, s31
    s_lshl_b32 s50, s50, 10
    s_add_u32 s50, s50, 23220224
    s_add_u32 s50, s50, s56
    s_addc_u32 s51, s57, 0
    s_mul_i32 s52, s79, 148
    s_add_u32 s52, s52, s31
    s_lshl_b32 s52, s52, 10
    s_add_u32 s52, s52, 23068672
    s_add_u32 s52, s52, s56
    s_addc_u32 s53, s57, 0
    s_mul_i32 s12, s78, 148
    s_mul_i32 s23, s3, 5
    s_add_u32 s12, s12, s23
    s_lshl_b32 s12, s12, 10
    s_add_u32 s12, s12, 23179264
    s_add_u32 s12, s12, s56
    s_addc_u32 s13, s57, 0
    s_mul_i32 s14, s78, 148
    s_mul_i32 s23, s3, 5
    s_add_u32 s14, s14, s23
    s_lshl_b32 s14, s14, 10
    s_add_u32 s14, s14, 23330816
    s_add_u32 s14, s14, s56
    s_addc_u32 s15, s57, 0
    s_mul_i32 s36, s79, 148
    s_mul_i32 s23, s3, 5
    s_add_u32 s36, s36, s23
    s_lshl_b32 s36, s36, 10
    s_add_u32 s36, s36, 23179264
    s_add_u32 s36, s36, s56
    s_addc_u32 s37, s57, 0
    s_mul_i32 s24, s3, 4096
    s_mul_i32 s28, s3, 8192
    s_mul_i32 s29, s3, 2048
    s_mul_i32 s30, s3, 1024
    s_add_u32 s5, s5, s7
    s_mul_i32 s22, s5, 40960
    s_add_u32 s22, s22, 18874368
    s_lshl_b32 s55, s4, 8
    s_add_u32 s55, s55, s22
    s_add_u32 s55, s55, 32768
    s_lshl_b32 s54, s4, 10
    s_add_u32 s54, s54, s22
    v_mov_b32 v172, -1
    v_mov_b32 v173, -1
    v_mov_b32 v174, -1
    v_mov_b32 v175, -1
    v_lshlrev_b32 v170, 3, v0
    s_add_u32 s25, s60, s7
    s_add_u32 s42, s60, s3
    s_cmp_lg_u32 s3, 4
    s_cbranch_scc1 L_gated_mix__softmax_full_mha__glu_gated_glu__prompt_np_24
    s_lshr_b32 s23, s4, 3
    s_lshl_b32 s23, s23, 3
    s_bfe_u32 s22, s2, 0x30003
    v_lshrrev_b32 v3, 3, v0
    v_lshlrev_b32 v3, 5, v3
    v_and_b32 v13, 7, v0
    v_add3_u32 v13, v13, v3, 32
    v_add_u32 v13, s23, v13
    s_add_u32 s23, s23, s22
    s_add_u32 s22, s22, 96
    v_writelane_b32 v13, s23, 16
    v_writelane_b32 v13, s22, 17
    s_mov_b32 s23, 26279936
    v_lshlrev_b32 v13, 7, v13
    s_mov_b64 exec, 262143
    s_mov_b32 s21, 400000
    s_branch L_gated_mix__softmax_full_mha__glu_gated_glu__prompt_p1_26
L_gated_mix__softmax_full_mha__glu_gated_glu__prompt_pl_25:
    s_sleep 0
L_gated_mix__softmax_full_mha__glu_gated_glu__prompt_p1_26:
    buffer_load_dword v3, v13, s[16:19], s23 offen sc1
    s_sub_u32 s21, s21, 1
    s_waitcnt vmcnt(0)
    v_cmp_ne_u32 vcc, 1, v3
    s_cselect_b64 exec, 0, exec
    s_and_b64 vcc, vcc, exec
    s_cbranch_scc1 L_gated_mix__softmax_full_mha__glu_gated_glu__prompt_pl_25
    s_mov_b64 exec, -1
L_gated_mix__softmax_full_mha__glu_gated_glu__prompt_np_24:
    s_barrier
    s_mov_b32 m0, s73
    s_nop 0
    global_load_lds_dwordx4 v8, s[76:77] sc1
    global_load_lds_dwordx4 v8, s[76:77] offset:1024 sc1
    s_mov_b64 exec, s[64:65]
    global_load_lds_dwordx4 v8, s[76:77] offset:2048 sc1
    s_mov_b64 exec, -1
    buffer_load_dwordx4 v[16:19], v8, s[16:19], s71 offen offset:0 sc1
    buffer_load_dwordx4 v[20:23], v8, s[16:19], s71 offen offset:1280 sc1
    s_mov_b64 exec, s[64:65]
    buffer_load_dwordx2 v[24:25], v12, s[16:19], s71 offen offset:1024 sc1
    buffer_load_dwordx2 v[26:27], v12, s[16:19], s71 offen offset:2304 sc1
    s_mov_b64 exec, -1
    s_mov_b32 m0, s72
    s_nop 0
    global_load_lds_dwordx4 v8, s[74:75] sc1
    global_load_lds_dwordx4 v8, s[74:75] offset:1024 sc1
    s_mov_b64 exec, s[64:65]
    global_load_lds_dwordx4 v8, s[74:75] offset:2048 sc1
    s_mov_b64 exec, -1
    s_waitcnt vmcnt(7) lgkmcnt(0)
    s_barrier
    s_cmp_lg_u32 s3, 5
    s_cbranch_scc1 L_gated_mix__softmax_full_mha__glu_gated_glu__prompt_nf_27
    s_lshr_b32 s23, s63, 8
    s_lshl_b32 s23, s23, 7
    s_add_u32 s23, s23, 26247168
    v_mov_b32 v12, 0
    v_mov_b32 v13, 1
    s_mov_b64 exec, 1
    buffer_store_dword v13, v12, s[16:19], s23 offen sc1
    s_mov_b64 exec, -1
L_gated_mix__softmax_full_mha__glu_gated_glu__prompt_nf_27:
    s_branch L_gated_mix__softmax_full_mha__glu_gated_glu__prompt_fin_3
L_gated_mix__softmax_full_mha__glu_gated_glu__prompt_sp_4:
    s_setprio 0
    s_lshl_b32 s22, s61, 3
    s_add_u32 s22, s22, s3
    v_mov_b32 v12, 0
    v_mov_b32 v13, 1
    s_lshl_b32 s24, s22, 9
    s_add_u32 s23, s24, 26214400
    s_add_u32 s25, s24, 26247168
    s_lshl_b32 s24, s22, 8
    s_add_u32 s24, s24, 26279936
    v_lshlrev_b32 v2, 7, v0
    s_mov_b64 exec, 15
    buffer_store_dword v12, v2, s[16:19], s23 offen sc1
    buffer_store_dword v12, v2, s[16:19], s25 offen sc1
    s_mov_b64 exec, 3
    buffer_store_dword v12, v2, s[16:19], s24 offen sc1
    s_mov_b64 exec, -1
    s_waitcnt vmcnt(0) lgkmcnt(0)
    s_barrier
    s_cmp_lg_u32 s3, 0
    s_cbranch_scc1 L_gated_mix__softmax_full_mha__glu_gated_glu__prompt_na_28
    s_mov_b64 exec, 1
    global_atomic_add v3, v12, v13, s[54:55] sc0 sc1
    s_waitcnt vmcnt(0)
    v_and_b32 v3, 7, v3
    v_cmp_eq_u32 vcc, 7, v3
    s_nop 1
    s_cmp_eq_u64 vcc, 0
    s_cbranch_scc1 L_gated_mix__softmax_full_mha__glu_gated_glu__prompt_na_28
    global_store_dword v12, v13, s[54:55] offset:128 sc1
L_gated_mix__softmax_full_mha__glu_gated_glu__prompt_na_28:
    s_mov_b64 exec, -1
    s_mov_b32 s12, s48
    s_mov_b32 s13, s49
    s_mov_b32 s14, 2211840
    s_lshl_b32 s23, s22, 13
    buffer_load_dword v4, v2, s[12:15], s23 offen
    s_add_u32 s23, s23, 524288
    buffer_load_dword v4, v2, s[12:15], s23 offen
    s_add_u32 s23, s23, 524288
    buffer_load_dword v4, v2, s[12:15], s23 offen
    s_add_u32 s23, s23, 524288
    buffer_load_dword v4, v2, s[12:15], s23 offen
    s_add_u32 s23, s23, 524288
    buffer_load_dword v4, v2, s[12:15], s23 offen
    s_add_u32 s23, s23, 524288
    s_mov_b32 s12, s40
    s_mov_b32 s13, s41
    s_mov_b32 s14, 819200
    s_lshl_b32 s23, s22, 13
    buffer_load_dword v4, v2, s[12:15], s23 offen
    s_add_u32 s23, s23, 524288
    buffer_load_dword v4, v2, s[12:15], s23 offen
    s_add_u32 s23, s23, 524288
    s_waitcnt vmcnt(0)
    s_cmp_lg_u32 s3, 4
    s_cbranch_scc1 L_gated_mix__softmax_full_mha__glu_gated_glu__prompt_wc_29
    v_mov_b32 v13, 0
    s_mov_b64 exec, 1
    s_mov_b32 s21, 400000
    s_branch L_gated_mix__softmax_full_mha__glu_gated_glu__prompt_p1_31
L_gated_mix__softmax_full_mha__glu_gated_glu__prompt_pl_30:
    s_sleep 4
L_gated_mix__softmax_full_mha__glu_gated_glu__prompt_p1_31:
    global_load_dword v3, v13, s[54:55] offset:128 sc1
    s_sub_u32 s21, s21, 1
    s_waitcnt vmcnt(0)
    v_cmp_ne_u32 vcc, 1, v3
    s_cselect_b64 exec, 0, exec
    s_and_b64 vcc, vcc, exec
    s_cbranch_scc1 L_gated_mix__softmax_full_mha__glu_gated_glu__prompt_pl_30
    s_mov_b64 exec, -1
L_gated_mix__softmax_full_mha__glu_gated_glu__prompt_wc_29:
    s_and_b32 s4, s2, 7
    s_lshl_b32 s4, s4, 2
    s_lshr_b32 s23, s2, 6
    s_add_u32 s4, s4, s23
    s_bfe_u32 s26, s2, 0x30003
    s_lshl_b32 s26, s26, 3
    s_and_b32 s6, s3, 3
    s_lshr_b32 s7, s3, 2
    s_lshl_b32 s5, s6, 1
    s_add_u32 s5, s5, s26
    s_lshr_b32 s23, s4, 3
    s_lshl_b32 s23, s23, 1
    s_add_u32 s26, s26, s23
    s_and_b32 s23, s4, 1
    s_add_u32 s26, s26, s23
    s_xor_b32 s27, s26, 1
    s_bfe_u32 s79, s4, 0x20001
    s_mul_i32 s79, s79, 5
    s_mul_i32 s23, s23, 3
    s_add_u32 s78, s79, s23
    s_add_u32 s79, s79, 2
    s_mul_i32 s70, s4, 163840
    s_add_u32 s70, s70, 4194304
    s_lshl_b32 s23, s7, 5
    s_add_u32 s23, s23, s6
    s_mul_i32 s74, s23, 2560
    s_add_u32 s74, s74, s70
    s_add_u32 s74, s74, s56
    s_addc_u32 s75, s57, 0
    s_lshl_b32 s71, s4, 6
    s_add_u32 s71, s71, s5
    s_mul_i32 s71, s71, 1280
    s_add_u32 s71, s71, 0
    s_mul_i32 s72, s3, 2608
    s_add_u32 s72, s72, 32768
    s_mov_b32 s64, -1
    s_mov_b32 s65, 0
    s_mov_b32 s68, 0x3f803f80
    s_mov_b32 s69, 0x00003f80
    s_cmp_lt_u32 s3, 4
    s_cbranch_scc1 L_cfin
    s_branch L_gated_mix__softmax_full_mha__glu_gated_glu__prompt_early_5
L_gated_mix__softmax_full_mha__glu_gated_glu__prompt_co_2:
    v_mov_b32 v12, 0
    v_mov_b32 v13, 0
    v_lshlrev_b32 v59, 7, v0
    s_mov_b32 s30, 4294901760
    s_mov_b32 s31, 32768
    v_mfma_f32_32x32x8_bf16 v[64:79], v[12:13], v[12:13], 0
    v_mfma_f32_32x32x8_bf16 v[80:95], v[12:13], v[12:13], 0
    v_mfma_f32_32x32x8_bf16 v[96:111], v[12:13], v[12:13], 0
    v_mfma_f32_32x32x8_bf16 v[112:127], v[12:13], v[12:13], 0
    v_mfma_f32_32x32x8_bf16 v[128:143], v[12:13], v[12:13], 0
    v_mfma_f32_32x32x8_bf16 v[144:159], v[12:13], v[12:13], 0
    v_mfma_f32_32x32x8_bf16 v[160:175], v[12:13], v[12:13], 0
    v_mfma_f32_32x32x8_bf16 v[176:191], v[12:13], v[12:13], 0
    v_mfma_f32_32x32x8_bf16 v[192:207], v[12:13], v[12:13], 0
    v_mfma_f32_32x32x8_bf16 v[208:223], v[12:13], v[12:13], 0
    v_mfma_f32_32x32x8_bf16 v[224:239], v[12:13], v[12:13], 0
    v_mfma_f32_32x32x8_bf16 v[240:255], v[12:13], v[12:13], 0
    s_lshr_b32 s23, s3, 1
    s_lshl_b32 s23, s23, 14
    v_and_b32 v56, 15, v0
    v_lshrrev_b32 v57, 4, v0
    v_lshrrev_b32 v58, 1, v56
    v_xor_b32 v58, v58, v57
    v_lshl_add_u32 v56, v56, 7, s23
    v_lshl_add_u32 v1, v58, 4, v56
    v_xor_b32 v2, 64, v1
    v_bfe_u32 v56, v0, 2, 2
    v_lshl_add_u32 v56, v57, 3, v56
    v_mul_u32_u24 v56, 192, v56
    v_and_b32 v58, 3, v0
    v_lshl_add_u32 v56, v58, 3, v56
    s_and_b32 s23, s3, 1
    s_mul_i32 s24, s23, 96
    s_add_u32 s24, s24, 98304
    v_add_u32 v56, s24, v56
    v_and_b32 v57, 1, v57
    v_lshlrev_b32 v57, 5, v57
    v_add_u32 v3, v56, v57
    v_sub_u32 v12, v56, v57
    s_cmp_eq_u32 s23, 1
    s_cselect_b64 vcc, -1, 0
    v_cndmask_b32 v56, v3, v12, vcc
    v_cndmask_b32 v12, v12, v3, vcc
    v_mov_b32 v3, v56
    s_lshl_b32 s23, s3, 13
    v_and_b32 v56, 15, v0
    v_lshrrev_b32 v57, 4, v0
    v_lshrrev_b32 v58, 1, v56
    v_xor_b32 v58, v58, v57
    v_lshl_add_u32 v56, v56, 7, s23
    v_lshl_add_u32 v4, v58, 4, v56
    v_xor_b32 v5, 64, v4
    v_bfe_u32 v56, v0, 2, 2
    v_lshl_add_u32 v56, v57, 3, v56
    v_mul_u32_u24 v56, 320, v56
    v_and_b32 v58, 3, v0
    v_lshl_add_u32 v56, v58, 3, v56
    v_add_u32 v56, 98304, v56
    v_and_b32 v57, 1, v57
    v_lshlrev_b32 v57, 5, v57
    v_add_u32 v6, v56, v57
    v_sub_u32 v7, v56, v57
    s_and_b32 s4, s2, 7
    s_lshl_b32 s4, s4, 2
    s_lshr_b32 s23, s2, 6
    s_add_u32 s4, s4, s23
    s_bfe_u32 s26, s2, 0x30003
    s_lshl_b32 s26, s26, 3
    s_and_b32 s6, s3, 3
    s_lshr_b32 s7, s3, 2
    s_lshl_b32 s5, s6, 1
    s_add_u32 s5, s5, s26
    s_lshr_b32 s23, s4, 3
    s_lshl_b32 s23, s23, 1
    s_add_u32 s26, s26, s23
    s_and_b32 s23, s4, 1
    s_add_u32 s26, s26, s23
    s_xor_b32 s27, s26, 1
    s_bfe_u32 s79, s4, 0x20001
    s_mul_i32 s79, s79, 5
    s_mul_i32 s23, s23, 3
    s_add_u32 s78, s79, s23
    s_add_u32 s79, s79, 2
    s_mul_i32 s70, s4, 163840
    s_add_u32 s70, s70, 4194304
    s_lshl_b32 s23, s7, 5
    s_add_u32 s23, s23, s6
    s_mul_i32 s74, s23, 2560
    s_add_u32 s74, s74, s70
    s_nop 0
    s_lshl_b32 s71, s4, 6
    s_add_u32 s71, s71, s5
    s_mul_i32 s71, s71, 1280
    s_add_u32 s71, s71, 0
    s_mul_i32 s72, s3, 2608
    s_add_u32 s72, s72, 32768
    s_mov_b32 s64, -1
    s_mov_b32 s65, 0
    s_mov_b32 s68, 0x3f803f80
    s_mov_b32 s69, 0x00003f80
    s_waitcnt lgkmcnt(0)
    s_mov_b32 s8, s36
    s_mov_b32 s9, s37
    s_lshl_b32 s23, s2, 2
    s_add_u32 s23, s23, s3
    s_mul_i32 s23, s23, 2560
    s_mov_b64 exec, 0xfffff
    buffer_load_dword v15, v59, s[8:11], s23 offen
    s_mov_b64 exec, -1
    s_mov_b32 s16, s56
    s_mov_b32 s17, s57
    s_add_u32 s74, s74, s56
    s_addc_u32 s75, s57, 0
    s_cmp_eq_u32 s60, 4
    s_cbranch_scc1 L_gated_mix__softmax_full_mha__glu_gated_glu__prompt_sp_4
    s_cmp_lg_u32 s60, 0
    s_cbranch_scc1 L_gated_mix__softmax_full_mha__glu_gated_glu__prompt_cq_33
    s_lshl_b32 s22, s62, 1
    s_lshr_b32 s23, s3, 1
    s_add_u32 s22, s22, s23
    s_mul_i32 s34, s22, 432
    s_lshl_b32 s29, s61, 1
    s_and_b32 s23, s3, 1
    s_add_u32 s29, s29, s23
    s_mul_i32 s29, s29, 3
    s_add_u32 s34, s34, s29
    s_lshl_b32 s34, s34, 10
    s_add_u32 s43, s34, 10485760
    s_mov_b32 s32, 0xbfb8aa3b
    s_barrier
    s_waitcnt lgkmcnt(0)
    ds_read_b128 v[16:19], v1 offset:0
    ds_read_b128 v[20:23], v1 offset:2048
    ds_read_b128 v[24:27], v1 offset:4096
    ds_read_b128 v[28:31], v1 offset:6144
    ds_read_b64_tr_b16 v[48:49], v3 offset:0
    ds_read_b64_tr_b16 v[50:51], v3 offset:768
    ds_read_b64_tr_b16 v[52:53], v12 offset:32
    ds_read_b64_tr_b16 v[54:55], v12 offset:800
    ds_read_b64_tr_b16 v[56:57], v3 offset:64
    ds_read_b64_tr_b16 v[58:59], v3 offset:832
    ds_read_b64_tr_b16 v[60:61], v3 offset:12288
    ds_read_b64_tr_b16 v[62:63], v3 offset:13056
    ds_read_b64_tr_b16 v[8:9], v12 offset:12320
    ds_read_b64_tr_b16 v[10:11], v12 offset:13088
    ds_read_b64_tr_b16 v[4:5], v3 offset:12352
    ds_read_b64_tr_b16 v[6:7], v3 offset:13120
    s_mov_b32 s21, 9
    s_mov_b32 s24, 0
    s_mov_b32 s25, 24576
.p2align 6
L_gated_mix__softmax_full_mha__glu_gated_glu__prompt_gl_37:
    s_waitcnt lgkmcnt(10)
    v_mfma_f32_16x16x32_bf16 v[64:67], v[48:51], v[16:19], v[64:67]
    ds_read_b128 v[32:35], v1 offset:8192
    v_mfma_f32_16x16x32_bf16 v[68:71], v[48:51], v[20:23], v[68:71]
    ds_read_b128 v[36:39], v1 offset:10240
    v_mfma_f32_16x16x32_bf16 v[80:83], v[48:51], v[24:27], v[80:83]
    ds_read_b128 v[40:43], v1 offset:12288
    v_mfma_f32_16x16x32_bf16 v[84:87], v[48:51], v[28:31], v[84:87]
    ds_read_b128 v[44:47], v1 offset:14336
    s_waitcnt lgkmcnt(12)
    v_mfma_f32_16x16x32_bf16 v[128:131], v[52:55], v[16:19], v[128:131]
    v_mfma_f32_16x16x32_bf16 v[132:135], v[52:55], v[20:23], v[132:135]
    v_mfma_f32_16x16x32_bf16 v[144:147], v[52:55], v[24:27], v[144:147]
    v_mfma_f32_16x16x32_bf16 v[148:151], v[52:55], v[28:31], v[148:151]
    s_waitcnt lgkmcnt(10)
    v_mfma_f32_16x16x32_bf16 v[192:195], v[56:59], v[16:19], v[192:195]
    v_mfma_f32_16x16x32_bf16 v[196:199], v[56:59], v[20:23], v[196:199]
    v_mfma_f32_16x16x32_bf16 v[208:211], v[56:59], v[24:27], v[208:211]
    v_mfma_f32_16x16x32_bf16 v[212:215], v[56:59], v[28:31], v[212:215]
    s_waitcnt lgkmcnt(8)
    v_mfma_f32_16x16x32_bf16 v[72:75], v[60:63], v[16:19], v[72:75]
    v_mfma_f32_16x16x32_bf16 v[76:79], v[60:63], v[20:23], v[76:79]
    v_mfma_f32_16x16x32_bf16 v[88:91], v[60:63], v[24:27], v[88:91]
    v_mfma_f32_16x16x32_bf16 v[92:95], v[60:63], v[28:31], v[92:95]
    s_waitcnt lgkmcnt(6)
    v_mfma_f32_16x16x32_bf16 v[136:139], v[8:11], v[16:19], v[136:139]
    v_mfma_f32_16x16x32_bf16 v[140:143], v[8:11], v[20:23], v[140:143]
    v_mfma_f32_16x16x32_bf16 v[152:155], v[8:11], v[24:27], v[152:155]
    v_mfma_f32_16x16x32_bf16 v[156:159], v[8:11], v[28:31], v[156:159]
    s_waitcnt lgkmcnt(4)
    v_mfma_f32_16x16x32_bf16 v[200:203], v[4:7], v[16:19], v[200:203]
    v_mfma_f32_16x16x32_bf16 v[204:207], v[4:7], v[20:23], v[204:207]
    v_mfma_f32_16x16x32_bf16 v[216:219], v[4:7], v[24:27], v[216:219]
    v_mfma_f32_16x16x32_bf16 v[220:223], v[4:7], v[28:31], v[220:223]
    s_waitcnt lgkmcnt(0)
    v_mfma_f32_16x16x32_bf16 v[96:99], v[48:51], v[32:35], v[96:99]
    ds_read_b128 v[16:19], v2 offset:0
    v_mfma_f32_16x16x32_bf16 v[100:103], v[48:51], v[36:39], v[100:103]
    ds_read_b128 v[20:23], v2 offset:2048
    v_mfma_f32_16x16x32_bf16 v[112:115], v[48:51], v[40:43], v[112:115]
    ds_read_b128 v[24:27], v2 offset:4096
    v_mfma_f32_16x16x32_bf16 v[116:119], v[48:51], v[44:47], v[116:119]
    ds_read_b128 v[28:31], v2 offset:6144
    v_mfma_f32_16x16x32_bf16 v[160:163], v[52:55], v[32:35], v[160:163]
    ds_read_b64_tr_b16 v[48:49], v3 offset:6144
    v_mfma_f32_16x16x32_bf16 v[164:167], v[52:55], v[36:39], v[164:167]
    ds_read_b64_tr_b16 v[50:51], v3 offset:6912
    v_mfma_f32_16x16x32_bf16 v[176:179], v[52:55], v[40:43], v[176:179]
    v_mfma_f32_16x16x32_bf16 v[180:183], v[52:55], v[44:47], v[180:183]
    ds_read_b64_tr_b16 v[52:53], v12 offset:6176
    v_mfma_f32_16x16x32_bf16 v[224:227], v[56:59], v[32:35], v[224:227]
    ds_read_b64_tr_b16 v[54:55], v12 offset:6944
    v_mfma_f32_16x16x32_bf16 v[228:231], v[56:59], v[36:39], v[228:231]
    v_mfma_f32_16x16x32_bf16 v[240:243], v[56:59], v[40:43], v[240:243]
    v_mfma_f32_16x16x32_bf16 v[244:247], v[56:59], v[44:47], v[244:247]
    ds_read_b64_tr_b16 v[56:57], v3 offset:6208
    v_mfma_f32_16x16x32_bf16 v[104:107], v[60:63], v[32:35], v[104:107]
    ds_read_b64_tr_b16 v[58:59], v3 offset:6976
    v_mfma_f32_16x16x32_bf16 v[108:111], v[60:63], v[36:39], v[108:111]
    v_mfma_f32_16x16x32_bf16 v[120:123], v[60:63], v[40:43], v[120:123]
    v_mfma_f32_16x16x32_bf16 v[124:127], v[60:63], v[44:47], v[124:127]
    ds_read_b64_tr_b16 v[60:61], v3 offset:18432
    v_mfma_f32_16x16x32_bf16 v[168:171], v[8:11], v[32:35], v[168:171]
    ds_read_b64_tr_b16 v[62:63], v3 offset:19200
    v_mfma_f32_16x16x32_bf16 v[172:175], v[8:11], v[36:39], v[172:175]
    v_mfma_f32_16x16x32_bf16 v[184:187], v[8:11], v[40:43], v[184:187]
    v_mfma_f32_16x16x32_bf16 v[188:191], v[8:11], v[44:47], v[188:191]
    ds_read_b64_tr_b16 v[8:9], v12 offset:18464
    v_mfma_f32_16x16x32_bf16 v[232:235], v[4:7], v[32:35], v[232:235]
    ds_read_b64_tr_b16 v[10:11], v12 offset:19232
    v_mfma_f32_16x16x32_bf16 v[236:239], v[4:7], v[36:39], v[236:239]
    v_mfma_f32_16x16x32_bf16 v[248:251], v[4:7], v[40:43], v[248:251]
    v_mfma_f32_16x16x32_bf16 v[252:255], v[4:7], v[44:47], v[252:255]
    ds_read_b64_tr_b16 v[4:5], v3 offset:18496
    ds_read_b64_tr_b16 v[6:7], v3 offset:19264
    s_waitcnt lgkmcnt(10)
    v_mfma_f32_16x16x32_bf16 v[64:67], v[48:51], v[16:19], v[64:67]
    ds_read_b128 v[32:35], v2 offset:8192
    v_mfma_f32_16x16x32_bf16 v[68:71], v[48:51], v[20:23], v[68:71]
    ds_read_b128 v[36:39], v2 offset:10240
    v_mfma_f32_16x16x32_bf16 v[80:83], v[48:51], v[24:27], v[80:83]
    ds_read_b128 v[40:43], v2 offset:12288
    v_mfma_f32_16x16x32_bf16 v[84:87], v[48:51], v[28:31], v[84:87]
    ds_read_b128 v[44:47], v2 offset:14336
    s_waitcnt lgkmcnt(12)
    v_mfma_f32_16x16x32_bf16 v[128:131], v[52:55], v[16:19], v[128:131]
    v_mfma_f32_16x16x32_bf16 v[132:135], v[52:55], v[20:23], v[132:135]
    v_mfma_f32_16x16x32_bf16 v[144:147], v[52:55], v[24:27], v[144:147]
    v_mfma_f32_16x16x32_bf16 v[148:151], v[52:55], v[28:31], v[148:151]
    s_waitcnt lgkmcnt(10)
    v_mfma_f32_16x16x32_bf16 v[192:195], v[56:59], v[16:19], v[192:195]
    v_mfma_f32_16x16x32_bf16 v[196:199], v[56:59], v[20:23], v[196:199]
    v_mfma_f32_16x16x32_bf16 v[208:211], v[56:59], v[24:27], v[208:211]
    v_mfma_f32_16x16x32_bf16 v[212:215], v[56:59], v[28:31], v[212:215]
    s_waitcnt lgkmcnt(8)
    v_mfma_f32_16x16x32_bf16 v[72:75], v[60:63], v[16:19], v[72:75]
    s_add_u32 s24, s24, 1
    s_cmp_eq_u32 s24, 3
    s_cselect_b32 s20, s30, s31
    v_mfma_f32_16x16x32_bf16 v[76:79], v[60:63], v[20:23], v[76:79]
    s_cselect_b32 s24, 0, s24
    s_sub_u32 s21, s21, 1
    v_mfma_f32_16x16x32_bf16 v[88:91], v[60:63], v[24:27], v[88:91]
    v_mfma_f32_16x16x32_bf16 v[92:95], v[60:63], v[28:31], v[92:95]
    s_waitcnt lgkmcnt(6)
    v_mfma_f32_16x16x32_bf16 v[136:139], v[8:11], v[16:19], v[136:139]
    v_add_u32 v1, s20, v1
    v_mfma_f32_16x16x32_bf16 v[140:143], v[8:11], v[20:23], v[140:143]
    v_add_u32 v3, s25, v3
    v_mfma_f32_16x16x32_bf16 v[152:155], v[8:11], v[24:27], v[152:155]
    v_add_u32 v12, s25, v12
    v_mfma_f32_16x16x32_bf16 v[156:159], v[8:11], v[28:31], v[156:159]
    s_sub_u32 s25, 0, s25
    s_waitcnt lgkmcnt(4)
    v_mfma_f32_16x16x32_bf16 v[200:203], v[4:7], v[16:19], v[200:203]
    v_mfma_f32_16x16x32_bf16 v[204:207], v[4:7], v[20:23], v[204:207]
    v_mfma_f32_16x16x32_bf16 v[216:219], v[4:7], v[24:27], v[216:219]
    v_mfma_f32_16x16x32_bf16 v[220:223], v[4:7], v[28:31], v[220:223]
    s_waitcnt lgkmcnt(0)
    v_mfma_f32_16x16x32_bf16 v[96:99], v[48:51], v[32:35], v[96:99]
    s_barrier
    ds_read_b128 v[16:19], v1 offset:0
    v_mfma_f32_16x16x32_bf16 v[100:103], v[48:51], v[36:39], v[100:103]
    ds_read_b128 v[20:23], v1 offset:2048
    v_mfma_f32_16x16x32_bf16 v[112:115], v[48:51], v[40:43], v[112:115]
    ds_read_b128 v[24:27], v1 offset:4096
    v_mfma_f32_16x16x32_bf16 v[116:119], v[48:51], v[44:47], v[116:119]
    ds_read_b128 v[28:31], v1 offset:6144
    v_mfma_f32_16x16x32_bf16 v[160:163], v[52:55], v[32:35], v[160:163]
    ds_read_b64_tr_b16 v[48:49], v3 offset:0
    v_mfma_f32_16x16x32_bf16 v[164:167], v[52:55], v[36:39], v[164:167]
    ds_read_b64_tr_b16 v[50:51], v3 offset:768
    v_mfma_f32_16x16x32_bf16 v[176:179], v[52:55], v[40:43], v[176:179]
    v_mfma_f32_16x16x32_bf16 v[180:183], v[52:55], v[44:47], v[180:183]
    ds_read_b64_tr_b16 v[52:53], v12 offset:32
    v_mfma_f32_16x16x32_bf16 v[224:227], v[56:59], v[32:35], v[224:227]
    ds_read_b64_tr_b16 v[54:55], v12 offset:800
    v_mfma_f32_16x16x32_bf16 v[228:231], v[56:59], v[36:39], v[228:231]
    v_mfma_f32_16x16x32_bf16 v[240:243], v[56:59], v[40:43], v[240:243]
    v_mfma_f32_16x16x32_bf16 v[244:247], v[56:59], v[44:47], v[244:247]
    ds_read_b64_tr_b16 v[56:57], v3 offset:64
    v_mfma_f32_16x16x32_bf16 v[104:107], v[60:63], v[32:35], v[104:107]
    ds_read_b64_tr_b16 v[58:59], v3 offset:832
    v_mfma_f32_16x16x32_bf16 v[108:111], v[60:63], v[36:39], v[108:111]
    v_add_u32 v2, s20, v2
    v_mfma_f32_16x16x32_bf16 v[120:123], v[60:63], v[40:43], v[120:123]
    v_mfma_f32_16x16x32_bf16 v[124:127], v[60:63], v[44:47], v[124:127]
    ds_read_b64_tr_b16 v[60:61], v3 offset:12288
    v_mfma_f32_16x16x32_bf16 v[168:171], v[8:11], v[32:35], v[168:171]
    ds_read_b64_tr_b16 v[62:63], v3 offset:13056
    v_mfma_f32_16x16x32_bf16 v[172:175], v[8:11], v[36:39], v[172:175]
    v_mfma_f32_16x16x32_bf16 v[184:187], v[8:11], v[40:43], v[184:187]
    v_mfma_f32_16x16x32_bf16 v[188:191], v[8:11], v[44:47], v[188:191]
    ds_read_b64_tr_b16 v[8:9], v12 offset:12320
    v_mfma_f32_16x16x32_bf16 v[232:235], v[4:7], v[32:35], v[232:235]
    ds_read_b64_tr_b16 v[10:11], v12 offset:13088
    v_mfma_f32_16x16x32_bf16 v[236:239], v[4:7], v[36:39], v[236:239]
    v_mfma_f32_16x16x32_bf16 v[248:251], v[4:7], v[40:43], v[248:251]
    v_mfma_f32_16x16x32_bf16 v[252:255], v[4:7], v[44:47], v[252:255]
    ds_read_b64_tr_b16 v[4:5], v3 offset:12352
    ds_read_b64_tr_b16 v[6:7], v3 offset:13120
    s_cmp_lg_u32 s21, 0
    s_cbranch_scc1 L_gated_mix__softmax_full_mha__glu_gated_glu__prompt_gl_37
L_epi:
    s_waitcnt lgkmcnt(12)
    ds_read_b128 v[32:35], v2 offset:0
    ds_read_b128 v[36:39], v2 offset:2048
    s_waitcnt lgkmcnt(6)
    ds_read_b64_tr_b16 v[52:53], v3 offset:6144
    ds_read_b64_tr_b16 v[54:55], v3 offset:6912
    ds_read_b64_tr_b16 v[8:9], v3 offset:18432
    ds_read_b64_tr_b16 v[10:11], v3 offset:19200
    v_mfma_f32_16x16x32_bf16 v[64:67], v[48:51], v[16:19], v[64:67]
    ds_read_b128 v[40:43], v2 offset:4096
    ds_read_b128 v[44:47], v2 offset:6144
    v_mfma_f32_16x16x32_bf16 v[68:71], v[48:51], v[20:23], v[68:71]
    v_mfma_f32_16x16x32_bf16 v[72:75], v[60:63], v[16:19], v[72:75]
    v_mfma_f32_16x16x32_bf16 v[76:79], v[60:63], v[20:23], v[76:79]
    s_waitcnt lgkmcnt(2)
    v_mfma_f32_16x16x32_bf16 v[64:67], v[52:55], v[32:35], v[64:67]
    v_mfma_f32_16x16x32_bf16 v[68:71], v[52:55], v[36:39], v[68:71]
    v_mfma_f32_16x16x32_bf16 v[72:75], v[8:11], v[32:35], v[72:75]
    v_mfma_f32_16x16x32_bf16 v[76:79], v[8:11], v[36:39], v[76:79]
    s_waitcnt lgkmcnt(0)
    v_mfma_f32_16x16x32_bf16 v[80:83], v[48:51], v[24:27], v[80:83]
    ds_read_b128 v[16:19], v1 offset:8192
    ds_read_b128 v[20:23], v1 offset:10240
    v_mfma_f32_16x16x32_bf16 v[84:87], v[48:51], v[28:31], v[84:87]
    ds_read_b128 v[32:35], v2 offset:8192
    ds_read_b128 v[36:39], v2 offset:10240
    s_nop 1
    v_pk_mul_f32 v[64:65], v[64:65], s[32:33] op_sel_hi:[1,0]
    v_pk_mul_f32 v[66:67], v[66:67], s[32:33] op_sel_hi:[1,0]
    v_pk_mul_f32 v[68:69], v[68:69], s[32:33] op_sel_hi:[1,0]
    v_pk_mul_f32 v[70:71], v[70:71], s[32:33] op_sel_hi:[1,0]
    v_exp_f32 v64, v64
    v_mfma_f32_16x16x32_bf16 v[88:91], v[60:63], v[24:27], v[88:91]
    ds_read_b64_tr_b16 v[56:57], v12 offset:32
    ds_read_b64_tr_b16 v[58:59], v12 offset:800
    v_exp_f32 v65, v65
    v_exp_f32 v66, v66
    v_exp_f32 v67, v67
    v_exp_f32 v68, v68
    v_exp_f32 v69, v69
    v_mfma_f32_16x16x32_bf16 v[92:95], v[60:63], v[28:31], v[92:95]
    ds_read_b64_tr_b16 v[4:5], v12 offset:12320
    ds_read_b64_tr_b16 v[6:7], v12 offset:13088
    v_exp_f32 v70, v70
    v_exp_f32 v71, v71
    v_pk_add_f32 v[64:65], v[64:65], 1.0 op_sel_hi:[1,0]
    v_pk_add_f32 v[66:67], v[66:67], 1.0 op_sel_hi:[1,0]
    v_pk_add_f32 v[68:69], v[68:69], 1.0 op_sel_hi:[1,0]
    v_mfma_f32_16x16x32_bf16 v[80:83], v[52:55], v[40:43], v[80:83]
    v_pk_add_f32 v[70:71], v[70:71], 1.0 op_sel_hi:[1,0]
    v_rcp_f32 v64, v64
    v_rcp_f32 v65, v65
    v_rcp_f32 v66, v66
    v_rcp_f32 v67, v67
    v_mfma_f32_16x16x32_bf16 v[84:87], v[52:55], v[44:47], v[84:87]
    v_rcp_f32 v68, v68
    v_rcp_f32 v69, v69
    v_rcp_f32 v70, v70
    v_rcp_f32 v71, v71
    v_mfma_f32_16x16x32_bf16 v[88:91], v[8:11], v[40:43], v[88:91]
    v_pk_mul_f32 v[64:65], v[64:65], v[72:73]
    v_pk_mul_f32 v[66:67], v[66:67], v[74:75]
    v_pk_mul_f32 v[68:69], v[68:69], v[76:77]
    v_pk_mul_f32 v[70:71], v[70:71], v[78:79]
    v_mfma_f32_16x16x32_bf16 v[92:95], v[8:11], v[44:47], v[92:95]
    v_cvt_pk_bf16_f32 v64, v64, v65
    v_cvt_pk_bf16_f32 v65, v66, v67
    v_cvt_pk_bf16_f32 v66, v68, v69
    v_cvt_pk_bf16_f32 v67, v70, v71
    s_waitcnt lgkmcnt(4)
    v_mfma_f32_16x16x32_bf16 v[96:99], v[48:51], v[16:19], v[96:99]
    ds_read_b128 v[24:27], v1 offset:12288
    ds_read_b128 v[28:31], v1 offset:14336
    v_mfma_f32_16x16x32_bf16 v[100:103], v[48:51], v[20:23], v[100:103]
    ds_read_b128 v[40:43], v2 offset:12288
    ds_read_b128 v[44:47], v2 offset:14336
    s_nop 1
    v_pk_mul_f32 v[80:81], v[80:81], s[32:33] op_sel_hi:[1,0]
    v_pk_mul_f32 v[82:83], v[82:83], s[32:33] op_sel_hi:[1,0]
    v_pk_mul_f32 v[84:85], v[84:85], s[32:33] op_sel_hi:[1,0]
    v_pk_mul_f32 v[86:87], v[86:87], s[32:33] op_sel_hi:[1,0]
    v_exp_f32 v80, v80
    v_mfma_f32_16x16x32_bf16 v[104:107], v[60:63], v[16:19], v[104:107]
    v_exp_f32 v81, v81
    v_exp_f32 v82, v82
    v_exp_f32 v83, v83
    v_exp_f32 v84, v84
    v_exp_f32 v85, v85
    v_mfma_f32_16x16x32_bf16 v[108:111], v[60:63], v[20:23], v[108:111]
    v_exp_f32 v86, v86
    v_exp_f32 v87, v87
    v_pk_add_f32 v[80:81], v[80:81], 1.0 op_sel_hi:[1,0]
    v_pk_add_f32 v[82:83], v[82:83], 1.0 op_sel_hi:[1,0]
    v_pk_add_f32 v[84:85], v[84:85], 1.0 op_sel_hi:[1,0]
    v_mfma_f32_16x16x32_bf16 v[96:99], v[52:55], v[32:35], v[96:99]
    v_pk_add_f32 v[86:87], v[86:87], 1.0 op_sel_hi:[1,0]
    v_rcp_f32 v80, v80
    v_rcp_f32 v81, v81
    v_rcp_f32 v82, v82
    v_rcp_f32 v83, v83
    v_mfma_f32_16x16x32_bf16 v[100:103], v[52:55], v[36:39], v[100:103]
    v_rcp_f32 v84, v84
    v_rcp_f32 v85, v85
    v_rcp_f32 v86, v86
    v_rcp_f32 v87, v87
    v_permlane32_swap_b32 v64, v66
    v_mfma_f32_16x16x32_bf16 v[104:107], v[8:11], v[32:35], v[104:107]
    v_permlane32_swap_b32 v65, v67
    v_pk_mul_f32 v[80:81], v[80:81], v[88:89]
    v_pk_mul_f32 v[82:83], v[82:83], v[90:91]
    v_pk_mul_f32 v[84:85], v[84:85], v[92:93]
    v_pk_mul_f32 v[86:87], v[86:87], v[94:95]
    v_mfma_f32_16x16x32_bf16 v[108:111], v[8:11], v[36:39], v[108:111]
    v_cvt_pk_bf16_f32 v68, v80, v81
    v_cvt_pk_bf16_f32 v69, v82, v83
    v_cvt_pk_bf16_f32 v70, v84, v85
    v_cvt_pk_bf16_f32 v71, v86, v87
    s_waitcnt lgkmcnt(0)
    v_mfma_f32_16x16x32_bf16 v[112:115], v[48:51], v[24:27], v[112:115]
    ds_read_b128 v[16:19], v1 offset:0
    ds_read_b128 v[20:23], v1 offset:2048
    v_mfma_f32_16x16x32_bf16 v[116:119], v[48:51], v[28:31], v[116:119]
    ds_read_b128 v[32:35], v2 offset:0
    ds_read_b128 v[36:39], v2 offset:2048
    s_nop 1
    v_pk_mul_f32 v[96:97], v[96:97], s[32:33] op_sel_hi:[1,0]
    v_pk_mul_f32 v[98:99], v[98:99], s[32:33] op_sel_hi:[1,0]
    v_pk_mul_f32 v[100:101], v[100:101], s[32:33] op_sel_hi:[1,0]
    v_pk_mul_f32 v[102:103], v[102:103], s[32:33] op_sel_hi:[1,0]
    v_exp_f32 v96, v96
    v_mfma_f32_16x16x32_bf16 v[120:123], v[60:63], v[24:27], v[120:123]
    v_exp_f32 v97, v97
    v_exp_f32 v98, v98
    v_exp_f32 v99, v99
    v_exp_f32 v100, v100
    v_exp_f32 v101, v101
    v_mfma_f32_16x16x32_bf16 v[124:127], v[60:63], v[28:31], v[124:127]
    v_exp_f32 v102, v102
    v_exp_f32 v103, v103
    v_pk_add_f32 v[96:97], v[96:97], 1.0 op_sel_hi:[1,0]
    v_pk_add_f32 v[98:99], v[98:99], 1.0 op_sel_hi:[1,0]
    v_pk_add_f32 v[100:101], v[100:101], 1.0 op_sel_hi:[1,0]
    v_mfma_f32_16x16x32_bf16 v[112:115], v[52:55], v[40:43], v[112:115]
    ds_read_b64_tr_b16 v[48:49], v12 offset:6176
    ds_read_b64_tr_b16 v[50:51], v12 offset:6944
    v_pk_add_f32 v[102:103], v[102:103], 1.0 op_sel_hi:[1,0]
    v_rcp_f32 v96, v96
    v_rcp_f32 v97, v97
    v_rcp_f32 v98, v98
    v_rcp_f32 v99, v99
    v_mfma_f32_16x16x32_bf16 v[116:119], v[52:55], v[44:47], v[116:119]
    ds_read_b64_tr_b16 v[60:61], v12 offset:18464
    ds_read_b64_tr_b16 v[62:63], v12 offset:19232
    v_rcp_f32 v100, v100
    v_rcp_f32 v101, v101
    v_rcp_f32 v102, v102
    v_rcp_f32 v103, v103
    v_permlane32_swap_b32 v68, v70
    v_mfma_f32_16x16x32_bf16 v[120:123], v[8:11], v[40:43], v[120:123]
    v_permlane32_swap_b32 v69, v71
    v_pk_mul_f32 v[96:97], v[96:97], v[104:105]
    v_pk_mul_f32 v[98:99], v[98:99], v[106:107]
    v_pk_mul_f32 v[100:101], v[100:101], v[108:109]
    v_pk_mul_f32 v[102:103], v[102:103], v[110:111]
    v_mfma_f32_16x16x32_bf16 v[124:127], v[8:11], v[44:47], v[124:127]
    v_cvt_pk_bf16_f32 v72, v96, v97
    v_cvt_pk_bf16_f32 v73, v98, v99
    v_cvt_pk_bf16_f32 v74, v100, v101
    v_cvt_pk_bf16_f32 v75, v102, v103
    s_waitcnt lgkmcnt(4)
    v_mfma_f32_16x16x32_bf16 v[128:131], v[56:59], v[16:19], v[128:131]
    ds_read_b128 v[24:27], v1 offset:4096
    ds_read_b128 v[28:31], v1 offset:6144
    v_mfma_f32_16x16x32_bf16 v[132:135], v[56:59], v[20:23], v[132:135]
    ds_read_b128 v[40:43], v2 offset:4096
    ds_read_b128 v[44:47], v2 offset:6144
    s_nop 1
    v_pk_mul_f32 v[112:113], v[112:113], s[32:33] op_sel_hi:[1,0]
    v_pk_mul_f32 v[114:115], v[114:115], s[32:33] op_sel_hi:[1,0]
    v_pk_mul_f32 v[116:117], v[116:117], s[32:33] op_sel_hi:[1,0]
    v_pk_mul_f32 v[118:119], v[118:119], s[32:33] op_sel_hi:[1,0]
    v_exp_f32 v112, v112
    v_mfma_f32_16x16x32_bf16 v[136:139], v[4:7], v[16:19], v[136:139]
    v_exp_f32 v113, v113
    v_exp_f32 v114, v114
    v_exp_f32 v115, v115
    v_exp_f32 v116, v116
    v_exp_f32 v117, v117
    v_mfma_f32_16x16x32_bf16 v[140:143], v[4:7], v[20:23], v[140:143]
    v_exp_f32 v118, v118
    v_exp_f32 v119, v119
    v_pk_add_f32 v[112:113], v[112:113], 1.0 op_sel_hi:[1,0]
    v_pk_add_f32 v[114:115], v[114:115], 1.0 op_sel_hi:[1,0]
    v_pk_add_f32 v[116:117], v[116:117], 1.0 op_sel_hi:[1,0]
    s_waitcnt lgkmcnt(4)
    v_mfma_f32_16x16x32_bf16 v[128:131], v[48:51], v[32:35], v[128:131]
    v_pk_add_f32 v[118:119], v[118:119], 1.0 op_sel_hi:[1,0]
    v_rcp_f32 v112, v112
    v_rcp_f32 v113, v113
    v_rcp_f32 v114, v114
    v_rcp_f32 v115, v115
    v_mfma_f32_16x16x32_bf16 v[132:135], v[48:51], v[36:39], v[132:135]
    v_rcp_f32 v116, v116
    v_rcp_f32 v117, v117
    v_rcp_f32 v118, v118
    v_rcp_f32 v119, v119
    v_permlane32_swap_b32 v72, v74
    v_mfma_f32_16x16x32_bf16 v[136:139], v[60:63], v[32:35], v[136:139]
    v_permlane32_swap_b32 v73, v75
    v_pk_mul_f32 v[112:113], v[112:113], v[120:121]
    v_pk_mul_f32 v[114:115], v[114:115], v[122:123]
    v_pk_mul_f32 v[116:117], v[116:117], v[124:125]
    v_pk_mul_f32 v[118:119], v[118:119], v[126:127]
    v_mfma_f32_16x16x32_bf16 v[140:143], v[60:63], v[36:39], v[140:143]
    v_cvt_pk_bf16_f32 v76, v112, v113
    v_cvt_pk_bf16_f32 v77, v114, v115
    v_cvt_pk_bf16_f32 v78, v116, v117
    v_cvt_pk_bf16_f32 v79, v118, v119
    s_waitcnt lgkmcnt(0)
    v_mfma_f32_16x16x32_bf16 v[144:147], v[56:59], v[24:27], v[144:147]
    ds_read_b128 v[16:19], v1 offset:8192
    ds_read_b128 v[20:23], v1 offset:10240
    v_mfma_f32_16x16x32_bf16 v[148:151], v[56:59], v[28:31], v[148:151]
    ds_read_b128 v[32:35], v2 offset:8192
    ds_read_b128 v[36:39], v2 offset:10240
    s_nop 1
    v_pk_mul_f32 v[128:129], v[128:129], s[32:33] op_sel_hi:[1,0]
    v_pk_mul_f32 v[130:131], v[130:131], s[32:33] op_sel_hi:[1,0]
    v_pk_mul_f32 v[132:133], v[132:133], s[32:33] op_sel_hi:[1,0]
    v_pk_mul_f32 v[134:135], v[134:135], s[32:33] op_sel_hi:[1,0]
    v_exp_f32 v128, v128
    v_mfma_f32_16x16x32_bf16 v[152:155], v[4:7], v[24:27], v[152:155]
    ds_read_b64_tr_b16 v[52:53], v3 offset:64
    ds_read_b64_tr_b16 v[54:55], v3 offset:832
    v_exp_f32 v129, v129
    v_exp_f32 v130, v130
    v_exp_f32 v131, v131
    v_exp_f32 v132, v132
    v_exp_f32 v133, v133
    v_mfma_f32_16x16x32_bf16 v[156:159], v[4:7], v[28:31], v[156:159]
    ds_read_b64_tr_b16 v[8:9], v3 offset:12352
    ds_read_b64_tr_b16 v[10:11], v3 offset:13120
    v_exp_f32 v134, v134
    v_exp_f32 v135, v135
    v_pk_add_f32 v[128:129], v[128:129], 1.0 op_sel_hi:[1,0]
    v_pk_add_f32 v[130:131], v[130:131], 1.0 op_sel_hi:[1,0]
    v_pk_add_f32 v[132:133], v[132:133], 1.0 op_sel_hi:[1,0]
    v_mfma_f32_16x16x32_bf16 v[144:147], v[48:51], v[40:43], v[144:147]
    v_pk_add_f32 v[134:135], v[134:135], 1.0 op_sel_hi:[1,0]
    v_rcp_f32 v128, v128
    v_rcp_f32 v129, v129
    v_rcp_f32 v130, v130
    v_rcp_f32 v131, v131
    v_mfma_f32_16x16x32_bf16 v[148:151], v[48:51], v[44:47], v[148:151]
    v_rcp_f32 v132, v132
    v_rcp_f32 v133, v133
    v_rcp_f32 v134, v134
    v_rcp_f32 v135, v135
    v_permlane32_swap_b32 v76, v78
    v_mfma_f32_16x16x32_bf16 v[152:155], v[60:63], v[40:43], v[152:155]
    v_permlane32_swap_b32 v77, v79
    v_pk_mul_f32 v[128:129], v[128:129], v[136:137]
    v_pk_mul_f32 v[130:131], v[130:131], v[138:139]
    v_pk_mul_f32 v[132:133], v[132:133], v[140:141]
    v_pk_mul_f32 v[134:135], v[134:135], v[142:143]
    v_mfma_f32_16x16x32_bf16 v[156:159], v[60:63], v[44:47], v[156:159]
    v_cvt_pk_bf16_f32 v80, v128, v129
    v_cvt_pk_bf16_f32 v81, v130, v131
    v_cvt_pk_bf16_f32 v82, v132, v133
    v_cvt_pk_bf16_f32 v83, v134, v135
    s_waitcnt lgkmcnt(4)
    v_mfma_f32_16x16x32_bf16 v[160:163], v[56:59], v[16:19], v[160:163]
    ds_read_b128 v[24:27], v1 offset:12288
    ds_read_b128 v[28:31], v1 offset:14336
    v_mfma_f32_16x16x32_bf16 v[164:167], v[56:59], v[20:23], v[164:167]
    ds_read_b128 v[40:43], v2 offset:12288
    ds_read_b128 v[44:47], v2 offset:14336
    s_nop 1
    v_pk_mul_f32 v[144:145], v[144:145], s[32:33] op_sel_hi:[1,0]
    v_pk_mul_f32 v[146:147], v[146:147], s[32:33] op_sel_hi:[1,0]
    v_pk_mul_f32 v[148:149], v[148:149], s[32:33] op_sel_hi:[1,0]
    v_pk_mul_f32 v[150:151], v[150:151], s[32:33] op_sel_hi:[1,0]
    v_exp_f32 v144, v144
    v_mfma_f32_16x16x32_bf16 v[168:171], v[4:7], v[16:19], v[168:171]
    v_exp_f32 v145, v145
    v_exp_f32 v146, v146
    v_exp_f32 v147, v147
    v_exp_f32 v148, v148
    v_exp_f32 v149, v149
    v_mfma_f32_16x16x32_bf16 v[172:175], v[4:7], v[20:23], v[172:175]
    v_exp_f32 v150, v150
    v_exp_f32 v151, v151
    v_pk_add_f32 v[144:145], v[144:145], 1.0 op_sel_hi:[1,0]
    v_pk_add_f32 v[146:147], v[146:147], 1.0 op_sel_hi:[1,0]
    v_pk_add_f32 v[148:149], v[148:149], 1.0 op_sel_hi:[1,0]
    v_mfma_f32_16x16x32_bf16 v[160:163], v[48:51], v[32:35], v[160:163]
    v_pk_add_f32 v[150:151], v[150:151], 1.0 op_sel_hi:[1,0]
    v_rcp_f32 v144, v144
    v_rcp_f32 v145, v145
    v_rcp_f32 v146, v146
    v_rcp_f32 v147, v147
    v_mfma_f32_16x16x32_bf16 v[164:167], v[48:51], v[36:39], v[164:167]
    v_rcp_f32 v148, v148
    v_rcp_f32 v149, v149
    v_rcp_f32 v150, v150
    v_rcp_f32 v151, v151
    v_permlane32_swap_b32 v80, v82
    v_mfma_f32_16x16x32_bf16 v[168:171], v[60:63], v[32:35], v[168:171]
    v_permlane32_swap_b32 v81, v83
    v_pk_mul_f32 v[144:145], v[144:145], v[152:153]
    v_pk_mul_f32 v[146:147], v[146:147], v[154:155]
    v_pk_mul_f32 v[148:149], v[148:149], v[156:157]
    v_pk_mul_f32 v[150:151], v[150:151], v[158:159]
    v_mfma_f32_16x16x32_bf16 v[172:175], v[60:63], v[36:39], v[172:175]
    v_cvt_pk_bf16_f32 v84, v144, v145
    v_cvt_pk_bf16_f32 v85, v146, v147
    v_cvt_pk_bf16_f32 v86, v148, v149
    v_cvt_pk_bf16_f32 v87, v150, v151
    s_waitcnt lgkmcnt(0)
    v_mfma_f32_16x16x32_bf16 v[176:179], v[56:59], v[24:27], v[176:179]
    ds_read_b128 v[16:19], v1 offset:0
    ds_read_b128 v[20:23], v1 offset:2048
    v_mfma_f32_16x16x32_bf16 v[180:183], v[56:59], v[28:31], v[180:183]
    ds_read_b128 v[32:35], v2 offset:0
    ds_read_b128 v[36:39], v2 offset:2048
    s_nop 1
    v_pk_mul_f32 v[160:161], v[160:161], s[32:33] op_sel_hi:[1,0]
    v_pk_mul_f32 v[162:163], v[162:163], s[32:33] op_sel_hi:[1,0]
    v_pk_mul_f32 v[164:165], v[164:165], s[32:33] op_sel_hi:[1,0]
    v_pk_mul_f32 v[166:167], v[166:167], s[32:33] op_sel_hi:[1,0]
    v_exp_f32 v160, v160
    v_mfma_f32_16x16x32_bf16 v[184:187], v[4:7], v[24:27], v[184:187]
    v_exp_f32 v161, v161
    v_exp_f32 v162, v162
    v_exp_f32 v163, v163
    v_exp_f32 v164, v164
    v_exp_f32 v165, v165
    v_mfma_f32_16x16x32_bf16 v[188:191], v[4:7], v[28:31], v[188:191]
    v_exp_f32 v166, v166
    v_exp_f32 v167, v167
    v_pk_add_f32 v[160:161], v[160:161], 1.0 op_sel_hi:[1,0]
    v_pk_add_f32 v[162:163], v[162:163], 1.0 op_sel_hi:[1,0]
    v_pk_add_f32 v[164:165], v[164:165], 1.0 op_sel_hi:[1,0]
    v_mfma_f32_16x16x32_bf16 v[176:179], v[48:51], v[40:43], v[176:179]
    ds_read_b64_tr_b16 v[56:57], v3 offset:6208
    ds_read_b64_tr_b16 v[58:59], v3 offset:6976
    v_pk_add_f32 v[166:167], v[166:167], 1.0 op_sel_hi:[1,0]
    v_rcp_f32 v160, v160
    v_rcp_f32 v161, v161
    v_rcp_f32 v162, v162
    v_rcp_f32 v163, v163
    v_mfma_f32_16x16x32_bf16 v[180:183], v[48:51], v[44:47], v[180:183]
    ds_read_b64_tr_b16 v[4:5], v3 offset:18496
    ds_read_b64_tr_b16 v[6:7], v3 offset:19264
    v_rcp_f32 v164, v164
    v_rcp_f32 v165, v165
    v_rcp_f32 v166, v166
    v_rcp_f32 v167, v167
    v_permlane32_swap_b32 v84, v86
    v_mfma_f32_16x16x32_bf16 v[184:187], v[60:63], v[40:43], v[184:187]
    v_permlane32_swap_b32 v85, v87
    v_pk_mul_f32 v[160:161], v[160:161], v[168:169]
    v_pk_mul_f32 v[162:163], v[162:163], v[170:171]
    v_pk_mul_f32 v[164:165], v[164:165], v[172:173]
    v_pk_mul_f32 v[166:167], v[166:167], v[174:175]
    v_mfma_f32_16x16x32_bf16 v[188:191], v[60:63], v[44:47], v[188:191]
    v_cvt_pk_bf16_f32 v88, v160, v161
    v_cvt_pk_bf16_f32 v89, v162, v163
    v_cvt_pk_bf16_f32 v90, v164, v165
    v_cvt_pk_bf16_f32 v91, v166, v167
    s_waitcnt lgkmcnt(4)
    v_mfma_f32_16x16x32_bf16 v[192:195], v[52:55], v[16:19], v[192:195]
    ds_read_b128 v[24:27], v1 offset:4096
    ds_read_b128 v[28:31], v1 offset:6144
    v_mfma_f32_16x16x32_bf16 v[196:199], v[52:55], v[20:23], v[196:199]
    ds_read_b128 v[40:43], v2 offset:4096
    ds_read_b128 v[44:47], v2 offset:6144
    s_nop 1
    v_pk_mul_f32 v[176:177], v[176:177], s[32:33] op_sel_hi:[1,0]
    v_pk_mul_f32 v[178:179], v[178:179], s[32:33] op_sel_hi:[1,0]
    v_pk_mul_f32 v[180:181], v[180:181], s[32:33] op_sel_hi:[1,0]
    v_pk_mul_f32 v[182:183], v[182:183], s[32:33] op_sel_hi:[1,0]
    v_exp_f32 v176, v176
    v_mfma_f32_16x16x32_bf16 v[200:203], v[8:11], v[16:19], v[200:203]
    v_exp_f32 v177, v177
    v_exp_f32 v178, v178
    v_exp_f32 v179, v179
    v_exp_f32 v180, v180
    v_exp_f32 v181, v181
    v_mfma_f32_16x16x32_bf16 v[204:207], v[8:11], v[20:23], v[204:207]
    v_exp_f32 v182, v182
    v_exp_f32 v183, v183
    v_pk_add_f32 v[176:177], v[176:177], 1.0 op_sel_hi:[1,0]
    v_pk_add_f32 v[178:179], v[178:179], 1.0 op_sel_hi:[1,0]
    v_pk_add_f32 v[180:181], v[180:181], 1.0 op_sel_hi:[1,0]
    s_waitcnt lgkmcnt(4)
    v_mfma_f32_16x16x32_bf16 v[192:195], v[56:59], v[32:35], v[192:195]
    v_pk_add_f32 v[182:183], v[182:183], 1.0 op_sel_hi:[1,0]
    v_rcp_f32 v176, v176
    v_rcp_f32 v177, v177
    v_rcp_f32 v178, v178
    v_rcp_f32 v179, v179
    v_mfma_f32_16x16x32_bf16 v[196:199], v[56:59], v[36:39], v[196:199]
    v_rcp_f32 v180, v180
    v_rcp_f32 v181, v181
    v_rcp_f32 v182, v182
    v_rcp_f32 v183, v183
    v_permlane32_swap_b32 v88, v90
    v_mfma_f32_16x16x32_bf16 v[200:203], v[4:7], v[32:35], v[200:203]
    v_permlane32_swap_b32 v89, v91
    v_pk_mul_f32 v[176:177], v[176:177], v[184:185]
    v_pk_mul_f32 v[178:179], v[178:179], v[186:187]
    v_pk_mul_f32 v[180:181], v[180:181], v[188:189]
    v_pk_mul_f32 v[182:183], v[182:183], v[190:191]
    v_mfma_f32_16x16x32_bf16 v[204:207], v[4:7], v[36:39], v[204:207]
    v_cvt_pk_bf16_f32 v92, v176, v177
    v_cvt_pk_bf16_f32 v93, v178, v179
    v_cvt_pk_bf16_f32 v94, v180, v181
    v_cvt_pk_bf16_f32 v95, v182, v183
    s_waitcnt lgkmcnt(0)
    v_mfma_f32_16x16x32_bf16 v[208:211], v[52:55], v[24:27], v[208:211]
    ds_read_b128 v[16:19], v1 offset:8192
    ds_read_b128 v[20:23], v1 offset:10240
    v_mfma_f32_16x16x32_bf16 v[212:215], v[52:55], v[28:31], v[212:215]
    ds_read_b128 v[32:35], v2 offset:8192
    ds_read_b128 v[36:39], v2 offset:10240
    s_nop 1
    v_pk_mul_f32 v[192:193], v[192:193], s[32:33] op_sel_hi:[1,0]
    v_pk_mul_f32 v[194:195], v[194:195], s[32:33] op_sel_hi:[1,0]
    v_pk_mul_f32 v[196:197], v[196:197], s[32:33] op_sel_hi:[1,0]
    v_pk_mul_f32 v[198:199], v[198:199], s[32:33] op_sel_hi:[1,0]
    v_exp_f32 v192, v192
    v_mfma_f32_16x16x32_bf16 v[216:219], v[8:11], v[24:27], v[216:219]
    v_exp_f32 v193, v193
    v_exp_f32 v194, v194
    v_exp_f32 v195, v195
    v_exp_f32 v196, v196
    v_exp_f32 v197, v197
    v_mfma_f32_16x16x32_bf16 v[220:223], v[8:11], v[28:31], v[220:223]
    v_exp_f32 v198, v198
    v_exp_f32 v199, v199
    v_pk_add_f32 v[192:193], v[192:193], 1.0 op_sel_hi:[1,0]
    v_pk_add_f32 v[194:195], v[194:195], 1.0 op_sel_hi:[1,0]
    v_pk_add_f32 v[196:197], v[196:197], 1.0 op_sel_hi:[1,0]
    v_mfma_f32_16x16x32_bf16 v[208:211], v[56:59], v[40:43], v[208:211]
    v_pk_add_f32 v[198:199], v[198:199], 1.0 op_sel_hi:[1,0]
    v_rcp_f32 v192, v192
    v_rcp_f32 v193, v193
    v_rcp_f32 v194, v194
    v_rcp_f32 v195, v195
    v_mfma_f32_16x16x32_bf16 v[212:215], v[56:59], v[44:47], v[212:215]
    v_rcp_f32 v196, v196
    v_rcp_f32 v197, v197
    v_rcp_f32 v198, v198
    v_rcp_f32 v199, v199
    v_permlane32_swap_b32 v92, v94
    v_mfma_f32_16x16x32_bf16 v[216:219], v[4:7], v[40:43], v[216:219]
    v_permlane32_swap_b32 v93, v95
    v_pk_mul_f32 v[192:193], v[192:193], v[200:201]
    v_pk_mul_f32 v[194:195], v[194:195], v[202:203]
    v_pk_mul_f32 v[196:197], v[196:197], v[204:205]
    v_pk_mul_f32 v[198:199], v[198:199], v[206:207]
    v_mfma_f32_16x16x32_bf16 v[220:223], v[4:7], v[44:47], v[220:223]
    v_cvt_pk_bf16_f32 v96, v192, v193
    v_cvt_pk_bf16_f32 v97, v194, v195
    v_cvt_pk_bf16_f32 v98, v196, v197
    v_cvt_pk_bf16_f32 v99, v198, v199
    s_waitcnt lgkmcnt(0)
    v_mfma_f32_16x16x32_bf16 v[224:227], v[52:55], v[16:19], v[224:227]
    ds_read_b128 v[24:27], v1 offset:12288
    ds_read_b128 v[28:31], v1 offset:14336
    v_mfma_f32_16x16x32_bf16 v[228:231], v[52:55], v[20:23], v[228:231]
    ds_read_b128 v[40:43], v2 offset:12288
    ds_read_b128 v[44:47], v2 offset:14336
    s_nop 1
    v_pk_mul_f32 v[208:209], v[208:209], s[32:33] op_sel_hi:[1,0]
    v_pk_mul_f32 v[210:211], v[210:211], s[32:33] op_sel_hi:[1,0]
    v_pk_mul_f32 v[212:213], v[212:213], s[32:33] op_sel_hi:[1,0]
    v_pk_mul_f32 v[214:215], v[214:215], s[32:33] op_sel_hi:[1,0]
    v_exp_f32 v208, v208
    v_mfma_f32_16x16x32_bf16 v[232:235], v[8:11], v[16:19], v[232:235]
    v_exp_f32 v209, v209
    v_exp_f32 v210, v210
    v_exp_f32 v211, v211
    v_exp_f32 v212, v212
    v_exp_f32 v213, v213
    v_mfma_f32_16x16x32_bf16 v[236:239], v[8:11], v[20:23], v[236:239]
    v_exp_f32 v214, v214
    v_exp_f32 v215, v215
    v_pk_add_f32 v[208:209], v[208:209], 1.0 op_sel_hi:[1,0]
    v_pk_add_f32 v[210:211], v[210:211], 1.0 op_sel_hi:[1,0]
    v_pk_add_f32 v[212:213], v[212:213], 1.0 op_sel_hi:[1,0]
    v_mfma_f32_16x16x32_bf16 v[224:227], v[56:59], v[32:35], v[224:227]
    v_pk_add_f32 v[214:215], v[214:215], 1.0 op_sel_hi:[1,0]
    v_rcp_f32 v208, v208
    v_rcp_f32 v209, v209
    v_rcp_f32 v210, v210
    v_rcp_f32 v211, v211
    v_mfma_f32_16x16x32_bf16 v[228:231], v[56:59], v[36:39], v[228:231]
    v_rcp_f32 v212, v212
    v_rcp_f32 v213, v213
    v_rcp_f32 v214, v214
    v_rcp_f32 v215, v215
    v_permlane32_swap_b32 v96, v98
    v_mfma_f32_16x16x32_bf16 v[232:235], v[4:7], v[32:35], v[232:235]
    v_permlane32_swap_b32 v97, v99
    v_pk_mul_f32 v[208:209], v[208:209], v[216:217]
    v_pk_mul_f32 v[210:211], v[210:211], v[218:219]
    v_pk_mul_f32 v[212:213], v[212:213], v[220:221]
    v_pk_mul_f32 v[214:215], v[214:215], v[222:223]
    v_mfma_f32_16x16x32_bf16 v[236:239], v[4:7], v[36:39], v[236:239]
    v_cvt_pk_bf16_f32 v100, v208, v209
    v_cvt_pk_bf16_f32 v101, v210, v211
    v_cvt_pk_bf16_f32 v102, v212, v213
    v_cvt_pk_bf16_f32 v103, v214, v215
    s_waitcnt lgkmcnt(0)
    v_mfma_f32_16x16x32_bf16 v[240:243], v[52:55], v[24:27], v[240:243]
    v_mfma_f32_16x16x32_bf16 v[244:247], v[52:55], v[28:31], v[244:247]
    s_nop 1
    v_pk_mul_f32 v[224:225], v[224:225], s[32:33] op_sel_hi:[1,0]
    v_pk_mul_f32 v[226:227], v[226:227], s[32:33] op_sel_hi:[1,0]
    v_pk_mul_f32 v[228:229], v[228:229], s[32:33] op_sel_hi:[1,0]
    v_pk_mul_f32 v[230:231], v[230:231], s[32:33] op_sel_hi:[1,0]
    v_exp_f32 v224, v224
    v_mfma_f32_16x16x32_bf16 v[248:251], v[8:11], v[24:27], v[248:251]
    v_exp_f32 v225, v225
    v_exp_f32 v226, v226
    v_exp_f32 v227, v227
    v_exp_f32 v228, v228
    v_exp_f32 v229, v229
    v_mfma_f32_16x16x32_bf16 v[252:255], v[8:11], v[28:31], v[252:255]
    v_exp_f32 v230, v230
    v_exp_f32 v231, v231
    v_pk_add_f32 v[224:225], v[224:225], 1.0 op_sel_hi:[1,0]
    v_pk_add_f32 v[226:227], v[226:227], 1.0 op_sel_hi:[1,0]
    v_pk_add_f32 v[228:229], v[228:229], 1.0 op_sel_hi:[1,0]
    v_mfma_f32_16x16x32_bf16 v[240:243], v[56:59], v[40:43], v[240:243]
    v_pk_add_f32 v[230:231], v[230:231], 1.0 op_sel_hi:[1,0]
    v_rcp_f32 v224, v224
    v_rcp_f32 v225, v225
    v_rcp_f32 v226, v226
    v_rcp_f32 v227, v227
    v_mfma_f32_16x16x32_bf16 v[244:247], v[56:59], v[44:47], v[244:247]
    v_rcp_f32 v228, v228
    v_rcp_f32 v229, v229
    v_rcp_f32 v230, v230
    v_rcp_f32 v231, v231
    v_permlane32_swap_b32 v100, v102
    v_mfma_f32_16x16x32_bf16 v[248:251], v[4:7], v[40:43], v[248:251]
    v_permlane32_swap_b32 v101, v103
    v_pk_mul_f32 v[224:225], v[224:225], v[232:233]
    v_pk_mul_f32 v[226:227], v[226:227], v[234:235]
    v_pk_mul_f32 v[228:229], v[228:229], v[236:237]
    v_pk_mul_f32 v[230:231], v[230:231], v[238:239]
    v_mfma_f32_16x16x32_bf16 v[252:255], v[4:7], v[44:47], v[252:255]
    v_cvt_pk_bf16_f32 v104, v224, v225
    v_cvt_pk_bf16_f32 v105, v226, v227
    v_cvt_pk_bf16_f32 v106, v228, v229
    v_cvt_pk_bf16_f32 v107, v230, v231
    s_nop 7
    v_pk_mul_f32 v[240:241], v[240:241], s[32:33] op_sel_hi:[1,0]
    v_pk_mul_f32 v[242:243], v[242:243], s[32:33] op_sel_hi:[1,0]
    v_pk_mul_f32 v[244:245], v[244:245], s[32:33] op_sel_hi:[1,0]
    v_pk_mul_f32 v[246:247], v[246:247], s[32:33] op_sel_hi:[1,0]
    v_exp_f32 v240, v240
    v_exp_f32 v241, v241
    v_exp_f32 v242, v242
    v_exp_f32 v243, v243
    v_exp_f32 v244, v244
    v_exp_f32 v245, v245
    v_exp_f32 v246, v246
    v_exp_f32 v247, v247
    v_pk_add_f32 v[240:241], v[240:241], 1.0 op_sel_hi:[1,0]
    v_pk_add_f32 v[242:243], v[242:243], 1.0 op_sel_hi:[1,0]
    v_pk_add_f32 v[244:245], v[244:245], 1.0 op_sel_hi:[1,0]
    v_pk_add_f32 v[246:247], v[246:247], 1.0 op_sel_hi:[1,0]
    v_rcp_f32 v240, v240
    v_rcp_f32 v241, v241
    v_rcp_f32 v242, v242
    v_rcp_f32 v243, v243
    v_rcp_f32 v244, v244
    v_rcp_f32 v245, v245
    v_rcp_f32 v246, v246
    v_rcp_f32 v247, v247
    v_permlane32_swap_b32 v104, v106
    v_permlane32_swap_b32 v105, v107
    v_pk_mul_f32 v[240:241], v[240:241], v[248:249]
    v_pk_mul_f32 v[242:243], v[242:243], v[250:251]
    v_pk_mul_f32 v[244:245], v[244:245], v[252:253]
    v_pk_mul_f32 v[246:247], v[246:247], v[254:255]
    v_cvt_pk_bf16_f32 v108, v240, v241
    v_cvt_pk_bf16_f32 v109, v242, v243
    v_cvt_pk_bf16_f32 v110, v244, v245
    v_cvt_pk_bf16_f32 v111, v246, v247
    s_nop 0
    v_permlane32_swap_b32 v108, v110
    v_permlane32_swap_b32 v109, v111
    v_and_b32 v1, 31, v0
    v_lshrrev_b32 v2, 5, v0
    v_lshlrev_b32 v8, 4, v0
    s_mul_i32 s23, s7, 10432
    s_add_u32 s23, s23, 32768
    s_add_u32 s22, s23, 2576
    v_add_u32 v4, s23, v8
    s_add_u32 s31, s23, 1024
    v_lshl_add_u32 v5, v1, 3, s31
    v_cmp_eq_u32 vcc, 0, v2
    v_mov_b32 v3, s22
    s_add_u32 s31, s23, 1280
    v_and_b32 v12, 3, v1
    v_cndmask_b32 v5, v3, v5, vcc
    v_lshl_add_u32 v12, v12, 4, s31
    v_lshl_add_u32 v12, v2, 6, v12
    v_lshrrev_b32 v13, 2, v1
    v_lshl_add_u32 v6, v13, 7, v12
    v_cmp_lt_u32 vcc, 20, v1
    v_subrev_u32 v12, 16, v3
    v_add_u32 v13, 16, v3
    v_cndmask_b32 v3, v12, v13, vcc
    v_cmp_gt_u32 vcc, 20, v1
    v_add_u32 v7, 640, v6
    v_mov_b32 v9, 0xdddddddd
    v_cndmask_b32 v6, v3, v6, vcc
    v_cndmask_b32 v7, v3, v7, vcc
    v_lshlrev_b32 v12, 3, v0
    v_mov_b32 v24, 0
    v_mov_b32 v25, 0
    v_mov_b32 v26, 0
    v_mov_b32 v27, 0
    s_barrier
    buffer_load_dwordx4 v[16:19], v8, s[16:19], s71 offen offset:0 sc1
    buffer_load_dwordx4 v[20:23], v8, s[16:19], s71 offen offset:1280 sc1
    s_mov_b64 exec, s[64:65]
    buffer_load_dwordx2 v[24:25], v12, s[16:19], s71 offen offset:1024 sc1
    buffer_load_dwordx2 v[26:27], v12, s[16:19], s71 offen offset:2304 sc1
    s_mov_b64 exec, -1
    s_mov_b32 m0, s72
    s_nop 0
    global_load_lds_dwordx4 v8, s[74:75] sc1
    global_load_lds_dwordx4 v8, s[74:75] offset:1024 sc1
    s_mov_b64 exec, s[64:65]
    global_load_lds_dwordx4 v8, s[74:75] offset:2048 sc1
    s_mov_b64 exec, -1
    v_lshlrev_b32 v14, 7, v0
    s_lshl_b32 s32, s62, 5
    s_add_u32 s32, s32, s61
    s_lshl_b32 s32, s32, 7
    s_add_u32 s32, s32, 26214400
    s_add_u32 s34, s5, s7
    s_lshl_b32 s34, s34, 7
    s_add_u32 s34, s34, 22020096
    s_and_b32 s35, s26, -2
    s_lshl_b32 s35, s35, 7
    s_add_u32 s35, s35, 22020096
    s_lshr_b32 s33, s26, 3
    s_lshl_b32 s33, s33, 12
    s_add_u32 s33, s33, 26214400
    s_mov_b32 s8, s52
    s_mov_b32 s9, s53
    s_mul_i32 s31, s6, 14
    s_mul_i32 s22, s6, 13
    s_add_u32 s22, s22, 56
    s_cmp_eq_u32 s7, 0
    s_cselect_b32 s31, s31, s22
    s_add_u32 s31, s31, 4
    s_min_u32 s22, s78, s79
    s_lshr_b32 s22, s22, 2
    s_mul_i32 s22, s22, 4736
    s_add_u32 s22, s22, 26244864
    v_cmp_gt_u32 vcc, 18, v0
    v_add_u32 v168, s22, v14
    v_add_u32 v160, s33, v14
    v_cndmask_b32 v168, v168, v160, vcc
    s_add_u32 s22, s78, 1
    s_max_u32 s22, s22, s79
    s_lshr_b32 s22, s22, 2
    s_mul_i32 s22, s22, 4736
    s_add_u32 s38, s22, 26244864
    s_mov_b32 s40, 0xfffc0000
    s_mov_b32 s41, 0x007fffff
    s_mov_b32 s66, -1
    s_mov_b32 s67, 0x007fffff
    v_mov_b32 v169, 1
    s_mul_i32 s44, s26, 108
    s_add_u32 s44, s44, s31
    s_lshl_b32 s44, s44, 10
    s_add_u32 s44, s44, 10485760
    s_add_u32 s44, s44, s56
    s_addc_u32 s45, s57, 0
    s_mul_i32 s46, s27, 108
    s_add_u32 s46, s46, s31
    s_lshl_b32 s46, s46, 10
    s_add_u32 s46, s46, 10485760
    s_add_u32 s46, s46, s56
    s_addc_u32 s47, s57, 0
    s_mul_i32 s48, s78, 148
    s_add_u32 s48, s48, s31
    s_lshl_b32 s48, s48, 10
    s_add_u32 s48, s48, 23068672
    s_add_u32 s48, s48, s56
    s_addc_u32 s49, s57, 0
    s_mul_i32 s50, s78, 148
    s_add_u32 s50, s50, s31
    s_lshl_b32 s50, s50, 10
    s_add_u32 s50, s50, 23220224
    s_add_u32 s50, s50, s56
    s_addc_u32 s51, s57, 0
    s_mul_i32 s52, s79, 148
    s_add_u32 s52, s52, s31
    s_lshl_b32 s52, s52, 10
    s_add_u32 s52, s52, 23068672
    s_add_u32 s52, s52, s56
    s_addc_u32 s53, s57, 0
    s_mul_i32 s12, s78, 148
    s_mul_i32 s23, s3, 5
    s_add_u32 s12, s12, s23
    s_lshl_b32 s12, s12, 10
    s_add_u32 s12, s12, 23179264
    s_add_u32 s12, s12, s56
    s_addc_u32 s13, s57, 0
    s_mul_i32 s14, s78, 148
    s_mul_i32 s23, s3, 5
    s_add_u32 s14, s14, s23
    s_lshl_b32 s14, s14, 10
    s_add_u32 s14, s14, 23330816
    s_add_u32 s14, s14, s56
    s_addc_u32 s15, s57, 0
    s_mul_i32 s36, s79, 148
    s_mul_i32 s23, s3, 5
    s_add_u32 s36, s36, s23
    s_lshl_b32 s36, s36, 10
    s_add_u32 s36, s36, 23179264
    s_add_u32 s36, s36, s56
    s_addc_u32 s37, s57, 0
    s_mul_i32 s24, s3, 4096
    s_mul_i32 s28, s3, 8192
    s_mul_i32 s29, s3, 2048
    s_mul_i32 s30, s3, 1024
    s_add_u32 s5, s5, s7
    s_mul_i32 s22, s5, 40960
    s_add_u32 s22, s22, 18874368
    s_lshl_b32 s55, s4, 8
    s_add_u32 s55, s55, s22
    s_add_u32 s55, s55, 32768
    s_lshl_b32 s54, s4, 10
    s_add_u32 s54, s54, s22
    v_mov_b32 v172, -1
    v_mov_b32 v173, -1
    v_mov_b32 v174, -1
    v_mov_b32 v175, -1
    v_lshlrev_b32 v170, 3, v0
    s_add_u32 s25, s60, s7
    s_add_u32 s42, s60, s3
    s_barrier
    s_branch L_gated_mix__softmax_full_mha__glu_gated_glu__prompt_cdone_32
L_gated_mix__softmax_full_mha__glu_gated_glu__prompt_cq_33:
    v_and_b32 v1, 31, v0
    v_lshrrev_b32 v2, 5, v0
    s_lshl_b32 s34, s62, 3
    s_lshl_b32 s23, s3, 1
    s_add_u32 s34, s34, s23
    s_and_b32 s29, s61, 3
    s_cmp_eq_u32 s60, 3
    s_cbranch_scc1 L_gated_mix__softmax_full_mha__glu_gated_glu__prompt_cg_36
    s_cmp_eq_u32 s60, 2
    s_cbranch_scc1 L_gated_mix__softmax_full_mha__glu_gated_glu__prompt_cv_34
    s_mov_b32 s33, 81920
    s_mov_b32 s42, 0x3ea52b5c
    s_movk_i32 s43, 1280
    s_mov_b32 s35, 0
    s_cmp_ge_u32 s61, 4
    s_cselect_b32 s33, 163840, s33
    s_cselect_b32 s42, 1.0, s42
    s_cselect_b32 s43, 2560, s43
    s_cselect_b32 s35, 4194304, s35
    s_cselect_b32 s38, 2, 0
    s_cselect_b64 vcc, -1, 0
    v_and_b32 v1, 15, v0
    v_lshl_add_u32 v1, v2, 4, v1
    v_bfe_u32 v2, v0, 4, 1
    v_and_b32 v3, 0x13, v1
    v_and_b32 v56, 4, v1
    v_lshl_or_b32 v3, v56, 1, v3
    v_bfe_u32 v56, v1, 3, 1
    v_lshl_or_b32 v3, v56, 2, v3
    v_cndmask_b32 v3, v1, v3, vcc
    v_lshlrev_b32 v9, 4, v3
    v_lshl_add_u32 v9, v2, 9, v9
    v_lshlrev_b32 v3, 3, v3
    v_mad_u32_u24 v10, v2, s33, v3
    s_lshl_b32 s29, s29, 3
    s_mul_i32 s29, s29, s33
    s_add_u32 s35, s35, s29
    s_add_u32 s28, s34, 0
    s_sub_u32 s29, s28, s38
    s_and_b32 s29, s29, 31
    s_and_b32 s28, s28, 32
    s_or_b32 s28, s28, s29
    s_mul_i32 s28, s28, s43
    s_add_u32 s76, s28, s35
    s_add_u32 s28, s34, 1
    s_sub_u32 s29, s28, s38
    s_and_b32 s29, s29, 31
    s_and_b32 s28, s28, 32
    s_or_b32 s28, s28, s29
    s_mul_i32 s28, s28, s43
    s_add_u32 s77, s28, s35
    s_barrier
    s_waitcnt lgkmcnt(0)
    ds_read_b128 v[16:19], v4 offset:0
    ds_read_b128 v[20:23], v4 offset:2048
    ds_read_b128 v[24:27], v4 offset:4096
    ds_read_b128 v[28:31], v4 offset:6144
    ds_read_b64_tr_b16 v[48:49], v6 offset:0
    ds_read_b64_tr_b16 v[50:51], v6 offset:1280
    ds_read_b64_tr_b16 v[52:53], v7 offset:32
    ds_read_b64_tr_b16 v[54:55], v7 offset:1312
    ds_read_b64_tr_b16 v[56:57], v6 offset:64
    ds_read_b64_tr_b16 v[58:59], v6 offset:1344
    ds_read_b64_tr_b16 v[60:61], v7 offset:96
    ds_read_b64_tr_b16 v[62:63], v7 offset:1376
    ds_read_b64_tr_b16 v[64:65], v6 offset:128
    ds_read_b64_tr_b16 v[66:67], v6 offset:1408
    s_waitcnt lgkmcnt(6)
    ds_read_b64_tr_b16 v[68:69], v7 offset:160
    ds_read_b64_tr_b16 v[70:71], v7 offset:1440
    ds_read_b64_tr_b16 v[72:73], v6 offset:192
    ds_read_b64_tr_b16 v[74:75], v6 offset:1472
    ds_read_b64_tr_b16 v[76:77], v7 offset:224
    ds_read_b64_tr_b16 v[78:79], v7 offset:1504
    ds_read_b64_tr_b16 v[80:81], v6 offset:256
    ds_read_b64_tr_b16 v[82:83], v6 offset:1536
    ds_read_b64_tr_b16 v[84:85], v7 offset:288
    ds_read_b64_tr_b16 v[86:87], v7 offset:1568
    s_mov_b32 s21, 9
    s_mov_b32 s24, 0
    s_mov_b32 s25, 24576
    s_waitcnt lgkmcnt(0)
.p2align 6
L_gated_mix__softmax_full_mha__glu_gated_glu__prompt_ql_38:
    v_mfma_f32_16x16x32_bf16 v[96:99], v[48:51], v[16:19], v[96:99]
    ds_read_b128 v[32:35], v5 offset:0
    v_mfma_f32_16x16x32_bf16 v[100:103], v[48:51], v[20:23], v[100:103]
    ds_read_b128 v[36:39], v5 offset:2048
    v_mfma_f32_16x16x32_bf16 v[176:179], v[48:51], v[24:27], v[176:179]
    ds_read_b128 v[40:43], v5 offset:4096
    v_mfma_f32_16x16x32_bf16 v[180:183], v[48:51], v[28:31], v[180:183]
    ds_read_b128 v[44:47], v5 offset:6144
    v_mfma_f32_16x16x32_bf16 v[104:107], v[52:55], v[16:19], v[104:107]
    ds_read_b64_tr_b16 v[48:49], v6 offset:10240
    v_mfma_f32_16x16x32_bf16 v[108:111], v[52:55], v[20:23], v[108:111]
    ds_read_b64_tr_b16 v[50:51], v6 offset:11520
    v_mfma_f32_16x16x32_bf16 v[184:187], v[52:55], v[24:27], v[184:187]
    v_mfma_f32_16x16x32_bf16 v[188:191], v[52:55], v[28:31], v[188:191]
    ds_read_b64_tr_b16 v[52:53], v7 offset:10272
    v_mfma_f32_16x16x32_bf16 v[112:115], v[56:59], v[16:19], v[112:115]
    ds_read_b64_tr_b16 v[54:55], v7 offset:11552
    v_mfma_f32_16x16x32_bf16 v[116:119], v[56:59], v[20:23], v[116:119]
    v_mfma_f32_16x16x32_bf16 v[192:195], v[56:59], v[24:27], v[192:195]
    v_mfma_f32_16x16x32_bf16 v[196:199], v[56:59], v[28:31], v[196:199]
    ds_read_b64_tr_b16 v[56:57], v6 offset:10304
    v_mfma_f32_16x16x32_bf16 v[120:123], v[60:63], v[16:19], v[120:123]
    ds_read_b64_tr_b16 v[58:59], v6 offset:11584
    v_mfma_f32_16x16x32_bf16 v[124:127], v[60:63], v[20:23], v[124:127]
    v_mfma_f32_16x16x32_bf16 v[200:203], v[60:63], v[24:27], v[200:203]
    v_mfma_f32_16x16x32_bf16 v[204:207], v[60:63], v[28:31], v[204:207]
    ds_read_b64_tr_b16 v[60:61], v7 offset:10336
    v_mfma_f32_16x16x32_bf16 v[128:131], v[64:67], v[16:19], v[128:131]
    ds_read_b64_tr_b16 v[62:63], v7 offset:11616
    v_mfma_f32_16x16x32_bf16 v[132:135], v[64:67], v[20:23], v[132:135]
    v_mfma_f32_16x16x32_bf16 v[208:211], v[64:67], v[24:27], v[208:211]
    v_mfma_f32_16x16x32_bf16 v[212:215], v[64:67], v[28:31], v[212:215]
    ds_read_b64_tr_b16 v[64:65], v6 offset:10368
    v_mfma_f32_16x16x32_bf16 v[136:139], v[68:71], v[16:19], v[136:139]
    ds_read_b64_tr_b16 v[66:67], v6 offset:11648
    v_mfma_f32_16x16x32_bf16 v[140:143], v[68:71], v[20:23], v[140:143]
    v_mfma_f32_16x16x32_bf16 v[216:219], v[68:71], v[24:27], v[216:219]
    v_mfma_f32_16x16x32_bf16 v[220:223], v[68:71], v[28:31], v[220:223]
    ds_read_b64_tr_b16 v[68:69], v7 offset:10400
    v_mfma_f32_16x16x32_bf16 v[144:147], v[72:75], v[16:19], v[144:147]
    ds_read_b64_tr_b16 v[70:71], v7 offset:11680
    v_mfma_f32_16x16x32_bf16 v[148:151], v[72:75], v[20:23], v[148:151]
    v_mfma_f32_16x16x32_bf16 v[224:227], v[72:75], v[24:27], v[224:227]
    v_mfma_f32_16x16x32_bf16 v[228:231], v[72:75], v[28:31], v[228:231]
    ds_read_b64_tr_b16 v[72:73], v6 offset:10432
    s_waitcnt lgkmcnt(9)
    v_mfma_f32_16x16x32_bf16 v[152:155], v[76:79], v[16:19], v[152:155]
    ds_read_b64_tr_b16 v[74:75], v6 offset:11712
    v_mfma_f32_16x16x32_bf16 v[156:159], v[76:79], v[20:23], v[156:159]
    v_mfma_f32_16x16x32_bf16 v[232:235], v[76:79], v[24:27], v[232:235]
    v_mfma_f32_16x16x32_bf16 v[236:239], v[76:79], v[28:31], v[236:239]
    ds_read_b64_tr_b16 v[76:77], v7 offset:10464
    v_mfma_f32_16x16x32_bf16 v[160:163], v[80:83], v[16:19], v[160:163]
    ds_read_b64_tr_b16 v[78:79], v7 offset:11744
    v_mfma_f32_16x16x32_bf16 v[164:167], v[80:83], v[20:23], v[164:167]
    v_mfma_f32_16x16x32_bf16 v[240:243], v[80:83], v[24:27], v[240:243]
    v_mfma_f32_16x16x32_bf16 v[244:247], v[80:83], v[28:31], v[244:247]
    ds_read_b64_tr_b16 v[80:81], v6 offset:10496
    v_mfma_f32_16x16x32_bf16 v[168:171], v[84:87], v[16:19], v[168:171]
    ds_read_b64_tr_b16 v[82:83], v6 offset:11776
    v_mfma_f32_16x16x32_bf16 v[172:175], v[84:87], v[20:23], v[172:175]
    v_mfma_f32_16x16x32_bf16 v[248:251], v[84:87], v[24:27], v[248:251]
    v_mfma_f32_16x16x32_bf16 v[252:255], v[84:87], v[28:31], v[252:255]
    ds_read_b64_tr_b16 v[84:85], v7 offset:10528
    ds_read_b64_tr_b16 v[86:87], v7 offset:11808
    s_waitcnt lgkmcnt(6)
    v_mfma_f32_16x16x32_bf16 v[96:99], v[48:51], v[32:35], v[96:99]
    s_add_u32 s24, s24, 1
    s_cmp_eq_u32 s24, 3
    s_cselect_b32 s20, s30, s31
    v_mfma_f32_16x16x32_bf16 v[100:103], v[48:51], v[36:39], v[100:103]
    s_cselect_b32 s24, 0, s24
    s_sub_u32 s21, s21, 1
    v_mfma_f32_16x16x32_bf16 v[176:179], v[48:51], v[40:43], v[176:179]
    v_mfma_f32_16x16x32_bf16 v[180:183], v[48:51], v[44:47], v[180:183]
    v_mfma_f32_16x16x32_bf16 v[104:107], v[52:55], v[32:35], v[104:107]
    v_add_u32 v4, s20, v4
    v_mfma_f32_16x16x32_bf16 v[108:111], v[52:55], v[36:39], v[108:111]
    v_add_u32 v6, s25, v6
    v_mfma_f32_16x16x32_bf16 v[184:187], v[52:55], v[40:43], v[184:187]
    v_add_u32 v7, s25, v7
    v_mfma_f32_16x16x32_bf16 v[188:191], v[52:55], v[44:47], v[188:191]
    s_sub_u32 s25, 0, s25
    v_mfma_f32_16x16x32_bf16 v[112:115], v[56:59], v[32:35], v[112:115]
    s_waitcnt lgkmcnt(0)
    s_barrier
    ds_read_b64_tr_b16 v[48:49], v6 offset:0
    v_mfma_f32_16x16x32_bf16 v[116:119], v[56:59], v[36:39], v[116:119]
    ds_read_b64_tr_b16 v[50:51], v6 offset:1280
    v_mfma_f32_16x16x32_bf16 v[192:195], v[56:59], v[40:43], v[192:195]
    ds_read_b64_tr_b16 v[52:53], v7 offset:32
    v_mfma_f32_16x16x32_bf16 v[196:199], v[56:59], v[44:47], v[196:199]
    ds_read_b64_tr_b16 v[54:55], v7 offset:1312
    v_mfma_f32_16x16x32_bf16 v[120:123], v[60:63], v[32:35], v[120:123]
    ds_read_b128 v[16:19], v4 offset:0
    v_mfma_f32_16x16x32_bf16 v[124:127], v[60:63], v[36:39], v[124:127]
    ds_read_b128 v[20:23], v4 offset:2048
    v_mfma_f32_16x16x32_bf16 v[200:203], v[60:63], v[40:43], v[200:203]
    ds_read_b128 v[24:27], v4 offset:4096
    v_mfma_f32_16x16x32_bf16 v[204:207], v[60:63], v[44:47], v[204:207]
    ds_read_b128 v[28:31], v4 offset:6144
    v_mfma_f32_16x16x32_bf16 v[128:131], v[64:67], v[32:35], v[128:131]
    ds_read_b64_tr_b16 v[56:57], v6 offset:64
    v_mfma_f32_16x16x32_bf16 v[132:135], v[64:67], v[36:39], v[132:135]
    ds_read_b64_tr_b16 v[58:59], v6 offset:1344
    v_mfma_f32_16x16x32_bf16 v[208:211], v[64:67], v[40:43], v[208:211]
    ds_read_b64_tr_b16 v[60:61], v7 offset:96
    v_mfma_f32_16x16x32_bf16 v[212:215], v[64:67], v[44:47], v[212:215]
    ds_read_b64_tr_b16 v[62:63], v7 offset:1376
    v_mfma_f32_16x16x32_bf16 v[136:139], v[68:71], v[32:35], v[136:139]
    ds_read_b64_tr_b16 v[64:65], v6 offset:128
    v_mfma_f32_16x16x32_bf16 v[140:143], v[68:71], v[36:39], v[140:143]
    ds_read_b64_tr_b16 v[66:67], v6 offset:1408
    v_mfma_f32_16x16x32_bf16 v[216:219], v[68:71], v[40:43], v[216:219]
    v_mfma_f32_16x16x32_bf16 v[220:223], v[68:71], v[44:47], v[220:223]
    ds_read_b64_tr_b16 v[68:69], v7 offset:160
    v_mfma_f32_16x16x32_bf16 v[144:147], v[72:75], v[32:35], v[144:147]
    ds_read_b64_tr_b16 v[70:71], v7 offset:1440
    v_mfma_f32_16x16x32_bf16 v[148:151], v[72:75], v[36:39], v[148:151]
    v_mfma_f32_16x16x32_bf16 v[224:227], v[72:75], v[40:43], v[224:227]
    v_mfma_f32_16x16x32_bf16 v[228:231], v[72:75], v[44:47], v[228:231]
    ds_read_b64_tr_b16 v[72:73], v6 offset:192
    s_waitcnt lgkmcnt(13)
    v_mfma_f32_16x16x32_bf16 v[152:155], v[76:79], v[32:35], v[152:155]
    ds_read_b64_tr_b16 v[74:75], v6 offset:1472
    v_mfma_f32_16x16x32_bf16 v[156:159], v[76:79], v[36:39], v[156:159]
    v_mfma_f32_16x16x32_bf16 v[232:235], v[76:79], v[40:43], v[232:235]
    v_mfma_f32_16x16x32_bf16 v[236:239], v[76:79], v[44:47], v[236:239]
    ds_read_b64_tr_b16 v[76:77], v7 offset:224
    v_mfma_f32_16x16x32_bf16 v[160:163], v[80:83], v[32:35], v[160:163]
    ds_read_b64_tr_b16 v[78:79], v7 offset:1504
    v_mfma_f32_16x16x32_bf16 v[164:167], v[80:83], v[36:39], v[164:167]
    v_mfma_f32_16x16x32_bf16 v[240:243], v[80:83], v[40:43], v[240:243]
    v_mfma_f32_16x16x32_bf16 v[244:247], v[80:83], v[44:47], v[244:247]
    ds_read_b64_tr_b16 v[80:81], v6 offset:256
    v_mfma_f32_16x16x32_bf16 v[168:171], v[84:87], v[32:35], v[168:171]
    v_add_u32 v5, s20, v5
    ds_read_b64_tr_b16 v[82:83], v6 offset:1536
    v_mfma_f32_16x16x32_bf16 v[172:175], v[84:87], v[36:39], v[172:175]
    v_mfma_f32_16x16x32_bf16 v[248:251], v[84:87], v[40:43], v[248:251]
    v_mfma_f32_16x16x32_bf16 v[252:255], v[84:87], v[44:47], v[252:255]
    ds_read_b64_tr_b16 v[84:85], v7 offset:288
    ds_read_b64_tr_b16 v[86:87], v7 offset:1568
    s_waitcnt lgkmcnt(6)
    s_cmp_lg_u32 s21, 0
    s_cbranch_scc1 L_gated_mix__softmax_full_mha__glu_gated_glu__prompt_ql_38
    ds_read_b128 v[32:35], v5 offset:0
    ds_read_b128 v[36:39], v5 offset:2048
    ds_read_b128 v[40:43], v5 offset:4096
    ds_read_b128 v[44:47], v5 offset:6144
    ds_read_b64_tr_b16 v[88:89], v6 offset:10240
    ds_read_b64_tr_b16 v[90:91], v6 offset:11520
    v_mfma_f32_16x16x32_bf16 v[96:99], v[48:51], v[16:19], v[96:99]
    ds_read_b64_tr_b16 v[92:93], v7 offset:10272
    v_mfma_f32_16x16x32_bf16 v[100:103], v[48:51], v[20:23], v[100:103]
    ds_read_b64_tr_b16 v[94:95], v7 offset:11552
    v_mfma_f32_16x16x32_bf16 v[176:179], v[48:51], v[24:27], v[176:179]
    v_mfma_f32_16x16x32_bf16 v[180:183], v[48:51], v[28:31], v[180:183]
    s_waitcnt lgkmcnt(2)
    v_mfma_f32_16x16x32_bf16 v[96:99], v[88:91], v[32:35], v[96:99]
    v_mfma_f32_16x16x32_bf16 v[100:103], v[88:91], v[36:39], v[100:103]
    v_mfma_f32_16x16x32_bf16 v[176:179], v[88:91], v[40:43], v[176:179]
    v_mfma_f32_16x16x32_bf16 v[180:183], v[88:91], v[44:47], v[180:183]
    v_mfma_f32_16x16x32_bf16 v[104:107], v[52:55], v[16:19], v[104:107]
    ds_read_b64_tr_b16 v[88:89], v6 offset:10304
    v_mfma_f32_16x16x32_bf16 v[108:111], v[52:55], v[20:23], v[108:111]
    ds_read_b64_tr_b16 v[90:91], v6 offset:11584
    v_mfma_f32_16x16x32_bf16 v[184:187], v[52:55], v[24:27], v[184:187]
    v_mfma_f32_16x16x32_bf16 v[188:191], v[52:55], v[28:31], v[188:191]
    s_waitcnt lgkmcnt(2)
    v_mfma_f32_16x16x32_bf16 v[104:107], v[92:95], v[32:35], v[104:107]
    v_mfma_f32_16x16x32_bf16 v[108:111], v[92:95], v[36:39], v[108:111]
    v_mfma_f32_16x16x32_bf16 v[184:187], v[92:95], v[40:43], v[184:187]
    v_mfma_f32_16x16x32_bf16 v[188:191], v[92:95], v[44:47], v[188:191]
    v_mfma_f32_16x16x32_bf16 v[112:115], v[56:59], v[16:19], v[112:115]
    ds_read_b64_tr_b16 v[92:93], v7 offset:10336
    v_pk_mul_f32 v[96:97], v[96:97], s[42:43] op_sel_hi:[1,0]
    v_pk_mul_f32 v[98:99], v[98:99], s[42:43] op_sel_hi:[1,0]
    v_pk_mul_f32 v[100:101], v[100:101], s[42:43] op_sel_hi:[1,0]
    v_mfma_f32_16x16x32_bf16 v[116:119], v[56:59], v[20:23], v[116:119]
    ds_read_b64_tr_b16 v[94:95], v7 offset:11616
    v_pk_mul_f32 v[102:103], v[102:103], s[42:43] op_sel_hi:[1,0]
    v_cvt_pk_bf16_f32 v96, v96, v97
    v_cvt_pk_bf16_f32 v97, v98, v99
    v_mfma_f32_16x16x32_bf16 v[192:195], v[56:59], v[24:27], v[192:195]
    v_cvt_pk_bf16_f32 v98, v100, v101
    v_cvt_pk_bf16_f32 v99, v102, v103
    v_pk_mul_f32 v[176:177], v[176:177], s[42:43] op_sel_hi:[1,0]
    v_mfma_f32_16x16x32_bf16 v[196:199], v[56:59], v[28:31], v[196:199]
    v_pk_mul_f32 v[178:179], v[178:179], s[42:43] op_sel_hi:[1,0]
    v_pk_mul_f32 v[180:181], v[180:181], s[42:43] op_sel_hi:[1,0]
    v_pk_mul_f32 v[182:183], v[182:183], s[42:43] op_sel_hi:[1,0]
    s_waitcnt lgkmcnt(2)
    v_mfma_f32_16x16x32_bf16 v[112:115], v[88:91], v[32:35], v[112:115]
    v_cvt_pk_bf16_f32 v176, v176, v177
    v_cvt_pk_bf16_f32 v177, v178, v179
    v_cvt_pk_bf16_f32 v178, v180, v181
    v_mfma_f32_16x16x32_bf16 v[116:119], v[88:91], v[36:39], v[116:119]
    v_cvt_pk_bf16_f32 v179, v182, v183
    v_permlane32_swap_b32 v96, v98
    v_permlane32_swap_b32 v97, v99
    v_mfma_f32_16x16x32_bf16 v[192:195], v[88:91], v[40:43], v[192:195]
    v_permlane32_swap_b32 v176, v178
    v_permlane32_swap_b32 v177, v179
    v_mfma_f32_16x16x32_bf16 v[196:199], v[88:91], v[44:47], v[196:199]
    buffer_store_dwordx4 v[96:99], v9, s[16:19], s76 offen sc1
    buffer_store_dwordx4 v[176:179], v9, s[16:19], s77 offen sc1
    v_mfma_f32_16x16x32_bf16 v[120:123], v[60:63], v[16:19], v[120:123]
    ds_read_b64_tr_b16 v[88:89], v6 offset:10368
    v_pk_mul_f32 v[104:105], v[104:105], s[42:43] op_sel_hi:[1,0]
    v_pk_mul_f32 v[106:107], v[106:107], s[42:43] op_sel_hi:[1,0]
    v_pk_mul_f32 v[108:109], v[108:109], s[42:43] op_sel_hi:[1,0]
    v_mfma_f32_16x16x32_bf16 v[124:127], v[60:63], v[20:23], v[124:127]
    ds_read_b64_tr_b16 v[90:91], v6 offset:11648
    v_pk_mul_f32 v[110:111], v[110:111], s[42:43] op_sel_hi:[1,0]
    v_cvt_pk_bf16_f32 v100, v104, v105
    v_cvt_pk_bf16_f32 v101, v106, v107
    v_mfma_f32_16x16x32_bf16 v[200:203], v[60:63], v[24:27], v[200:203]
    v_cvt_pk_bf16_f32 v102, v108, v109
    v_cvt_pk_bf16_f32 v103, v110, v111
    v_pk_mul_f32 v[184:185], v[184:185], s[42:43] op_sel_hi:[1,0]
    v_mfma_f32_16x16x32_bf16 v[204:207], v[60:63], v[28:31], v[204:207]
    v_pk_mul_f32 v[186:187], v[186:187], s[42:43] op_sel_hi:[1,0]
    v_pk_mul_f32 v[188:189], v[188:189], s[42:43] op_sel_hi:[1,0]
    v_pk_mul_f32 v[190:191], v[190:191], s[42:43] op_sel_hi:[1,0]
    s_waitcnt lgkmcnt(2)
    v_mfma_f32_16x16x32_bf16 v[120:123], v[92:95], v[32:35], v[120:123]
    v_cvt_pk_bf16_f32 v180, v184, v185
    v_cvt_pk_bf16_f32 v181, v186, v187
    v_cvt_pk_bf16_f32 v182, v188, v189
    v_mfma_f32_16x16x32_bf16 v[124:127], v[92:95], v[36:39], v[124:127]
    v_cvt_pk_bf16_f32 v183, v190, v191
    v_permlane32_swap_b32 v100, v102
    v_permlane32_swap_b32 v101, v103
    v_mfma_f32_16x16x32_bf16 v[200:203], v[92:95], v[40:43], v[200:203]
    v_permlane32_swap_b32 v180, v182
    v_permlane32_swap_b32 v181, v183
    buffer_store_dwordx2 v[100:101], v10, s[16:19], s76 offen offset:1024 sc1
    v_mfma_f32_16x16x32_bf16 v[204:207], v[92:95], v[44:47], v[204:207]
    s_add_u32 s76, s76, s33
    buffer_store_dwordx2 v[180:181], v10, s[16:19], s77 offen offset:1024 sc1
    s_add_u32 s77, s77, s33
    v_mfma_f32_16x16x32_bf16 v[128:131], v[64:67], v[16:19], v[128:131]
    ds_read_b64_tr_b16 v[92:93], v7 offset:10400
    v_pk_mul_f32 v[112:113], v[112:113], s[42:43] op_sel_hi:[1,0]
    v_pk_mul_f32 v[114:115], v[114:115], s[42:43] op_sel_hi:[1,0]
    v_pk_mul_f32 v[116:117], v[116:117], s[42:43] op_sel_hi:[1,0]
    v_mfma_f32_16x16x32_bf16 v[132:135], v[64:67], v[20:23], v[132:135]
    ds_read_b64_tr_b16 v[94:95], v7 offset:11680
    v_pk_mul_f32 v[118:119], v[118:119], s[42:43] op_sel_hi:[1,0]
    v_cvt_pk_bf16_f32 v104, v112, v113
    v_cvt_pk_bf16_f32 v105, v114, v115
    v_mfma_f32_16x16x32_bf16 v[208:211], v[64:67], v[24:27], v[208:211]
    v_cvt_pk_bf16_f32 v106, v116, v117
    v_cvt_pk_bf16_f32 v107, v118, v119
    v_pk_mul_f32 v[192:193], v[192:193], s[42:43] op_sel_hi:[1,0]
    v_mfma_f32_16x16x32_bf16 v[212:215], v[64:67], v[28:31], v[212:215]
    v_pk_mul_f32 v[194:195], v[194:195], s[42:43] op_sel_hi:[1,0]
    v_pk_mul_f32 v[196:197], v[196:197], s[42:43] op_sel_hi:[1,0]
    v_pk_mul_f32 v[198:199], v[198:199], s[42:43] op_sel_hi:[1,0]
    s_waitcnt lgkmcnt(2)
    v_mfma_f32_16x16x32_bf16 v[128:131], v[88:91], v[32:35], v[128:131]
    v_cvt_pk_bf16_f32 v184, v192, v193
    v_cvt_pk_bf16_f32 v185, v194, v195
    v_cvt_pk_bf16_f32 v186, v196, v197
    v_mfma_f32_16x16x32_bf16 v[132:135], v[88:91], v[36:39], v[132:135]
    v_cvt_pk_bf16_f32 v187, v198, v199
    v_permlane32_swap_b32 v104, v106
    v_permlane32_swap_b32 v105, v107
    v_mfma_f32_16x16x32_bf16 v[208:211], v[88:91], v[40:43], v[208:211]
    v_permlane32_swap_b32 v184, v186
    v_permlane32_swap_b32 v185, v187
    buffer_store_dwordx4 v[102:105], v9, s[16:19], s76 offen sc1
    v_mfma_f32_16x16x32_bf16 v[212:215], v[88:91], v[44:47], v[212:215]
    s_add_u32 s76, s76, s33
    buffer_store_dwordx4 v[182:185], v9, s[16:19], s77 offen sc1
    s_add_u32 s77, s77, s33
    v_mfma_f32_16x16x32_bf16 v[136:139], v[68:71], v[16:19], v[136:139]
    ds_read_b64_tr_b16 v[88:89], v6 offset:10432
    v_pk_mul_f32 v[120:121], v[120:121], s[42:43] op_sel_hi:[1,0]
    v_pk_mul_f32 v[122:123], v[122:123], s[42:43] op_sel_hi:[1,0]
    v_pk_mul_f32 v[124:125], v[124:125], s[42:43] op_sel_hi:[1,0]
    v_pk_mul_f32 v[126:127], v[126:127], s[42:43] op_sel_hi:[1,0]
    v_mfma_f32_16x16x32_bf16 v[140:143], v[68:71], v[20:23], v[140:143]
    ds_read_b64_tr_b16 v[90:91], v6 offset:11712
    v_cvt_pk_bf16_f32 v108, v120, v121
    v_cvt_pk_bf16_f32 v109, v122, v123
    v_cvt_pk_bf16_f32 v110, v124, v125
    v_cvt_pk_bf16_f32 v111, v126, v127
    v_mfma_f32_16x16x32_bf16 v[216:219], v[68:71], v[24:27], v[216:219]
    v_pk_mul_f32 v[200:201], v[200:201], s[42:43] op_sel_hi:[1,0]
    v_pk_mul_f32 v[202:203], v[202:203], s[42:43] op_sel_hi:[1,0]
    v_pk_mul_f32 v[204:205], v[204:205], s[42:43] op_sel_hi:[1,0]
    v_mfma_f32_16x16x32_bf16 v[220:223], v[68:71], v[28:31], v[220:223]
    v_pk_mul_f32 v[206:207], v[206:207], s[42:43] op_sel_hi:[1,0]
    v_cvt_pk_bf16_f32 v188, v200, v201
    v_cvt_pk_bf16_f32 v189, v202, v203
    s_waitcnt lgkmcnt(2)
    v_mfma_f32_16x16x32_bf16 v[136:139], v[92:95], v[32:35], v[136:139]
    v_cvt_pk_bf16_f32 v190, v204, v205
    v_cvt_pk_bf16_f32 v191, v206, v207
    v_permlane32_swap_b32 v108, v110
    v_mfma_f32_16x16x32_bf16 v[140:143], v[92:95], v[36:39], v[140:143]
    v_permlane32_swap_b32 v109, v111
    v_permlane32_swap_b32 v188, v190
    v_permlane32_swap_b32 v189, v191
    v_mfma_f32_16x16x32_bf16 v[216:219], v[92:95], v[40:43], v[216:219]
    buffer_store_dwordx4 v[106:109], v9, s[16:19], s76 offen sc1
    buffer_store_dwordx2 v[110:111], v10, s[16:19], s76 offen offset:1024 sc1
    s_add_u32 s76, s76, s33
    v_mfma_f32_16x16x32_bf16 v[220:223], v[92:95], v[44:47], v[220:223]
    buffer_store_dwordx4 v[186:189], v9, s[16:19], s77 offen sc1
    buffer_store_dwordx2 v[190:191], v10, s[16:19], s77 offen offset:1024 sc1
    s_add_u32 s77, s77, s33
    v_mfma_f32_16x16x32_bf16 v[144:147], v[72:75], v[16:19], v[144:147]
    ds_read_b64_tr_b16 v[92:93], v7 offset:10464
    v_pk_mul_f32 v[128:129], v[128:129], s[42:43] op_sel_hi:[1,0]
    v_pk_mul_f32 v[130:131], v[130:131], s[42:43] op_sel_hi:[1,0]
    v_pk_mul_f32 v[132:133], v[132:133], s[42:43] op_sel_hi:[1,0]
    v_mfma_f32_16x16x32_bf16 v[148:151], v[72:75], v[20:23], v[148:151]
    ds_read_b64_tr_b16 v[94:95], v7 offset:11744
    v_pk_mul_f32 v[134:135], v[134:135], s[42:43] op_sel_hi:[1,0]
    v_cvt_pk_bf16_f32 v112, v128, v129
    v_cvt_pk_bf16_f32 v113, v130, v131
    v_mfma_f32_16x16x32_bf16 v[224:227], v[72:75], v[24:27], v[224:227]
    v_cvt_pk_bf16_f32 v114, v132, v133
    v_cvt_pk_bf16_f32 v115, v134, v135
    v_pk_mul_f32 v[208:209], v[208:209], s[42:43] op_sel_hi:[1,0]
    v_mfma_f32_16x16x32_bf16 v[228:231], v[72:75], v[28:31], v[228:231]
    v_pk_mul_f32 v[210:211], v[210:211], s[42:43] op_sel_hi:[1,0]
    v_pk_mul_f32 v[212:213], v[212:213], s[42:43] op_sel_hi:[1,0]
    v_pk_mul_f32 v[214:215], v[214:215], s[42:43] op_sel_hi:[1,0]
    s_waitcnt lgkmcnt(2)
    v_mfma_f32_16x16x32_bf16 v[144:147], v[88:91], v[32:35], v[144:147]
    v_cvt_pk_bf16_f32 v192, v208, v209
    v_cvt_pk_bf16_f32 v193, v210, v211
    v_cvt_pk_bf16_f32 v194, v212, v213
    v_mfma_f32_16x16x32_bf16 v[148:151], v[88:91], v[36:39], v[148:151]
    v_cvt_pk_bf16_f32 v195, v214, v215
    v_permlane32_swap_b32 v112, v114
    v_permlane32_swap_b32 v113, v115
    v_mfma_f32_16x16x32_bf16 v[224:227], v[88:91], v[40:43], v[224:227]
    v_permlane32_swap_b32 v192, v194
    v_permlane32_swap_b32 v193, v195
    buffer_store_dwordx4 v[112:115], v9, s[16:19], s76 offen sc1
    v_mfma_f32_16x16x32_bf16 v[228:231], v[88:91], v[44:47], v[228:231]
    s_add_u32 s76, s76, s33
    buffer_store_dwordx4 v[192:195], v9, s[16:19], s77 offen sc1
    s_add_u32 s77, s77, s33
    v_mfma_f32_16x16x32_bf16 v[152:155], v[76:79], v[16:19], v[152:155]
    ds_read_b64_tr_b16 v[88:89], v6 offset:10496
    v_pk_mul_f32 v[136:137], v[136:137], s[42:43] op_sel_hi:[1,0]
    v_pk_mul_f32 v[138:139], v[138:139], s[42:43] op_sel_hi:[1,0]
    v_pk_mul_f32 v[140:141], v[140:141], s[42:43] op_sel_hi:[1,0]
    v_mfma_f32_16x16x32_bf16 v[156:159], v[76:79], v[20:23], v[156:159]
    ds_read_b64_tr_b16 v[90:91], v6 offset:11776
    v_pk_mul_f32 v[142:143], v[142:143], s[42:43] op_sel_hi:[1,0]
    v_cvt_pk_bf16_f32 v116, v136, v137
    v_cvt_pk_bf16_f32 v117, v138, v139
    v_mfma_f32_16x16x32_bf16 v[232:235], v[76:79], v[24:27], v[232:235]
    v_cvt_pk_bf16_f32 v118, v140, v141
    v_cvt_pk_bf16_f32 v119, v142, v143
    v_pk_mul_f32 v[216:217], v[216:217], s[42:43] op_sel_hi:[1,0]
    v_mfma_f32_16x16x32_bf16 v[236:239], v[76:79], v[28:31], v[236:239]
    v_pk_mul_f32 v[218:219], v[218:219], s[42:43] op_sel_hi:[1,0]
    v_pk_mul_f32 v[220:221], v[220:221], s[42:43] op_sel_hi:[1,0]
    v_pk_mul_f32 v[222:223], v[222:223], s[42:43] op_sel_hi:[1,0]
    s_waitcnt lgkmcnt(2)
    v_mfma_f32_16x16x32_bf16 v[152:155], v[92:95], v[32:35], v[152:155]
    v_cvt_pk_bf16_f32 v196, v216, v217
    v_cvt_pk_bf16_f32 v197, v218, v219
    v_cvt_pk_bf16_f32 v198, v220, v221
    v_mfma_f32_16x16x32_bf16 v[156:159], v[92:95], v[36:39], v[156:159]
    v_cvt_pk_bf16_f32 v199, v222, v223
    v_permlane32_swap_b32 v116, v118
    v_permlane32_swap_b32 v117, v119
    v_mfma_f32_16x16x32_bf16 v[232:235], v[92:95], v[40:43], v[232:235]
    v_permlane32_swap_b32 v196, v198
    v_permlane32_swap_b32 v197, v199
    v_mfma_f32_16x16x32_bf16 v[236:239], v[92:95], v[44:47], v[236:239]
    buffer_store_dwordx4 v[116:119], v9, s[16:19], s76 offen sc1
    buffer_store_dwordx4 v[196:199], v9, s[16:19], s77 offen sc1
    v_mfma_f32_16x16x32_bf16 v[160:163], v[80:83], v[16:19], v[160:163]
    ds_read_b64_tr_b16 v[92:93], v7 offset:10528
    v_pk_mul_f32 v[144:145], v[144:145], s[42:43] op_sel_hi:[1,0]
    v_pk_mul_f32 v[146:147], v[146:147], s[42:43] op_sel_hi:[1,0]
    v_pk_mul_f32 v[148:149], v[148:149], s[42:43] op_sel_hi:[1,0]
    v_mfma_f32_16x16x32_bf16 v[164:167], v[80:83], v[20:23], v[164:167]
    ds_read_b64_tr_b16 v[94:95], v7 offset:11808
    v_pk_mul_f32 v[150:151], v[150:151], s[42:43] op_sel_hi:[1,0]
    v_cvt_pk_bf16_f32 v120, v144, v145
    v_cvt_pk_bf16_f32 v121, v146, v147
    v_mfma_f32_16x16x32_bf16 v[240:243], v[80:83], v[24:27], v[240:243]
    v_cvt_pk_bf16_f32 v122, v148, v149
    v_cvt_pk_bf16_f32 v123, v150, v151
    v_pk_mul_f32 v[224:225], v[224:225], s[42:43] op_sel_hi:[1,0]
    v_mfma_f32_16x16x32_bf16 v[244:247], v[80:83], v[28:31], v[244:247]
    v_pk_mul_f32 v[226:227], v[226:227], s[42:43] op_sel_hi:[1,0]
    v_pk_mul_f32 v[228:229], v[228:229], s[42:43] op_sel_hi:[1,0]
    v_pk_mul_f32 v[230:231], v[230:231], s[42:43] op_sel_hi:[1,0]
    s_waitcnt lgkmcnt(2)
    v_mfma_f32_16x16x32_bf16 v[160:163], v[88:91], v[32:35], v[160:163]
    v_cvt_pk_bf16_f32 v200, v224, v225
    v_cvt_pk_bf16_f32 v201, v226, v227
    v_cvt_pk_bf16_f32 v202, v228, v229
    v_mfma_f32_16x16x32_bf16 v[164:167], v[88:91], v[36:39], v[164:167]
    v_cvt_pk_bf16_f32 v203, v230, v231
    v_permlane32_swap_b32 v120, v122
    v_permlane32_swap_b32 v121, v123
    v_mfma_f32_16x16x32_bf16 v[240:243], v[88:91], v[40:43], v[240:243]
    v_permlane32_swap_b32 v200, v202
    v_permlane32_swap_b32 v201, v203
    buffer_store_dwordx2 v[120:121], v10, s[16:19], s76 offen offset:1024 sc1
    v_mfma_f32_16x16x32_bf16 v[244:247], v[88:91], v[44:47], v[244:247]
    s_add_u32 s76, s76, s33
    buffer_store_dwordx2 v[200:201], v10, s[16:19], s77 offen offset:1024 sc1
    s_add_u32 s77, s77, s33
    v_mfma_f32_16x16x32_bf16 v[168:171], v[84:87], v[16:19], v[168:171]
    v_pk_mul_f32 v[152:153], v[152:153], s[42:43] op_sel_hi:[1,0]
    v_pk_mul_f32 v[154:155], v[154:155], s[42:43] op_sel_hi:[1,0]
    v_pk_mul_f32 v[156:157], v[156:157], s[42:43] op_sel_hi:[1,0]
    v_mfma_f32_16x16x32_bf16 v[172:175], v[84:87], v[20:23], v[172:175]
    v_pk_mul_f32 v[158:159], v[158:159], s[42:43] op_sel_hi:[1,0]
    v_cvt_pk_bf16_f32 v124, v152, v153
    v_cvt_pk_bf16_f32 v125, v154, v155
    v_mfma_f32_16x16x32_bf16 v[248:251], v[84:87], v[24:27], v[248:251]
    v_cvt_pk_bf16_f32 v126, v156, v157
    v_cvt_pk_bf16_f32 v127, v158, v159
    v_pk_mul_f32 v[232:233], v[232:233], s[42:43] op_sel_hi:[1,0]
    v_mfma_f32_16x16x32_bf16 v[252:255], v[84:87], v[28:31], v[252:255]
    v_pk_mul_f32 v[234:235], v[234:235], s[42:43] op_sel_hi:[1,0]
    v_pk_mul_f32 v[236:237], v[236:237], s[42:43] op_sel_hi:[1,0]
    v_pk_mul_f32 v[238:239], v[238:239], s[42:43] op_sel_hi:[1,0]
    s_waitcnt lgkmcnt(0)
    v_mfma_f32_16x16x32_bf16 v[168:171], v[92:95], v[32:35], v[168:171]
    v_cvt_pk_bf16_f32 v204, v232, v233
    v_cvt_pk_bf16_f32 v205, v234, v235
    v_cvt_pk_bf16_f32 v206, v236, v237
    v_mfma_f32_16x16x32_bf16 v[172:175], v[92:95], v[36:39], v[172:175]
    v_cvt_pk_bf16_f32 v207, v238, v239
    v_permlane32_swap_b32 v124, v126
    v_permlane32_swap_b32 v125, v127
    v_mfma_f32_16x16x32_bf16 v[248:251], v[92:95], v[40:43], v[248:251]
    v_permlane32_swap_b32 v204, v206
    v_permlane32_swap_b32 v205, v207
    buffer_store_dwordx4 v[122:125], v9, s[16:19], s76 offen sc1
    v_mfma_f32_16x16x32_bf16 v[252:255], v[92:95], v[44:47], v[252:255]
    s_add_u32 s76, s76, s33
    buffer_store_dwordx4 v[202:205], v9, s[16:19], s77 offen sc1
    s_add_u32 s77, s77, s33
    v_pk_mul_f32 v[160:161], v[160:161], s[42:43] op_sel_hi:[1,0]
    v_pk_mul_f32 v[162:163], v[162:163], s[42:43] op_sel_hi:[1,0]
    v_pk_mul_f32 v[164:165], v[164:165], s[42:43] op_sel_hi:[1,0]
    v_pk_mul_f32 v[166:167], v[166:167], s[42:43] op_sel_hi:[1,0]
    v_cvt_pk_bf16_f32 v128, v160, v161
    v_cvt_pk_bf16_f32 v129, v162, v163
    v_cvt_pk_bf16_f32 v130, v164, v165
    v_cvt_pk_bf16_f32 v131, v166, v167
    v_pk_mul_f32 v[240:241], v[240:241], s[42:43] op_sel_hi:[1,0]
    v_pk_mul_f32 v[242:243], v[242:243], s[42:43] op_sel_hi:[1,0]
    v_pk_mul_f32 v[244:245], v[244:245], s[42:43] op_sel_hi:[1,0]
    v_pk_mul_f32 v[246:247], v[246:247], s[42:43] op_sel_hi:[1,0]
    v_cvt_pk_bf16_f32 v208, v240, v241
    v_cvt_pk_bf16_f32 v209, v242, v243
    v_cvt_pk_bf16_f32 v210, v244, v245
    v_cvt_pk_bf16_f32 v211, v246, v247
    v_permlane32_swap_b32 v128, v130
    v_permlane32_swap_b32 v129, v131
    v_permlane32_swap_b32 v208, v210
    v_permlane32_swap_b32 v209, v211
    buffer_store_dwordx4 v[126:129], v9, s[16:19], s76 offen sc1
    buffer_store_dwordx2 v[130:131], v10, s[16:19], s76 offen offset:1024 sc1
    s_add_u32 s76, s76, s33
    buffer_store_dwordx4 v[206:209], v9, s[16:19], s77 offen sc1
    buffer_store_dwordx2 v[210:211], v10, s[16:19], s77 offen offset:1024 sc1
    s_add_u32 s77, s77, s33
    v_pk_mul_f32 v[168:169], v[168:169], s[42:43] op_sel_hi:[1,0]
    v_pk_mul_f32 v[170:171], v[170:171], s[42:43] op_sel_hi:[1,0]
    v_pk_mul_f32 v[172:173], v[172:173], s[42:43] op_sel_hi:[1,0]
    v_pk_mul_f32 v[174:175], v[174:175], s[42:43] op_sel_hi:[1,0]
    v_cvt_pk_bf16_f32 v132, v168, v169
    v_cvt_pk_bf16_f32 v133, v170, v171
    v_cvt_pk_bf16_f32 v134, v172, v173
    v_cvt_pk_bf16_f32 v135, v174, v175
    v_pk_mul_f32 v[248:249], v[248:249], s[42:43] op_sel_hi:[1,0]
    v_pk_mul_f32 v[250:251], v[250:251], s[42:43] op_sel_hi:[1,0]
    v_pk_mul_f32 v[252:253], v[252:253], s[42:43] op_sel_hi:[1,0]
    v_pk_mul_f32 v[254:255], v[254:255], s[42:43] op_sel_hi:[1,0]
    v_cvt_pk_bf16_f32 v212, v248, v249
    v_cvt_pk_bf16_f32 v213, v250, v251
    v_cvt_pk_bf16_f32 v214, v252, v253
    v_cvt_pk_bf16_f32 v215, v254, v255
    v_permlane32_swap_b32 v132, v134
    v_permlane32_swap_b32 v133, v135
    v_permlane32_swap_b32 v212, v214
    v_permlane32_swap_b32 v213, v215
    buffer_store_dwordx4 v[132:135], v9, s[16:19], s76 offen sc1
    s_add_u32 s76, s76, s33
    buffer_store_dwordx4 v[212:215], v9, s[16:19], s77 offen sc1
    s_add_u32 s77, s77, s33
    s_branch L_gated_mix__softmax_full_mha__glu_gated_glu__prompt_qd_35
L_gated_mix__softmax_full_mha__glu_gated_glu__prompt_cv_34:
    s_movk_i32 s43, 2560
    s_mov_b32 s35, 4195584
    s_mov_b32 s38, 1
    s_mov_b32 s33, 163840
    s_mov_b32 s42, 163200
    v_and_b32 v1, 15, v0
    v_lshl_add_u32 v1, v2, 4, v1
    v_bfe_u32 v2, v0, 4, 1
    v_and_b32 v3, 3, v1
    v_lshlrev_b32 v3, 4, v3
    v_lshl_add_u32 v3, v2, 6, v3
    v_lshrrev_b32 v58, 2, v1
    v_add_u32 v56, 0, v58
    v_mul_u32_u24 v57, 205, v56
    v_lshrrev_b32 v57, 10, v57
    v_lshl_add_u32 v56, v56, 7, v3
    v_mad_u32_u24 v9, v57, s42, v56
    v_add_u32 v56, 8, v58
    v_mul_u32_u24 v57, 205, v56
    v_lshrrev_b32 v57, 10, v57
    v_lshl_add_u32 v56, v56, 7, v3
    v_mad_u32_u24 v10, v57, s42, v56
    v_add_u32 v56, 16, v58
    v_mul_u32_u24 v57, 205, v56
    v_lshrrev_b32 v57, 10, v57
    v_lshl_add_u32 v56, v56, 7, v3
    v_mad_u32_u24 v11, v57, s42, v56
    v_add_u32 v56, 24, v58
    v_mul_u32_u24 v57, 205, v56
    v_lshrrev_b32 v57, 10, v57
    v_lshl_add_u32 v56, v56, 7, v3
    v_mad_u32_u24 v13, v57, s42, v56
    v_add_u32 v56, 32, v58
    v_mul_u32_u24 v57, 205, v56
    v_lshrrev_b32 v57, 10, v57
    v_lshl_add_u32 v56, v56, 7, v3
    v_mad_u32_u24 v14, v57, s42, v56
    s_lshl_b32 s29, s29, 3
    s_mul_i32 s29, s29, s33
    s_add_u32 s35, s35, s29
    s_add_u32 s28, s34, 0
    s_sub_u32 s29, s28, s38
    s_and_b32 s29, s29, 31
    s_and_b32 s28, s28, 32
    s_or_b32 s28, s28, s29
    s_mul_i32 s28, s28, s43
    s_add_u32 s76, s28, s35
    s_add_u32 s28, s34, 1
    s_sub_u32 s29, s28, s38
    s_and_b32 s29, s29, 31
    s_and_b32 s28, s28, 32
    s_or_b32 s28, s28, s29
    s_mul_i32 s28, s28, s43
    s_add_u32 s77, s28, s35
    s_barrier
    s_waitcnt lgkmcnt(0)
    ds_read_b128 v[16:19], v4 offset:0
    ds_read_b128 v[20:23], v4 offset:2048
    ds_read_b128 v[24:27], v4 offset:4096
    ds_read_b128 v[28:31], v4 offset:6144
    ds_read_b64_tr_b16 v[48:49], v6 offset:0
    ds_read_b64_tr_b16 v[50:51], v6 offset:1280
    ds_read_b64_tr_b16 v[52:53], v7 offset:32
    ds_read_b64_tr_b16 v[54:55], v7 offset:1312
    ds_read_b64_tr_b16 v[56:57], v6 offset:64
    ds_read_b64_tr_b16 v[58:59], v6 offset:1344
    ds_read_b64_tr_b16 v[60:61], v7 offset:96
    ds_read_b64_tr_b16 v[62:63], v7 offset:1376
    ds_read_b64_tr_b16 v[64:65], v6 offset:128
    ds_read_b64_tr_b16 v[66:67], v6 offset:1408
    s_waitcnt lgkmcnt(6)
    ds_read_b64_tr_b16 v[68:69], v7 offset:160
    ds_read_b64_tr_b16 v[70:71], v7 offset:1440
    ds_read_b64_tr_b16 v[72:73], v6 offset:192
    ds_read_b64_tr_b16 v[74:75], v6 offset:1472
    ds_read_b64_tr_b16 v[76:77], v7 offset:224
    ds_read_b64_tr_b16 v[78:79], v7 offset:1504
    ds_read_b64_tr_b16 v[80:81], v6 offset:256
    ds_read_b64_tr_b16 v[82:83], v6 offset:1536
    ds_read_b64_tr_b16 v[84:85], v7 offset:288
    ds_read_b64_tr_b16 v[86:87], v7 offset:1568
    s_mov_b32 s21, 9
    s_mov_b32 s24, 0
    s_mov_b32 s25, 24576
    s_waitcnt lgkmcnt(0)
.p2align 6
L_gated_mix__softmax_full_mha__glu_gated_glu__prompt_ql_39:
    v_mfma_f32_16x16x32_bf16 v[96:99], v[16:19], v[48:51], v[96:99]
    ds_read_b128 v[32:35], v5 offset:0
    v_mfma_f32_16x16x32_bf16 v[136:139], v[20:23], v[48:51], v[136:139]
    ds_read_b128 v[36:39], v5 offset:2048
    v_mfma_f32_16x16x32_bf16 v[176:179], v[24:27], v[48:51], v[176:179]
    ds_read_b128 v[40:43], v5 offset:4096
    v_mfma_f32_16x16x32_bf16 v[216:219], v[28:31], v[48:51], v[216:219]
    ds_read_b128 v[44:47], v5 offset:6144
    v_mfma_f32_16x16x32_bf16 v[100:103], v[16:19], v[52:55], v[100:103]
    ds_read_b64_tr_b16 v[48:49], v6 offset:10240
    v_mfma_f32_16x16x32_bf16 v[140:143], v[20:23], v[52:55], v[140:143]
    ds_read_b64_tr_b16 v[50:51], v6 offset:11520
    v_mfma_f32_16x16x32_bf16 v[180:183], v[24:27], v[52:55], v[180:183]
    v_mfma_f32_16x16x32_bf16 v[220:223], v[28:31], v[52:55], v[220:223]
    ds_read_b64_tr_b16 v[52:53], v7 offset:10272
    v_mfma_f32_16x16x32_bf16 v[104:107], v[16:19], v[56:59], v[104:107]
    ds_read_b64_tr_b16 v[54:55], v7 offset:11552
    v_mfma_f32_16x16x32_bf16 v[144:147], v[20:23], v[56:59], v[144:147]
    v_mfma_f32_16x16x32_bf16 v[184:187], v[24:27], v[56:59], v[184:187]
    v_mfma_f32_16x16x32_bf16 v[224:227], v[28:31], v[56:59], v[224:227]
    ds_read_b64_tr_b16 v[56:57], v6 offset:10304
    v_mfma_f32_16x16x32_bf16 v[108:111], v[16:19], v[60:63], v[108:111]
    ds_read_b64_tr_b16 v[58:59], v6 offset:11584
    v_mfma_f32_16x16x32_bf16 v[148:151], v[20:23], v[60:63], v[148:151]
    v_mfma_f32_16x16x32_bf16 v[188:191], v[24:27], v[60:63], v[188:191]
    v_mfma_f32_16x16x32_bf16 v[228:231], v[28:31], v[60:63], v[228:231]
    ds_read_b64_tr_b16 v[60:61], v7 offset:10336
    v_mfma_f32_16x16x32_bf16 v[112:115], v[16:19], v[64:67], v[112:115]
    ds_read_b64_tr_b16 v[62:63], v7 offset:11616
    v_mfma_f32_16x16x32_bf16 v[152:155], v[20:23], v[64:67], v[152:155]
    v_mfma_f32_16x16x32_bf16 v[192:195], v[24:27], v[64:67], v[192:195]
    v_mfma_f32_16x16x32_bf16 v[232:235], v[28:31], v[64:67], v[232:235]
    ds_read_b64_tr_b16 v[64:65], v6 offset:10368
    v_mfma_f32_16x16x32_bf16 v[116:119], v[16:19], v[68:71], v[116:119]
    ds_read_b64_tr_b16 v[66:67], v6 offset:11648
    v_mfma_f32_16x16x32_bf16 v[156:159], v[20:23], v[68:71], v[156:159]
    v_mfma_f32_16x16x32_bf16 v[196:199], v[24:27], v[68:71], v[196:199]
    v_mfma_f32_16x16x32_bf16 v[236:239], v[28:31], v[68:71], v[236:239]
    ds_read_b64_tr_b16 v[68:69], v7 offset:10400
    v_mfma_f32_16x16x32_bf16 v[120:123], v[16:19], v[72:75], v[120:123]
    ds_read_b64_tr_b16 v[70:71], v7 offset:11680
    v_mfma_f32_16x16x32_bf16 v[160:163], v[20:23], v[72:75], v[160:163]
    v_mfma_f32_16x16x32_bf16 v[200:203], v[24:27], v[72:75], v[200:203]
    v_mfma_f32_16x16x32_bf16 v[240:243], v[28:31], v[72:75], v[240:243]
    ds_read_b64_tr_b16 v[72:73], v6 offset:10432
    s_waitcnt lgkmcnt(9)
    v_mfma_f32_16x16x32_bf16 v[124:127], v[16:19], v[76:79], v[124:127]
    ds_read_b64_tr_b16 v[74:75], v6 offset:11712
    v_mfma_f32_16x16x32_bf16 v[164:167], v[20:23], v[76:79], v[164:167]
    v_mfma_f32_16x16x32_bf16 v[204:207], v[24:27], v[76:79], v[204:207]
    v_mfma_f32_16x16x32_bf16 v[244:247], v[28:31], v[76:79], v[244:247]
    ds_read_b64_tr_b16 v[76:77], v7 offset:10464
    v_mfma_f32_16x16x32_bf16 v[128:131], v[16:19], v[80:83], v[128:131]
    ds_read_b64_tr_b16 v[78:79], v7 offset:11744
    v_mfma_f32_16x16x32_bf16 v[168:171], v[20:23], v[80:83], v[168:171]
    v_mfma_f32_16x16x32_bf16 v[208:211], v[24:27], v[80:83], v[208:211]
    v_mfma_f32_16x16x32_bf16 v[248:251], v[28:31], v[80:83], v[248:251]
    ds_read_b64_tr_b16 v[80:81], v6 offset:10496
    v_mfma_f32_16x16x32_bf16 v[132:135], v[16:19], v[84:87], v[132:135]
    ds_read_b64_tr_b16 v[82:83], v6 offset:11776
    v_mfma_f32_16x16x32_bf16 v[172:175], v[20:23], v[84:87], v[172:175]
    v_mfma_f32_16x16x32_bf16 v[212:215], v[24:27], v[84:87], v[212:215]
    v_mfma_f32_16x16x32_bf16 v[252:255], v[28:31], v[84:87], v[252:255]
    ds_read_b64_tr_b16 v[84:85], v7 offset:10528
    ds_read_b64_tr_b16 v[86:87], v7 offset:11808
    s_waitcnt lgkmcnt(6)
    v_mfma_f32_16x16x32_bf16 v[96:99], v[32:35], v[48:51], v[96:99]
    s_add_u32 s24, s24, 1
    s_cmp_eq_u32 s24, 3
    s_cselect_b32 s20, s30, s31
    v_mfma_f32_16x16x32_bf16 v[136:139], v[36:39], v[48:51], v[136:139]
    s_cselect_b32 s24, 0, s24
    s_sub_u32 s21, s21, 1
    v_mfma_f32_16x16x32_bf16 v[176:179], v[40:43], v[48:51], v[176:179]
    v_mfma_f32_16x16x32_bf16 v[216:219], v[44:47], v[48:51], v[216:219]
    v_mfma_f32_16x16x32_bf16 v[100:103], v[32:35], v[52:55], v[100:103]
    v_add_u32 v4, s20, v4
    v_mfma_f32_16x16x32_bf16 v[140:143], v[36:39], v[52:55], v[140:143]
    v_add_u32 v6, s25, v6
    v_mfma_f32_16x16x32_bf16 v[180:183], v[40:43], v[52:55], v[180:183]
    v_add_u32 v7, s25, v7
    v_mfma_f32_16x16x32_bf16 v[220:223], v[44:47], v[52:55], v[220:223]
    s_sub_u32 s25, 0, s25
    v_mfma_f32_16x16x32_bf16 v[104:107], v[32:35], v[56:59], v[104:107]
    s_waitcnt lgkmcnt(0)
    s_barrier
    ds_read_b64_tr_b16 v[48:49], v6 offset:0
    v_mfma_f32_16x16x32_bf16 v[144:147], v[36:39], v[56:59], v[144:147]
    ds_read_b64_tr_b16 v[50:51], v6 offset:1280
    v_mfma_f32_16x16x32_bf16 v[184:187], v[40:43], v[56:59], v[184:187]
    ds_read_b64_tr_b16 v[52:53], v7 offset:32
    v_mfma_f32_16x16x32_bf16 v[224:227], v[44:47], v[56:59], v[224:227]
    ds_read_b64_tr_b16 v[54:55], v7 offset:1312
    v_mfma_f32_16x16x32_bf16 v[108:111], v[32:35], v[60:63], v[108:111]
    ds_read_b128 v[16:19], v4 offset:0
    v_mfma_f32_16x16x32_bf16 v[148:151], v[36:39], v[60:63], v[148:151]
    ds_read_b128 v[20:23], v4 offset:2048
    v_mfma_f32_16x16x32_bf16 v[188:191], v[40:43], v[60:63], v[188:191]
    ds_read_b128 v[24:27], v4 offset:4096
    v_mfma_f32_16x16x32_bf16 v[228:231], v[44:47], v[60:63], v[228:231]
    ds_read_b128 v[28:31], v4 offset:6144
    v_mfma_f32_16x16x32_bf16 v[112:115], v[32:35], v[64:67], v[112:115]
    ds_read_b64_tr_b16 v[56:57], v6 offset:64
    v_mfma_f32_16x16x32_bf16 v[152:155], v[36:39], v[64:67], v[152:155]
    ds_read_b64_tr_b16 v[58:59], v6 offset:1344
    v_mfma_f32_16x16x32_bf16 v[192:195], v[40:43], v[64:67], v[192:195]
    ds_read_b64_tr_b16 v[60:61], v7 offset:96
    v_mfma_f32_16x16x32_bf16 v[232:235], v[44:47], v[64:67], v[232:235]
    ds_read_b64_tr_b16 v[62:63], v7 offset:1376
    v_mfma_f32_16x16x32_bf16 v[116:119], v[32:35], v[68:71], v[116:119]
    ds_read_b64_tr_b16 v[64:65], v6 offset:128
    v_mfma_f32_16x16x32_bf16 v[156:159], v[36:39], v[68:71], v[156:159]
    ds_read_b64_tr_b16 v[66:67], v6 offset:1408
    v_mfma_f32_16x16x32_bf16 v[196:199], v[40:43], v[68:71], v[196:199]
    v_mfma_f32_16x16x32_bf16 v[236:239], v[44:47], v[68:71], v[236:239]
    ds_read_b64_tr_b16 v[68:69], v7 offset:160
    v_mfma_f32_16x16x32_bf16 v[120:123], v[32:35], v[72:75], v[120:123]
    ds_read_b64_tr_b16 v[70:71], v7 offset:1440
    v_mfma_f32_16x16x32_bf16 v[160:163], v[36:39], v[72:75], v[160:163]
    v_mfma_f32_16x16x32_bf16 v[200:203], v[40:43], v[72:75], v[200:203]
    v_mfma_f32_16x16x32_bf16 v[240:243], v[44:47], v[72:75], v[240:243]
    ds_read_b64_tr_b16 v[72:73], v6 offset:192
    s_waitcnt lgkmcnt(13)
    v_mfma_f32_16x16x32_bf16 v[124:127], v[32:35], v[76:79], v[124:127]
    ds_read_b64_tr_b16 v[74:75], v6 offset:1472
    v_mfma_f32_16x16x32_bf16 v[164:167], v[36:39], v[76:79], v[164:167]
    v_mfma_f32_16x16x32_bf16 v[204:207], v[40:43], v[76:79], v[204:207]
    v_mfma_f32_16x16x32_bf16 v[244:247], v[44:47], v[76:79], v[244:247]
    ds_read_b64_tr_b16 v[76:77], v7 offset:224
    v_mfma_f32_16x16x32_bf16 v[128:131], v[32:35], v[80:83], v[128:131]
    ds_read_b64_tr_b16 v[78:79], v7 offset:1504
    v_mfma_f32_16x16x32_bf16 v[168:171], v[36:39], v[80:83], v[168:171]
    v_mfma_f32_16x16x32_bf16 v[208:211], v[40:43], v[80:83], v[208:211]
    v_mfma_f32_16x16x32_bf16 v[248:251], v[44:47], v[80:83], v[248:251]
    ds_read_b64_tr_b16 v[80:81], v6 offset:256
    v_mfma_f32_16x16x32_bf16 v[132:135], v[32:35], v[84:87], v[132:135]
    v_add_u32 v5, s20, v5
    ds_read_b64_tr_b16 v[82:83], v6 offset:1536
    v_mfma_f32_16x16x32_bf16 v[172:175], v[36:39], v[84:87], v[172:175]
    v_mfma_f32_16x16x32_bf16 v[212:215], v[40:43], v[84:87], v[212:215]
    v_mfma_f32_16x16x32_bf16 v[252:255], v[44:47], v[84:87], v[252:255]
    ds_read_b64_tr_b16 v[84:85], v7 offset:288
    ds_read_b64_tr_b16 v[86:87], v7 offset:1568
    s_waitcnt lgkmcnt(6)
    s_cmp_lg_u32 s21, 0
    s_cbranch_scc1 L_gated_mix__softmax_full_mha__glu_gated_glu__prompt_ql_39
    ds_read_b128 v[32:35], v5 offset:0
    ds_read_b128 v[36:39], v5 offset:2048
    ds_read_b128 v[40:43], v5 offset:4096
    ds_read_b128 v[44:47], v5 offset:6144
    ds_read_b64_tr_b16 v[88:89], v6 offset:10240
    ds_read_b64_tr_b16 v[90:91], v6 offset:11520
    v_mfma_f32_16x16x32_bf16 v[96:99], v[16:19], v[48:51], v[96:99]
    ds_read_b64_tr_b16 v[92:93], v7 offset:10272
    v_mfma_f32_16x16x32_bf16 v[136:139], v[20:23], v[48:51], v[136:139]
    ds_read_b64_tr_b16 v[94:95], v7 offset:11552
    v_mfma_f32_16x16x32_bf16 v[176:179], v[24:27], v[48:51], v[176:179]
    v_mfma_f32_16x16x32_bf16 v[216:219], v[28:31], v[48:51], v[216:219]
    s_waitcnt lgkmcnt(2)
    v_mfma_f32_16x16x32_bf16 v[96:99], v[32:35], v[88:91], v[96:99]
    v_mfma_f32_16x16x32_bf16 v[136:139], v[36:39], v[88:91], v[136:139]
    v_mfma_f32_16x16x32_bf16 v[176:179], v[40:43], v[88:91], v[176:179]
    v_mfma_f32_16x16x32_bf16 v[216:219], v[44:47], v[88:91], v[216:219]
    v_mfma_f32_16x16x32_bf16 v[100:103], v[16:19], v[52:55], v[100:103]
    ds_read_b64_tr_b16 v[88:89], v6 offset:10304
    v_mfma_f32_16x16x32_bf16 v[140:143], v[20:23], v[52:55], v[140:143]
    ds_read_b64_tr_b16 v[90:91], v6 offset:11584
    v_mfma_f32_16x16x32_bf16 v[180:183], v[24:27], v[52:55], v[180:183]
    v_mfma_f32_16x16x32_bf16 v[220:223], v[28:31], v[52:55], v[220:223]
    s_waitcnt lgkmcnt(2)
    v_mfma_f32_16x16x32_bf16 v[100:103], v[32:35], v[92:95], v[100:103]
    v_mfma_f32_16x16x32_bf16 v[140:143], v[36:39], v[92:95], v[140:143]
    v_mfma_f32_16x16x32_bf16 v[180:183], v[40:43], v[92:95], v[180:183]
    v_mfma_f32_16x16x32_bf16 v[220:223], v[44:47], v[92:95], v[220:223]
    v_mfma_f32_16x16x32_bf16 v[104:107], v[16:19], v[56:59], v[104:107]
    ds_read_b64_tr_b16 v[92:93], v7 offset:10336
    v_mfma_f32_16x16x32_bf16 v[144:147], v[20:23], v[56:59], v[144:147]
    ds_read_b64_tr_b16 v[94:95], v7 offset:11616
    v_mfma_f32_16x16x32_bf16 v[184:187], v[24:27], v[56:59], v[184:187]
    v_mfma_f32_16x16x32_bf16 v[224:227], v[28:31], v[56:59], v[224:227]
    s_waitcnt lgkmcnt(2)
    v_mfma_f32_16x16x32_bf16 v[104:107], v[32:35], v[88:91], v[104:107]
    v_mfma_f32_16x16x32_bf16 v[144:147], v[36:39], v[88:91], v[144:147]
    v_mfma_f32_16x16x32_bf16 v[184:187], v[40:43], v[88:91], v[184:187]
    v_mfma_f32_16x16x32_bf16 v[224:227], v[44:47], v[88:91], v[224:227]
    v_mfma_f32_16x16x32_bf16 v[108:111], v[16:19], v[60:63], v[108:111]
    ds_read_b64_tr_b16 v[88:89], v6 offset:10368
    v_cvt_pk_bf16_f32 v96, v96, v97
    v_cvt_pk_bf16_f32 v97, v98, v99
    v_cvt_pk_bf16_f32 v98, v100, v101
    v_cvt_pk_bf16_f32 v99, v102, v103
    v_mfma_f32_16x16x32_bf16 v[148:151], v[20:23], v[60:63], v[148:151]
    ds_read_b64_tr_b16 v[90:91], v6 offset:11648
    v_cvt_pk_bf16_f32 v136, v136, v137
    v_cvt_pk_bf16_f32 v137, v138, v139
    v_cvt_pk_bf16_f32 v138, v140, v141
    v_cvt_pk_bf16_f32 v139, v142, v143
    v_mfma_f32_16x16x32_bf16 v[188:191], v[24:27], v[60:63], v[188:191]
    v_permlane32_swap_b32 v96, v98
    v_permlane32_swap_b32 v97, v99
    buffer_store_dwordx4 v[96:99], v9, s[16:19], s76 offen offset:0 sc1
    v_cvt_pk_bf16_f32 v176, v176, v177
    v_mfma_f32_16x16x32_bf16 v[228:231], v[28:31], v[60:63], v[228:231]
    v_cvt_pk_bf16_f32 v177, v178, v179
    v_cvt_pk_bf16_f32 v178, v180, v181
    v_cvt_pk_bf16_f32 v179, v182, v183
    v_permlane32_swap_b32 v136, v138
    s_waitcnt lgkmcnt(2)
    v_mfma_f32_16x16x32_bf16 v[108:111], v[32:35], v[92:95], v[108:111]
    v_permlane32_swap_b32 v137, v139
    buffer_store_dwordx4 v[136:139], v9, s[16:19], s76 offen offset:640 sc1
    v_cvt_pk_bf16_f32 v216, v216, v217
    v_cvt_pk_bf16_f32 v217, v218, v219
    v_mfma_f32_16x16x32_bf16 v[148:151], v[36:39], v[92:95], v[148:151]
    v_cvt_pk_bf16_f32 v218, v220, v221
    v_cvt_pk_bf16_f32 v219, v222, v223
    v_permlane32_swap_b32 v176, v178
    v_mfma_f32_16x16x32_bf16 v[188:191], v[40:43], v[92:95], v[188:191]
    v_permlane32_swap_b32 v177, v179
    buffer_store_dwordx4 v[176:179], v9, s[16:19], s77 offen offset:0 sc1
    s_nop 0
    v_mfma_f32_16x16x32_bf16 v[228:231], v[44:47], v[92:95], v[228:231]
    v_permlane32_swap_b32 v216, v218
    v_permlane32_swap_b32 v217, v219
    buffer_store_dwordx4 v[216:219], v9, s[16:19], s77 offen offset:640 sc1
    v_mfma_f32_16x16x32_bf16 v[112:115], v[16:19], v[64:67], v[112:115]
    ds_read_b64_tr_b16 v[92:93], v7 offset:10400
    v_mfma_f32_16x16x32_bf16 v[152:155], v[20:23], v[64:67], v[152:155]
    ds_read_b64_tr_b16 v[94:95], v7 offset:11680
    v_mfma_f32_16x16x32_bf16 v[192:195], v[24:27], v[64:67], v[192:195]
    v_mfma_f32_16x16x32_bf16 v[232:235], v[28:31], v[64:67], v[232:235]
    s_waitcnt lgkmcnt(2)
    v_mfma_f32_16x16x32_bf16 v[112:115], v[32:35], v[88:91], v[112:115]
    v_mfma_f32_16x16x32_bf16 v[152:155], v[36:39], v[88:91], v[152:155]
    v_mfma_f32_16x16x32_bf16 v[192:195], v[40:43], v[88:91], v[192:195]
    v_mfma_f32_16x16x32_bf16 v[232:235], v[44:47], v[88:91], v[232:235]
    v_mfma_f32_16x16x32_bf16 v[116:119], v[16:19], v[68:71], v[116:119]
    ds_read_b64_tr_b16 v[88:89], v6 offset:10432
    v_cvt_pk_bf16_f32 v104, v104, v105
    v_cvt_pk_bf16_f32 v105, v106, v107
    v_cvt_pk_bf16_f32 v106, v108, v109
    v_cvt_pk_bf16_f32 v107, v110, v111
    v_mfma_f32_16x16x32_bf16 v[156:159], v[20:23], v[68:71], v[156:159]
    ds_read_b64_tr_b16 v[90:91], v6 offset:11712
    v_cvt_pk_bf16_f32 v144, v144, v145
    v_cvt_pk_bf16_f32 v145, v146, v147
    v_cvt_pk_bf16_f32 v146, v148, v149
    v_cvt_pk_bf16_f32 v147, v150, v151
    v_mfma_f32_16x16x32_bf16 v[196:199], v[24:27], v[68:71], v[196:199]
    v_permlane32_swap_b32 v104, v106
    v_permlane32_swap_b32 v105, v107
    buffer_store_dwordx4 v[104:107], v10, s[16:19], s76 offen offset:0 sc1
    v_cvt_pk_bf16_f32 v184, v184, v185
    v_mfma_f32_16x16x32_bf16 v[236:239], v[28:31], v[68:71], v[236:239]
    v_cvt_pk_bf16_f32 v185, v186, v187
    v_cvt_pk_bf16_f32 v186, v188, v189
    v_cvt_pk_bf16_f32 v187, v190, v191
    v_permlane32_swap_b32 v144, v146
    s_waitcnt lgkmcnt(2)
    v_mfma_f32_16x16x32_bf16 v[116:119], v[32:35], v[92:95], v[116:119]
    v_permlane32_swap_b32 v145, v147
    buffer_store_dwordx4 v[144:147], v10, s[16:19], s76 offen offset:640 sc1
    v_cvt_pk_bf16_f32 v224, v224, v225
    v_cvt_pk_bf16_f32 v225, v226, v227
    v_mfma_f32_16x16x32_bf16 v[156:159], v[36:39], v[92:95], v[156:159]
    v_cvt_pk_bf16_f32 v226, v228, v229
    v_cvt_pk_bf16_f32 v227, v230, v231
    v_permlane32_swap_b32 v184, v186
    v_mfma_f32_16x16x32_bf16 v[196:199], v[40:43], v[92:95], v[196:199]
    v_permlane32_swap_b32 v185, v187
    buffer_store_dwordx4 v[184:187], v10, s[16:19], s77 offen offset:0 sc1
    s_nop 0
    v_mfma_f32_16x16x32_bf16 v[236:239], v[44:47], v[92:95], v[236:239]
    v_permlane32_swap_b32 v224, v226
    v_permlane32_swap_b32 v225, v227
    buffer_store_dwordx4 v[224:227], v10, s[16:19], s77 offen offset:640 sc1
    v_mfma_f32_16x16x32_bf16 v[120:123], v[16:19], v[72:75], v[120:123]
    ds_read_b64_tr_b16 v[92:93], v7 offset:10464
    v_mfma_f32_16x16x32_bf16 v[160:163], v[20:23], v[72:75], v[160:163]
    ds_read_b64_tr_b16 v[94:95], v7 offset:11744
    v_mfma_f32_16x16x32_bf16 v[200:203], v[24:27], v[72:75], v[200:203]
    v_mfma_f32_16x16x32_bf16 v[240:243], v[28:31], v[72:75], v[240:243]
    s_waitcnt lgkmcnt(2)
    v_mfma_f32_16x16x32_bf16 v[120:123], v[32:35], v[88:91], v[120:123]
    v_mfma_f32_16x16x32_bf16 v[160:163], v[36:39], v[88:91], v[160:163]
    v_mfma_f32_16x16x32_bf16 v[200:203], v[40:43], v[88:91], v[200:203]
    v_mfma_f32_16x16x32_bf16 v[240:243], v[44:47], v[88:91], v[240:243]
    v_mfma_f32_16x16x32_bf16 v[124:127], v[16:19], v[76:79], v[124:127]
    ds_read_b64_tr_b16 v[88:89], v6 offset:10496
    v_cvt_pk_bf16_f32 v112, v112, v113
    v_cvt_pk_bf16_f32 v113, v114, v115
    v_cvt_pk_bf16_f32 v114, v116, v117
    v_cvt_pk_bf16_f32 v115, v118, v119
    v_mfma_f32_16x16x32_bf16 v[164:167], v[20:23], v[76:79], v[164:167]
    ds_read_b64_tr_b16 v[90:91], v6 offset:11776
    v_cvt_pk_bf16_f32 v152, v152, v153
    v_cvt_pk_bf16_f32 v153, v154, v155
    v_cvt_pk_bf16_f32 v154, v156, v157
    v_cvt_pk_bf16_f32 v155, v158, v159
    v_mfma_f32_16x16x32_bf16 v[204:207], v[24:27], v[76:79], v[204:207]
    v_permlane32_swap_b32 v112, v114
    v_permlane32_swap_b32 v113, v115
    buffer_store_dwordx4 v[112:115], v11, s[16:19], s76 offen offset:0 sc1
    v_cvt_pk_bf16_f32 v192, v192, v193
    v_mfma_f32_16x16x32_bf16 v[244:247], v[28:31], v[76:79], v[244:247]
    v_cvt_pk_bf16_f32 v193, v194, v195
    v_cvt_pk_bf16_f32 v194, v196, v197
    v_cvt_pk_bf16_f32 v195, v198, v199
    v_permlane32_swap_b32 v152, v154
    s_waitcnt lgkmcnt(2)
    v_mfma_f32_16x16x32_bf16 v[124:127], v[32:35], v[92:95], v[124:127]
    v_permlane32_swap_b32 v153, v155
    buffer_store_dwordx4 v[152:155], v11, s[16:19], s76 offen offset:640 sc1
    v_cvt_pk_bf16_f32 v232, v232, v233
    v_cvt_pk_bf16_f32 v233, v234, v235
    v_mfma_f32_16x16x32_bf16 v[164:167], v[36:39], v[92:95], v[164:167]
    v_cvt_pk_bf16_f32 v234, v236, v237
    v_cvt_pk_bf16_f32 v235, v238, v239
    v_permlane32_swap_b32 v192, v194
    v_mfma_f32_16x16x32_bf16 v[204:207], v[40:43], v[92:95], v[204:207]
    v_permlane32_swap_b32 v193, v195
    buffer_store_dwordx4 v[192:195], v11, s[16:19], s77 offen offset:0 sc1
    s_nop 0
    v_mfma_f32_16x16x32_bf16 v[244:247], v[44:47], v[92:95], v[244:247]
    v_permlane32_swap_b32 v232, v234
    v_permlane32_swap_b32 v233, v235
    buffer_store_dwordx4 v[232:235], v11, s[16:19], s77 offen offset:640 sc1
    v_mfma_f32_16x16x32_bf16 v[128:131], v[16:19], v[80:83], v[128:131]
    ds_read_b64_tr_b16 v[92:93], v7 offset:10528
    v_mfma_f32_16x16x32_bf16 v[168:171], v[20:23], v[80:83], v[168:171]
    ds_read_b64_tr_b16 v[94:95], v7 offset:11808
    v_mfma_f32_16x16x32_bf16 v[208:211], v[24:27], v[80:83], v[208:211]
    v_mfma_f32_16x16x32_bf16 v[248:251], v[28:31], v[80:83], v[248:251]
    s_waitcnt lgkmcnt(2)
    v_mfma_f32_16x16x32_bf16 v[128:131], v[32:35], v[88:91], v[128:131]
    v_mfma_f32_16x16x32_bf16 v[168:171], v[36:39], v[88:91], v[168:171]
    v_mfma_f32_16x16x32_bf16 v[208:211], v[40:43], v[88:91], v[208:211]
    v_mfma_f32_16x16x32_bf16 v[248:251], v[44:47], v[88:91], v[248:251]
    v_mfma_f32_16x16x32_bf16 v[132:135], v[16:19], v[84:87], v[132:135]
    v_cvt_pk_bf16_f32 v120, v120, v121
    v_cvt_pk_bf16_f32 v121, v122, v123
    v_cvt_pk_bf16_f32 v122, v124, v125
    v_cvt_pk_bf16_f32 v123, v126, v127
    v_mfma_f32_16x16x32_bf16 v[172:175], v[20:23], v[84:87], v[172:175]
    v_cvt_pk_bf16_f32 v160, v160, v161
    v_cvt_pk_bf16_f32 v161, v162, v163
    v_cvt_pk_bf16_f32 v162, v164, v165
    v_cvt_pk_bf16_f32 v163, v166, v167
    v_mfma_f32_16x16x32_bf16 v[212:215], v[24:27], v[84:87], v[212:215]
    v_permlane32_swap_b32 v120, v122
    v_permlane32_swap_b32 v121, v123
    buffer_store_dwordx4 v[120:123], v13, s[16:19], s76 offen offset:0 sc1
    v_cvt_pk_bf16_f32 v200, v200, v201
    v_mfma_f32_16x16x32_bf16 v[252:255], v[28:31], v[84:87], v[252:255]
    v_cvt_pk_bf16_f32 v201, v202, v203
    v_cvt_pk_bf16_f32 v202, v204, v205
    v_cvt_pk_bf16_f32 v203, v206, v207
    v_permlane32_swap_b32 v160, v162
    s_waitcnt lgkmcnt(0)
    v_mfma_f32_16x16x32_bf16 v[132:135], v[32:35], v[92:95], v[132:135]
    v_permlane32_swap_b32 v161, v163
    buffer_store_dwordx4 v[160:163], v13, s[16:19], s76 offen offset:640 sc1
    v_cvt_pk_bf16_f32 v240, v240, v241
    v_cvt_pk_bf16_f32 v241, v242, v243
    v_mfma_f32_16x16x32_bf16 v[172:175], v[36:39], v[92:95], v[172:175]
    v_cvt_pk_bf16_f32 v242, v244, v245
    v_cvt_pk_bf16_f32 v243, v246, v247
    v_permlane32_swap_b32 v200, v202
    v_mfma_f32_16x16x32_bf16 v[212:215], v[40:43], v[92:95], v[212:215]
    v_permlane32_swap_b32 v201, v203
    buffer_store_dwordx4 v[200:203], v13, s[16:19], s77 offen offset:0 sc1
    s_nop 0
    v_mfma_f32_16x16x32_bf16 v[252:255], v[44:47], v[92:95], v[252:255]
    v_permlane32_swap_b32 v240, v242
    v_permlane32_swap_b32 v241, v243
    buffer_store_dwordx4 v[240:243], v13, s[16:19], s77 offen offset:640 sc1
    s_nop 7
    v_cvt_pk_bf16_f32 v128, v128, v129
    v_cvt_pk_bf16_f32 v129, v130, v131
    v_cvt_pk_bf16_f32 v130, v132, v133
    v_cvt_pk_bf16_f32 v131, v134, v135
    v_cvt_pk_bf16_f32 v168, v168, v169
    v_cvt_pk_bf16_f32 v169, v170, v171
    v_cvt_pk_bf16_f32 v170, v172, v173
    v_cvt_pk_bf16_f32 v171, v174, v175
    v_permlane32_swap_b32 v128, v130
    v_permlane32_swap_b32 v129, v131
    buffer_store_dwordx4 v[128:131], v14, s[16:19], s76 offen offset:0 sc1
    v_cvt_pk_bf16_f32 v208, v208, v209
    v_cvt_pk_bf16_f32 v209, v210, v211
    v_cvt_pk_bf16_f32 v210, v212, v213
    v_cvt_pk_bf16_f32 v211, v214, v215
    v_permlane32_swap_b32 v168, v170
    v_permlane32_swap_b32 v169, v171
    buffer_store_dwordx4 v[168:171], v14, s[16:19], s76 offen offset:640 sc1
    v_cvt_pk_bf16_f32 v248, v248, v249
    v_cvt_pk_bf16_f32 v249, v250, v251
    v_cvt_pk_bf16_f32 v250, v252, v253
    v_cvt_pk_bf16_f32 v251, v254, v255
    v_permlane32_swap_b32 v208, v210
    v_permlane32_swap_b32 v209, v211
    buffer_store_dwordx4 v[208:211], v14, s[16:19], s77 offen offset:0 sc1
    s_nop 0
    v_permlane32_swap_b32 v248, v250
    v_permlane32_swap_b32 v249, v251
    buffer_store_dwordx4 v[248:251], v14, s[16:19], s77 offen offset:640 sc1
    s_branch L_gated_mix__softmax_full_mha__glu_gated_glu__prompt_qd_35
L_gated_mix__softmax_full_mha__glu_gated_glu__prompt_cg_36:
    s_lshl_b32 s23, s3, 13
    v_bfe_u32 v3, v1, 1, 3
    v_xor_b32 v3, v3, v2
    v_lshl_add_u32 v56, v1, 7, s23
    v_xor_b32 v57, 0, v3
    v_lshl_add_u32 v4, v57, 4, v56
    v_xor_b32 v57, 2, v3
    v_lshl_add_u32 v5, v57, 4, v56
    v_xor_b32 v57, 4, v3
    v_lshl_add_u32 v6, v57, 4, v56
    v_xor_b32 v57, 6, v3
    v_lshl_add_u32 v7, v57, 4, v56
    s_mov_b32 s12, s50
    s_mov_b32 s13, s51
    s_mov_b32 s14, 1280
    s_mov_b32 m0, 147584
    v_lshlrev_b32 v3, 4, v0
    v_lshlrev_b32 v8, 4, v2
    v_add_u32 v8, 147584, v8
    buffer_load_dwordx4 v3, s[12:15], 0 offen lds
    buffer_load_dwordx4 v3, s[12:15], 0 offen offset:1024 lds
    s_mov_b32 s21, 10
    s_mov_b32 s24, 0
    s_waitcnt vmcnt(0) lgkmcnt(0)
    s_barrier
L_gated_mix__softmax_full_mha__glu_gated_glu__prompt_gg_40:
    ds_read_b128 v[16:19], v4
    ds_read_b128 v[20:23], v4 offset:4096
    ds_read_b128 v[24:27], v8 offset:0
    ds_read_b128 v[28:31], v5
    ds_read_b128 v[32:35], v5 offset:4096
    ds_read_b128 v[36:39], v8 offset:32
    ds_read_b128 v[40:43], v6
    ds_read_b128 v[44:47], v6 offset:4096
    ds_read_b128 v[48:51], v8 offset:64
    ds_read_b128 v[52:55], v7
    ds_read_b128 v[56:59], v7 offset:4096
    ds_read_b128 v[60:63], v8 offset:96
    s_add_u32 s24, s24, 1
    s_cmp_eq_u32 s24, 3
    s_cselect_b32 s20, s30, s31
    s_cselect_b32 s24, 0, s24
    s_sub_u32 s21, s21, 1
    s_waitcnt lgkmcnt(0)
    s_cmp_eq_u32 s21, 0
    s_cbranch_scc1 L_gated_mix__softmax_full_mha__glu_gated_glu__prompt_nb_41
    s_barrier
L_gated_mix__softmax_full_mha__glu_gated_glu__prompt_nb_41:
    v_mfma_f32_32x32x16_bf16 v[64:79], v[24:27], v[16:19], v[64:79]
    v_mfma_f32_32x32x16_bf16 v[80:95], v[24:27], v[20:23], v[80:95]
    v_add_u32 v4, s20, v4
    v_mfma_f32_32x32x16_bf16 v[64:79], v[36:39], v[28:31], v[64:79]
    v_mfma_f32_32x32x16_bf16 v[80:95], v[36:39], v[32:35], v[80:95]
    v_add_u32 v5, s20, v5
    v_mfma_f32_32x32x16_bf16 v[64:79], v[48:51], v[40:43], v[64:79]
    v_mfma_f32_32x32x16_bf16 v[80:95], v[48:51], v[44:47], v[80:95]
    v_add_u32 v6, s20, v6
    v_mfma_f32_32x32x16_bf16 v[64:79], v[60:63], v[52:55], v[64:79]
    v_mfma_f32_32x32x16_bf16 v[80:95], v[60:63], v[56:59], v[80:95]
    v_add_u32 v7, s20, v7
    v_add_u32 v8, 128, v8
    s_cmp_lg_u32 s21, 0
    s_cbranch_scc1 L_gated_mix__softmax_full_mha__glu_gated_glu__prompt_gg_40
    s_mov_b32 s32, 0xbfb8aa3b
    s_lshl_b32 s28, s34, 7
    s_add_u32 s28, s28, 22020096
    v_lshlrev_b32 v3, 2, v1
    s_nop 7
    v_mul_f32 v64, s32, v64
    v_exp_f32 v64, v64
    s_nop 0
    v_add_f32 v64, 1.0, v64
    v_rcp_f32 v64, v64
    s_nop 0
    buffer_store_dword v64, v3, s[16:19], s28 offen offset:0 sc1
    v_mul_f32 v80, s32, v80
    v_exp_f32 v80, v80
    s_nop 0
    v_add_f32 v80, 1.0, v80
    v_rcp_f32 v80, v80
    s_nop 0
    buffer_store_dword v80, v3, s[16:19], s28 offen offset:128 sc1
L_gated_mix__softmax_full_mha__glu_gated_glu__prompt_qd_35:
    s_waitcnt vmcnt(0)
    s_barrier
L_cfin:
    v_and_b32 v1, 31, v0
    v_lshrrev_b32 v2, 5, v0
    v_lshlrev_b32 v8, 4, v0
    s_mul_i32 s23, s7, 10432
    s_add_u32 s23, s23, 32768
    s_add_u32 s22, s23, 2576
    v_add_u32 v4, s23, v8
    s_add_u32 s31, s23, 1024
    v_lshl_add_u32 v5, v1, 3, s31
    v_cmp_eq_u32 vcc, 0, v2
    v_mov_b32 v3, s22
    s_add_u32 s31, s23, 1280
    v_and_b32 v12, 3, v1
    v_cndmask_b32 v5, v3, v5, vcc
    v_lshl_add_u32 v12, v12, 4, s31
    v_lshl_add_u32 v12, v2, 6, v12
    v_lshrrev_b32 v13, 2, v1
    v_lshl_add_u32 v6, v13, 7, v12
    v_cmp_lt_u32 vcc, 20, v1
    v_subrev_u32 v12, 16, v3
    v_add_u32 v13, 16, v3
    v_cndmask_b32 v3, v12, v13, vcc
    v_cmp_gt_u32 vcc, 20, v1
    v_add_u32 v7, 640, v6
    v_mov_b32 v9, 0xdddddddd
    v_cndmask_b32 v6, v3, v6, vcc
    v_cndmask_b32 v7, v3, v7, vcc
    v_lshlrev_b32 v12, 3, v0
    v_mov_b32 v24, 0
    v_mov_b32 v25, 0
    v_mov_b32 v26, 0
    v_mov_b32 v27, 0
    s_barrier
    buffer_load_dwordx4 v[16:19], v8, s[16:19], s71 offen offset:0 sc1
    buffer_load_dwordx4 v[20:23], v8, s[16:19], s71 offen offset:1280 sc1
    s_mov_b64 exec, s[64:65]
    buffer_load_dwordx2 v[24:25], v12, s[16:19], s71 offen offset:1024 sc1
    buffer_load_dwordx2 v[26:27], v12, s[16:19], s71 offen offset:2304 sc1
    s_mov_b64 exec, -1
    s_mov_b32 m0, s72
    s_nop 0
    global_load_lds_dwordx4 v8, s[74:75] sc1
    global_load_lds_dwordx4 v8, s[74:75] offset:1024 sc1
    s_mov_b64 exec, s[64:65]
    global_load_lds_dwordx4 v8, s[74:75] offset:2048 sc1
    s_mov_b64 exec, -1
    v_lshlrev_b32 v14, 7, v0
    s_lshl_b32 s32, s62, 5
    s_add_u32 s32, s32, s61
    s_lshl_b32 s32, s32, 7
    s_add_u32 s32, s32, 26214400
    s_add_u32 s34, s5, s7
    s_lshl_b32 s34, s34, 7
    s_add_u32 s34, s34, 22020096
    s_and_b32 s35, s26, -2
    s_lshl_b32 s35, s35, 7
    s_add_u32 s35, s35, 22020096
    s_lshr_b32 s33, s26, 3
    s_lshl_b32 s33, s33, 12
    s_add_u32 s33, s33, 26214400
    s_mov_b32 s8, s52
    s_mov_b32 s9, s53
    s_mul_i32 s31, s6, 14
    s_mul_i32 s22, s6, 13
    s_add_u32 s22, s22, 56
    s_cmp_eq_u32 s7, 0
    s_cselect_b32 s31, s31, s22
    s_add_u32 s31, s31, 4
    s_min_u32 s22, s78, s79
    s_lshr_b32 s22, s22, 2
    s_mul_i32 s22, s22, 4736
    s_add_u32 s22, s22, 26244864
    v_cmp_gt_u32 vcc, 18, v0
    v_add_u32 v168, s22, v14
    v_add_u32 v160, s33, v14
    v_cndmask_b32 v168, v168, v160, vcc
    s_add_u32 s22, s78, 1
    s_max_u32 s22, s22, s79
    s_lshr_b32 s22, s22, 2
    s_mul_i32 s22, s22, 4736
    s_add_u32 s38, s22, 26244864
    s_mov_b32 s40, 0xfffc0000
    s_mov_b32 s41, 0x007fffff
    s_mov_b32 s66, -1
    s_mov_b32 s67, 0x007fffff
    v_mov_b32 v169, 1
    s_mul_i32 s44, s26, 108
    s_add_u32 s44, s44, s31
    s_lshl_b32 s44, s44, 10
    s_add_u32 s44, s44, 10485760
    s_add_u32 s44, s44, s56
    s_addc_u32 s45, s57, 0
    s_mul_i32 s46, s27, 108
    s_add_u32 s46, s46, s31
    s_lshl_b32 s46, s46, 10
    s_add_u32 s46, s46, 10485760
    s_add_u32 s46, s46, s56
    s_addc_u32 s47, s57, 0
    s_mul_i32 s48, s78, 148
    s_add_u32 s48, s48, s31
    s_lshl_b32 s48, s48, 10
    s_add_u32 s48, s48, 23068672
    s_add_u32 s48, s48, s56
    s_addc_u32 s49, s57, 0
    s_mul_i32 s50, s78, 148
    s_add_u32 s50, s50, s31
    s_lshl_b32 s50, s50, 10
    s_add_u32 s50, s50, 23220224
    s_add_u32 s50, s50, s56
    s_addc_u32 s51, s57, 0
    s_mul_i32 s52, s79, 148
    s_add_u32 s52, s52, s31
    s_lshl_b32 s52, s52, 10
    s_add_u32 s52, s52, 23068672
    s_add_u32 s52, s52, s56
    s_addc_u32 s53, s57, 0
    s_mul_i32 s12, s78, 148
    s_mul_i32 s23, s3, 5
    s_add_u32 s12, s12, s23
    s_lshl_b32 s12, s12, 10
    s_add_u32 s12, s12, 23179264
    s_add_u32 s12, s12, s56
    s_addc_u32 s13, s57, 0
    s_mul_i32 s14, s78, 148
    s_mul_i32 s23, s3, 5
    s_add_u32 s14, s14, s23
    s_lshl_b32 s14, s14, 10
    s_add_u32 s14, s14, 23330816
    s_add_u32 s14, s14, s56
    s_addc_u32 s15, s57, 0
    s_mul_i32 s36, s79, 148
    s_mul_i32 s23, s3, 5
    s_add_u32 s36, s36, s23
    s_lshl_b32 s36, s36, 10
    s_add_u32 s36, s36, 23179264
    s_add_u32 s36, s36, s56
    s_addc_u32 s37, s57, 0
    s_mul_i32 s24, s3, 4096
    s_mul_i32 s28, s3, 8192
    s_mul_i32 s29, s3, 2048
    s_mul_i32 s30, s3, 1024
    s_add_u32 s5, s5, s7
    s_mul_i32 s22, s5, 40960
    s_add_u32 s22, s22, 18874368
    s_lshl_b32 s55, s4, 8
    s_add_u32 s55, s55, s22
    s_add_u32 s55, s55, 32768
    s_lshl_b32 s54, s4, 10
    s_add_u32 s54, s54, s22
    v_mov_b32 v172, -1
    v_mov_b32 v173, -1
    v_mov_b32 v174, -1
    v_mov_b32 v175, -1
    v_lshlrev_b32 v170, 3, v0
    s_add_u32 s25, s60, s7
    s_add_u32 s42, s60, s3
    s_barrier
L_gated_mix__softmax_full_mha__glu_gated_glu__prompt_cdone_32:
L_gated_mix__softmax_full_mha__glu_gated_glu__prompt_fin_3:
L_main:
    s_mul_i32 s23, s7, 10432
    v_subrev_u32 v12, s23, v4
    v_subrev_u32 v13, s23, v5
    ds_read_b128 v[44:47], v12 offset:41728
    ds_read_b64 v[34:35], v13 offset:41728
    ds_read_b128 v[56:59], v4 offset:41728
    ds_read_b64 v[60:61], v5 offset:41728
    ds_read_b128 v[40:43], v7 offset:44336
    ds_read_b128 v[28:31], v4 offset:44336
    ds_read_b64 v[32:33], v5 offset:44336
    ds_read_b128 v[36:39], v6 offset:44336
    v_mov_b32 v12, 0
    v_mov_b32 v13, 0
    v_cmp_eq_u32 vcc, 0, v2
    s_add_u32 m0, s72, 20864
    s_add_u32 s74, s74, 10240
    s_addc_u32 s75, s75, 0
    global_load_lds_dwordx4 v8, s[74:75] sc1
    global_load_lds_dwordx4 v8, s[74:75] offset:1024 sc1
    s_mov_b64 exec, s[64:65]
    global_load_lds_dwordx4 v8, s[74:75] offset:2048 sc1
    s_mov_b64 exec, -1
    s_waitcnt vmcnt(6) lgkmcnt(6)
    v_mfma_f32_32x32x16_bf16 v[176:191], v[44:47], v[16:19], 0
    v_mfma_f32_32x32x8_bf16 v[176:191], v[34:35], v[24:25], v[176:191]
    v_mfma_f32_32x32x16_bf16 v[192:207], v[44:47], v[20:23], 0
    v_mfma_f32_32x32x8_bf16 v[192:207], v[34:35], v[26:27], v[192:207]
    v_mfma_f32_32x32x8_bf16 v[224:239], v[12:13], v[12:13], 0
    v_lshlrev_b32 v3, 2, v1
    s_nop 7
    v_max3_f32 v208, v176, v177, v178
    v_max3_f32 v208, v208, v179, v180
    v_max3_f32 v208, v208, v181, v182
    v_max3_f32 v208, v208, v183, v184
    v_max3_f32 v208, v208, v185, v186
    v_max3_f32 v208, v208, v187, v188
    v_max3_f32 v208, v208, v189, v190
    v_max3_f32 v208, v208, v191, v176
    v_mfma_f32_32x32x8_bf16 v[240:255], v[12:13], v[12:13], 0
    v_max3_f32 v209, v192, v193, v194
    v_max3_f32 v209, v209, v195, v196
    v_max3_f32 v209, v209, v197, v198
    v_max3_f32 v209, v209, v199, v200
    v_max3_f32 v209, v209, v201, v202
    v_max3_f32 v209, v209, v203, v204
    v_max3_f32 v209, v209, v205, v206
    v_max3_f32 v209, v209, v207, v192
    s_mov_b32 s23, 0x07060302
    v_mov_b32 v210, v208
    v_mov_b32 v211, v209
    s_nop 0
    v_permlane32_swap_b32 v208, v210
    v_permlane32_swap_b32 v209, v211
    s_nop 0
    v_max_f32 v208, v208, v210
    v_max_f32 v209, v209, v211
    v_xor_b32 v208, 0x80000000, v208
    v_xor_b32 v209, 0x80000000, v209
    v_and_b32 v210, 0xffff0000, v208
    v_and_b32 v211, 0xffff0000, v209
    v_sub_f32 v212, v208, v210
    v_sub_f32 v213, v209, v211
    v_and_b32 v214, 0xffff0000, v212
    v_and_b32 v215, 0xffff0000, v213
    v_sub_f32 v212, v212, v214
    v_sub_f32 v213, v213, v215
    v_perm_b32 v210, v214, v210, s23
    v_perm_b32 v211, v215, v211, s23
    v_lshrrev_b32 v212, 16, v212
    v_lshrrev_b32 v213, 16, v213
    v_cndmask_b32 v24, v210, v24, vcc
    v_cndmask_b32 v26, v211, v26, vcc
    v_cndmask_b32 v25, v212, v25, vcc
    v_cndmask_b32 v27, v213, v27, vcc
    s_waitcnt lgkmcnt(0)
    v_mov_b32 v13, 1
    v_mfma_f32_32x32x16_bf16 v[176:191], v[56:59], v[16:19], 0
    v_mfma_f32_32x32x8_bf16 v[176:191], v[60:61], v[24:25], v[176:191]
    v_mfma_f32_32x32x16_bf16 v[192:207], v[56:59], v[20:23], 0
    v_mfma_f32_32x32x8_bf16 v[192:207], v[60:61], v[26:27], v[192:207]
    v_and_b32 v12, 15, v0
    v_lshlrev_b32 v12, 4, v12
    v_lshl_add_u32 v12, v2, 8, v12
    v_bfe_u32 v160, v0, 4, 1
    v_lshl_add_u32 v12, v160, 9, v12
    s_waitcnt vmcnt(3)
    s_nop 0
.p2align 6
    s_waitcnt lgkmcnt(0)
    s_barrier
    s_setprio 3
    v_exp_f32 v176, v176
    v_exp_f32 v177, v177
    ds_read_b128 v[52:55], v7 offset:0
    v_exp_f32 v178, v178
    v_exp_f32 v179, v179
    v_exp_f32 v180, v180
    v_exp_f32 v181, v181
    v_mfma_f32_32x32x16_bf16 v[208:223], v[28:31], v[16:19], 0
    ds_read_b128 v[44:47], v4 offset:0
    v_exp_f32 v182, v182
    v_exp_f32 v183, v183
    v_exp_f32 v184, v184
    v_exp_f32 v185, v185
    v_mfma_f32_32x32x8_bf16 v[208:223], v[32:33], v[24:25], v[208:223]
    ds_read_b64 v[34:35], v5 offset:0
    v_exp_f32 v186, v186
    v_exp_f32 v187, v187
    v_exp_f32 v188, v188
    v_exp_f32 v189, v189
    v_smfmac_f32_32x32x32_bf16 v[224:239], v[36:39], v[176:183], v9
    ds_read_b128 v[48:51], v6 offset:0
    v_exp_f32 v190, v190
    v_exp_f32 v191, v191
    v_exp_f32 v192, v192
    v_exp_f32 v193, v193
    v_smfmac_f32_32x32x32_bf16 v[224:239], v[40:43], v[184:191], v9
    s_add_u32 m0, s72, 41728
    s_add_u32 s74, s74, 10240
    s_addc_u32 s75, s75, 0
    global_load_lds_dwordx4 v8, s[74:75] sc1
    v_exp_f32 v194, v194
    v_exp_f32 v195, v195
    v_exp_f32 v196, v196
    v_exp_f32 v197, v197
    v_mfma_f32_32x32x16_bf16 v[176:191], v[28:31], v[20:23], 0
    global_load_lds_dwordx4 v8, s[74:75] offset:1024 sc1
    v_exp_f32 v198, v198
    v_exp_f32 v199, v199
    v_exp_f32 v200, v200
    v_exp_f32 v201, v201
    v_mfma_f32_32x32x8_bf16 v[176:191], v[32:33], v[26:27], v[176:191]
    s_mov_b64 exec, s[64:65]
    global_load_lds_dwordx4 v8, s[74:75] offset:2048 sc1
    s_mov_b64 exec, -1
    v_exp_f32 v202, v202
    v_exp_f32 v203, v203
    v_exp_f32 v204, v204
    v_exp_f32 v205, v205
    v_smfmac_f32_32x32x32_bf16 v[240:255], v[36:39], v[192:199], v9
    s_cmp_lg_u32 s25, 0
    s_cbranch_scc1 L_gated_mix__softmax_full_mha__glu_gated_glu__prompt_nh_54
    buffer_store_dwordx4 v[64:67], v12, s[16:19], s43 offen offset:0 sc1
L_gated_mix__softmax_full_mha__glu_gated_glu__prompt_nh_54:
    v_exp_f32 v206, v206
    v_exp_f32 v207, v207
    s_waitcnt lgkmcnt(0)
    s_setprio 2
    v_exp_f32 v208, v208
    v_exp_f32 v209, v209
    v_smfmac_f32_32x32x32_bf16 v[240:255], v[40:43], v[200:207], v9
    ds_read_b128 v[40:43], v7 offset:2608
    s_cmp_lg_u32 s25, 0
    s_cbranch_scc1 L_gated_mix__softmax_full_mha__glu_gated_glu__prompt_nh_55
    buffer_store_dwordx4 v[80:83], v12, s[16:19], s43 offen offset:1024 sc1
L_gated_mix__softmax_full_mha__glu_gated_glu__prompt_nh_55:
    v_exp_f32 v210, v210
    v_exp_f32 v211, v211
    v_exp_f32 v212, v212
    v_exp_f32 v213, v213
    v_mfma_f32_32x32x16_bf16 v[192:207], v[44:47], v[16:19], 0
    ds_read_b128 v[28:31], v4 offset:2608
    s_cmp_lg_u32 s25, 0
    s_cbranch_scc1 L_gated_mix__softmax_full_mha__glu_gated_glu__prompt_nh_56
    buffer_store_dwordx4 v[96:99], v12, s[16:19], s43 offen offset:2048 sc1
    s_add_u32 s43, s43, 110592
L_gated_mix__softmax_full_mha__glu_gated_glu__prompt_nh_56:
    v_exp_f32 v214, v214
    v_exp_f32 v215, v215
    v_exp_f32 v216, v216
    v_exp_f32 v217, v217
    v_mfma_f32_32x32x8_bf16 v[192:207], v[34:35], v[24:25], v[192:207]
    ds_read_b64 v[32:33], v5 offset:2608
    s_cmp_lg_u32 s25, 0
    s_cbranch_scc1 L_gated_mix__softmax_full_mha__glu_gated_glu__prompt_nh_57
    buffer_store_dwordx4 v[68:71], v12, s[16:19], s43 offen offset:0 sc1
L_gated_mix__softmax_full_mha__glu_gated_glu__prompt_nh_57:
    v_exp_f32 v218, v218
    v_exp_f32 v219, v219
    v_exp_f32 v220, v220
    v_exp_f32 v221, v221
    v_smfmac_f32_32x32x32_bf16 v[224:239], v[48:51], v[208:215], v9
    ds_read_b128 v[36:39], v6 offset:2608
    s_cmp_lg_u32 s25, 0
    s_cbranch_scc1 L_gated_mix__softmax_full_mha__glu_gated_glu__prompt_nh_58
    buffer_store_dwordx4 v[84:87], v12, s[16:19], s43 offen offset:1024 sc1
L_gated_mix__softmax_full_mha__glu_gated_glu__prompt_nh_58:
    v_exp_f32 v222, v222
    v_exp_f32 v223, v223
    v_exp_f32 v176, v176
    v_exp_f32 v177, v177
    v_smfmac_f32_32x32x32_bf16 v[224:239], v[52:55], v[216:223], v9
    s_cmp_lg_u32 s25, 0
    s_cbranch_scc1 L_gated_mix__softmax_full_mha__glu_gated_glu__prompt_nh_59
    buffer_store_dwordx4 v[100:103], v12, s[16:19], s43 offen offset:2048 sc1
    s_add_u32 s43, s43, 110592
L_gated_mix__softmax_full_mha__glu_gated_glu__prompt_nh_59:
    v_exp_f32 v178, v178
    v_exp_f32 v179, v179
    v_exp_f32 v180, v180
    v_exp_f32 v181, v181
    v_mfma_f32_32x32x16_bf16 v[208:223], v[44:47], v[20:23], 0
    s_cmp_lg_u32 s25, 0
    s_cbranch_scc1 L_gated_mix__softmax_full_mha__glu_gated_glu__prompt_nh_60
    buffer_store_dwordx4 v[72:75], v12, s[16:19], s43 offen offset:0 sc1
L_gated_mix__softmax_full_mha__glu_gated_glu__prompt_nh_60:
    v_exp_f32 v182, v182
    v_exp_f32 v183, v183
    v_exp_f32 v184, v184
    v_exp_f32 v185, v185
    v_mfma_f32_32x32x8_bf16 v[208:223], v[34:35], v[26:27], v[208:223]
    s_cmp_lg_u32 s25, 0
    s_cbranch_scc1 L_gated_mix__softmax_full_mha__glu_gated_glu__prompt_nh_61
    buffer_store_dwordx4 v[88:91], v12, s[16:19], s43 offen offset:1024 sc1
L_gated_mix__softmax_full_mha__glu_gated_glu__prompt_nh_61:
    v_exp_f32 v186, v186
    v_exp_f32 v187, v187
    v_exp_f32 v188, v188
    v_exp_f32 v189, v189
    v_smfmac_f32_32x32x32_bf16 v[240:255], v[48:51], v[176:183], v9
    s_cmp_lg_u32 s25, 0
    s_cbranch_scc1 L_gated_mix__softmax_full_mha__glu_gated_glu__prompt_nh_62
    buffer_store_dwordx4 v[104:107], v12, s[16:19], s43 offen offset:2048 sc1
    s_add_u32 s43, s43, 110592
L_gated_mix__softmax_full_mha__glu_gated_glu__prompt_nh_62:
    v_exp_f32 v190, v190
    v_exp_f32 v191, v191
    s_waitcnt lgkmcnt(0)
    s_setprio 1
    v_exp_f32 v192, v192
    v_exp_f32 v193, v193
    v_smfmac_f32_32x32x32_bf16 v[240:255], v[52:55], v[184:191], v9
    ds_read_b128 v[52:55], v7 offset:5216
    s_cmp_lg_u32 s25, 0
    s_cbranch_scc1 L_gated_mix__softmax_full_mha__glu_gated_glu__prompt_nh_63
    buffer_store_dwordx4 v[76:79], v12, s[16:19], s43 offen offset:0 sc1
L_gated_mix__softmax_full_mha__glu_gated_glu__prompt_nh_63:
    v_exp_f32 v194, v194
    v_exp_f32 v195, v195
    v_exp_f32 v196, v196
    v_exp_f32 v197, v197
    v_mfma_f32_32x32x16_bf16 v[176:191], v[28:31], v[16:19], 0
    ds_read_b128 v[44:47], v4 offset:5216
    s_cmp_lg_u32 s25, 0
    s_cbranch_scc1 L_gated_mix__softmax_full_mha__glu_gated_glu__prompt_nh_64
    buffer_store_dwordx4 v[92:95], v12, s[16:19], s43 offen offset:1024 sc1
L_gated_mix__softmax_full_mha__glu_gated_glu__prompt_nh_64:
    v_exp_f32 v198, v198
    v_exp_f32 v199, v199
    v_exp_f32 v200, v200
    v_exp_f32 v201, v201
    v_mfma_f32_32x32x8_bf16 v[176:191], v[32:33], v[24:25], v[176:191]
    ds_read_b64 v[34:35], v5 offset:5216
    s_cmp_lg_u32 s25, 0
    s_cbranch_scc1 L_gated_mix__softmax_full_mha__glu_gated_glu__prompt_nh_65
    buffer_store_dwordx4 v[108:111], v12, s[16:19], s43 offen offset:2048 sc1
    s_add_u32 s43, s43, 110592
L_gated_mix__softmax_full_mha__glu_gated_glu__prompt_nh_65:
    v_exp_f32 v202, v202
    v_exp_f32 v203, v203
    v_exp_f32 v204, v204
    v_exp_f32 v205, v205
    v_smfmac_f32_32x32x32_bf16 v[224:239], v[36:39], v[192:199], v9
    ds_read_b128 v[48:51], v6 offset:5216
    v_exp_f32 v206, v206
    v_exp_f32 v207, v207
    v_exp_f32 v208, v208
    v_exp_f32 v209, v209
    v_smfmac_f32_32x32x32_bf16 v[224:239], v[40:43], v[200:207], v9
    v_exp_f32 v210, v210
    v_exp_f32 v211, v211
    v_exp_f32 v212, v212
    v_exp_f32 v213, v213
    v_mfma_f32_32x32x16_bf16 v[192:207], v[28:31], v[20:23], 0
    v_exp_f32 v214, v214
    v_exp_f32 v215, v215
    v_exp_f32 v216, v216
    v_exp_f32 v217, v217
    v_mfma_f32_32x32x8_bf16 v[192:207], v[32:33], v[26:27], v[192:207]
    v_exp_f32 v218, v218
    v_exp_f32 v219, v219
    v_exp_f32 v220, v220
    v_exp_f32 v221, v221
    v_smfmac_f32_32x32x32_bf16 v[240:255], v[36:39], v[208:215], v9
    v_exp_f32 v222, v222
    v_exp_f32 v223, v223
    s_waitcnt lgkmcnt(0)
    s_setprio 0
    v_exp_f32 v176, v176
    v_exp_f32 v177, v177
    v_smfmac_f32_32x32x32_bf16 v[240:255], v[40:43], v[216:223], v9
    ds_read_b128 v[40:43], v7 offset:7824
    v_exp_f32 v178, v178
    v_exp_f32 v179, v179
    v_exp_f32 v180, v180
    v_exp_f32 v181, v181
    v_mfma_f32_32x32x16_bf16 v[208:223], v[44:47], v[16:19], 0
    ds_read_b128 v[28:31], v4 offset:7824
    v_exp_f32 v182, v182
    v_exp_f32 v183, v183
    v_exp_f32 v184, v184
    v_exp_f32 v185, v185
    v_mfma_f32_32x32x8_bf16 v[208:223], v[34:35], v[24:25], v[208:223]
    ds_read_b64 v[32:33], v5 offset:7824
    v_exp_f32 v186, v186
    v_exp_f32 v187, v187
    v_exp_f32 v188, v188
    v_exp_f32 v189, v189
    v_smfmac_f32_32x32x32_bf16 v[224:239], v[48:51], v[176:183], v9
    ds_read_b128 v[36:39], v6 offset:7824
    v_exp_f32 v190, v190
    v_exp_f32 v191, v191
    v_exp_f32 v192, v192
    v_exp_f32 v193, v193
    v_smfmac_f32_32x32x32_bf16 v[224:239], v[52:55], v[184:191], v9
    v_exp_f32 v194, v194
    v_exp_f32 v195, v195
    v_exp_f32 v196, v196
    v_exp_f32 v197, v197
    v_mfma_f32_32x32x16_bf16 v[176:191], v[44:47], v[20:23], 0
    v_exp_f32 v198, v198
    v_exp_f32 v199, v199
    v_exp_f32 v200, v200
    v_exp_f32 v201, v201
    v_mfma_f32_32x32x8_bf16 v[176:191], v[34:35], v[26:27], v[176:191]
    v_exp_f32 v202, v202
    v_exp_f32 v203, v203
    v_exp_f32 v204, v204
    v_exp_f32 v205, v205
    v_smfmac_f32_32x32x32_bf16 v[240:255], v[48:51], v[192:199], v9
    v_exp_f32 v206, v206
    v_exp_f32 v207, v207
    s_waitcnt vmcnt(0) lgkmcnt(0)
    s_barrier
    s_cmp_lg_u32 s42, 0
    s_cbranch_scc1 L_gated_mix__softmax_full_mha__glu_gated_glu__prompt_nf_66
    s_mov_b64 exec, 1
    buffer_store_dword v13, v14, s[16:19], s32 offen sc1
    s_mov_b64 exec, -1
L_gated_mix__softmax_full_mha__glu_gated_glu__prompt_nf_66:
    s_setprio 3
    v_exp_f32 v208, v208
    v_exp_f32 v209, v209
    v_smfmac_f32_32x32x32_bf16 v[240:255], v[52:55], v[200:207], v9
    ds_read_b128 v[52:55], v7 offset:20864
    buffer_store_dwordx4 v[172:175], v8, s[16:19], s54 offen sc1
    v_exp_f32 v210, v210
    v_exp_f32 v211, v211
    v_exp_f32 v212, v212
    v_exp_f32 v213, v213
    v_mfma_f32_32x32x16_bf16 v[192:207], v[28:31], v[16:19], 0
    ds_read_b128 v[44:47], v4 offset:20864
    s_mov_b64 exec, s[64:65]
    buffer_store_dwordx2 v[172:173], v170, s[16:19], s55 offen sc1
    s_mov_b64 exec, -1
    v_exp_f32 v214, v214
    v_exp_f32 v215, v215
    v_exp_f32 v216, v216
    v_exp_f32 v217, v217
    v_mfma_f32_32x32x8_bf16 v[192:207], v[32:33], v[24:25], v[192:207]
    ds_read_b64 v[34:35], v5 offset:20864
    v_exp_f32 v218, v218
    v_exp_f32 v219, v219
    v_exp_f32 v220, v220
    v_exp_f32 v221, v221
    v_smfmac_f32_32x32x32_bf16 v[224:239], v[36:39], v[208:215], v9
    ds_read_b128 v[48:51], v6 offset:20864
    v_exp_f32 v222, v222
    v_exp_f32 v223, v223
    v_exp_f32 v176, v176
    v_exp_f32 v177, v177
    v_smfmac_f32_32x32x32_bf16 v[224:239], v[40:43], v[216:223], v9
    s_add_u32 m0, s72, 0
    s_add_u32 s74, s74, 10240
    s_addc_u32 s75, s75, 0
    global_load_lds_dwordx4 v8, s[74:75] sc1
    v_exp_f32 v178, v178
    v_exp_f32 v179, v179
    v_exp_f32 v180, v180
    v_exp_f32 v181, v181
    v_mfma_f32_32x32x16_bf16 v[208:223], v[28:31], v[20:23], 0
    global_load_lds_dwordx4 v8, s[74:75] offset:1024 sc1
    v_exp_f32 v182, v182
    v_exp_f32 v183, v183
    v_exp_f32 v184, v184
    v_exp_f32 v185, v185
    v_mfma_f32_32x32x8_bf16 v[208:223], v[32:33], v[26:27], v[208:223]
    s_mov_b64 exec, s[64:65]
    global_load_lds_dwordx4 v8, s[74:75] offset:2048 sc1
    s_mov_b64 exec, -1
    v_exp_f32 v186, v186
    v_exp_f32 v187, v187
    v_exp_f32 v188, v188
    v_exp_f32 v189, v189
    v_smfmac_f32_32x32x32_bf16 v[240:255], v[36:39], v[176:183], v9
    buffer_load_dword v10, v3, s[16:19], s34 offen sc1
    v_lshlrev_b32 v3, 2, v0
    buffer_load_dword v11, v3, s[16:19], s35 offen sc1
    v_exp_f32 v190, v190
    v_exp_f32 v191, v191
    s_waitcnt lgkmcnt(0)
    s_setprio 2
    v_exp_f32 v192, v192
    v_exp_f32 v193, v193
    v_smfmac_f32_32x32x32_bf16 v[240:255], v[40:43], v[184:191], v9
    ds_read_b128 v[40:43], v7 offset:23472
    v_exp_f32 v194, v194
    v_exp_f32 v195, v195
    v_exp_f32 v196, v196
    v_exp_f32 v197, v197
    v_mfma_f32_32x32x16_bf16 v[176:191], v[44:47], v[16:19], 0
    ds_read_b128 v[28:31], v4 offset:23472
    v_exp_f32 v198, v198
    v_exp_f32 v199, v199
    v_exp_f32 v200, v200
    v_exp_f32 v201, v201
    v_mfma_f32_32x32x8_bf16 v[176:191], v[34:35], v[24:25], v[176:191]
    ds_read_b64 v[32:33], v5 offset:23472
    v_exp_f32 v202, v202
    v_exp_f32 v203, v203
    v_exp_f32 v204, v204
    v_exp_f32 v205, v205
    v_smfmac_f32_32x32x32_bf16 v[224:239], v[48:51], v[192:199], v9
    ds_read_b128 v[36:39], v6 offset:23472
    v_exp_f32 v206, v206
    v_exp_f32 v207, v207
    v_exp_f32 v208, v208
    v_exp_f32 v209, v209
    v_smfmac_f32_32x32x32_bf16 v[224:239], v[52:55], v[200:207], v9
    v_exp_f32 v210, v210
    v_exp_f32 v211, v211
    v_exp_f32 v212, v212
    v_exp_f32 v213, v213
    v_mfma_f32_32x32x16_bf16 v[192:207], v[44:47], v[20:23], 0
    v_exp_f32 v214, v214
    v_exp_f32 v215, v215
    v_exp_f32 v216, v216
    v_exp_f32 v217, v217
    v_mfma_f32_32x32x8_bf16 v[192:207], v[34:35], v[26:27], v[192:207]
    v_exp_f32 v218, v218
    v_exp_f32 v219, v219
    v_exp_f32 v220, v220
    v_exp_f32 v221, v221
    v_smfmac_f32_32x32x32_bf16 v[240:255], v[48:51], v[208:215], v9
    v_exp_f32 v222, v222
    v_exp_f32 v223, v223
    s_waitcnt lgkmcnt(0)
    s_setprio 1
    v_exp_f32 v176, v176
    v_exp_f32 v177, v177
    v_smfmac_f32_32x32x32_bf16 v[240:255], v[52:55], v[216:223], v9
    ds_read_b128 v[52:55], v7 offset:26080
    v_exp_f32 v178, v178
    v_exp_f32 v179, v179
    v_exp_f32 v180, v180
    v_exp_f32 v181, v181
    v_mfma_f32_32x32x16_bf16 v[208:223], v[28:31], v[16:19], 0
    ds_read_b128 v[44:47], v4 offset:26080
    v_exp_f32 v182, v182
    v_exp_f32 v183, v183
    v_exp_f32 v184, v184
    v_exp_f32 v185, v185
    v_mfma_f32_32x32x8_bf16 v[208:223], v[32:33], v[24:25], v[208:223]
    ds_read_b64 v[34:35], v5 offset:26080
    v_exp_f32 v186, v186
    v_exp_f32 v187, v187
    v_exp_f32 v188, v188
    v_exp_f32 v189, v189
    v_smfmac_f32_32x32x32_bf16 v[224:239], v[36:39], v[176:183], v9
    ds_read_b128 v[48:51], v6 offset:26080
    v_exp_f32 v190, v190
    v_exp_f32 v191, v191
    v_exp_f32 v192, v192
    v_exp_f32 v193, v193
    v_smfmac_f32_32x32x32_bf16 v[224:239], v[40:43], v[184:191], v9
    v_exp_f32 v194, v194
    v_exp_f32 v195, v195
    v_exp_f32 v196, v196
    v_exp_f32 v197, v197
    v_mfma_f32_32x32x16_bf16 v[176:191], v[28:31], v[20:23], 0
    v_exp_f32 v198, v198
    v_exp_f32 v199, v199
    v_exp_f32 v200, v200
    v_exp_f32 v201, v201
    v_mfma_f32_32x32x8_bf16 v[176:191], v[32:33], v[26:27], v[176:191]
    v_exp_f32 v202, v202
    v_exp_f32 v203, v203
    v_exp_f32 v204, v204
    v_exp_f32 v205, v205
    v_smfmac_f32_32x32x32_bf16 v[240:255], v[36:39], v[192:199], v9
    v_exp_f32 v206, v206
    v_exp_f32 v207, v207
    s_waitcnt lgkmcnt(0)
    s_setprio 0
    v_exp_f32 v208, v208
    v_exp_f32 v209, v209
    v_smfmac_f32_32x32x32_bf16 v[240:255], v[40:43], v[200:207], v9
    ds_read_b128 v[40:43], v7 offset:28688
    s_mov_b64 exec, s[66:67]
    buffer_load_dword v12, v168, s[16:19], 0 offen sc1
    s_mov_b64 exec, s[40:41]
    buffer_load_dword v169, v14, s[16:19], s38 offen sc1
    s_mov_b64 exec, -1
    s_nop 0
    v_exp_f32 v210, v210
    v_exp_f32 v211, v211
    v_exp_f32 v212, v212
    v_exp_f32 v213, v213
    v_mfma_f32_32x32x16_bf16 v[192:207], v[44:47], v[16:19], 0
    ds_read_b128 v[28:31], v4 offset:28688
    v_exp_f32 v214, v214
    v_exp_f32 v215, v215
    v_exp_f32 v216, v216
    v_exp_f32 v217, v217
    v_mfma_f32_32x32x8_bf16 v[192:207], v[34:35], v[24:25], v[192:207]
    ds_read_b64 v[32:33], v5 offset:28688
    v_exp_f32 v218, v218
    v_exp_f32 v219, v219
    v_exp_f32 v220, v220
    v_exp_f32 v221, v221
    v_smfmac_f32_32x32x32_bf16 v[224:239], v[48:51], v[208:215], v9
    ds_read_b128 v[36:39], v6 offset:28688
    v_exp_f32 v222, v222
    v_exp_f32 v223, v223
    v_exp_f32 v176, v176
    v_exp_f32 v177, v177
    v_smfmac_f32_32x32x32_bf16 v[224:239], v[52:55], v[216:223], v9
    v_exp_f32 v178, v178
    v_exp_f32 v179, v179
    v_exp_f32 v180, v180
    v_exp_f32 v181, v181
    v_mfma_f32_32x32x16_bf16 v[208:223], v[44:47], v[20:23], 0
    v_exp_f32 v182, v182
    v_exp_f32 v183, v183
    v_exp_f32 v184, v184
    v_exp_f32 v185, v185
    v_mfma_f32_32x32x8_bf16 v[208:223], v[34:35], v[26:27], v[208:223]
    v_exp_f32 v186, v186
    v_exp_f32 v187, v187
    v_exp_f32 v188, v188
    v_exp_f32 v189, v189
    v_smfmac_f32_32x32x32_bf16 v[240:255], v[48:51], v[176:183], v9
    v_exp_f32 v190, v190
    v_exp_f32 v191, v191
    s_waitcnt vmcnt(7) lgkmcnt(0)
    s_barrier
    s_cmp_lg_u32 s3, 5
    s_cbranch_scc1 L_gated_mix__softmax_full_mha__glu_gated_glu__prompt_nf_67
    s_mov_b64 exec, 1
    buffer_atomic_add v13, v14, s[16:19], s33 offen offset:2560 sc1
    s_mov_b64 exec, -1
L_gated_mix__softmax_full_mha__glu_gated_glu__prompt_nf_67:
    s_setprio 3
    v_exp_f32 v192, v192
    v_exp_f32 v193, v193
    v_smfmac_f32_32x32x32_bf16 v[240:255], v[52:55], v[184:191], v9
    ds_read_b128 v[52:55], v7 offset:41728
    v_exp_f32 v194, v194
    v_exp_f32 v195, v195
    v_exp_f32 v196, v196
    v_exp_f32 v197, v197
    v_mfma_f32_32x32x16_bf16 v[176:191], v[28:31], v[16:19], 0
    ds_read_b128 v[44:47], v4 offset:41728
    v_exp_f32 v198, v198
    v_exp_f32 v199, v199
    v_exp_f32 v200, v200
    v_exp_f32 v201, v201
    v_mfma_f32_32x32x8_bf16 v[176:191], v[32:33], v[24:25], v[176:191]
    ds_read_b64 v[34:35], v5 offset:41728
    v_exp_f32 v202, v202
    v_exp_f32 v203, v203
    v_exp_f32 v204, v204
    v_exp_f32 v205, v205
    v_smfmac_f32_32x32x32_bf16 v[224:239], v[36:39], v[192:199], v9
    ds_read_b128 v[48:51], v6 offset:41728
    v_exp_f32 v206, v206
    v_exp_f32 v207, v207
    s_waitcnt vmcnt(0)
    s_mov_b32 s21, 400000
L_gated_mix__softmax_full_mha__glu_gated_glu__prompt_ph_52:
    s_mov_b64 exec, s[66:67]
    v_and_b32 v12, v12, v169
    v_cmp_ne_u32 vcc, 1, v12
    s_cbranch_vccz L_gated_mix__softmax_full_mha__glu_gated_glu__prompt_ok_53
    s_sleep 4
    buffer_load_dword v12, v168, s[16:19], 0 offen sc1
    s_mov_b64 exec, s[40:41]
    buffer_load_dword v169, v14, s[16:19], s38 offen sc1
    s_sub_u32 s21, s21, 1
    s_waitcnt vmcnt(0)
    s_cbranch_scc0 L_gated_mix__softmax_full_mha__glu_gated_glu__prompt_ph_52
L_gated_mix__softmax_full_mha__glu_gated_glu__prompt_ok_53:
    s_mov_b64 exec, -1
    v_exp_f32 v208, v208
    v_exp_f32 v209, v209
    v_smfmac_f32_32x32x32_bf16 v[224:239], v[40:43], v[200:207], v9
    global_load_dwordx4 v[56:59], v8, s[44:45] offset:-4096 sc1
    v_exp_f32 v210, v210
    v_exp_f32 v211, v211
    v_exp_f32 v212, v212
    v_exp_f32 v213, v213
    v_mfma_f32_32x32x16_bf16 v[192:207], v[28:31], v[20:23], 0
    global_load_dwordx4 v[64:67], v8, s[48:49] offset:-4096 sc1
    v_exp_f32 v214, v214
    v_exp_f32 v215, v215
    v_exp_f32 v216, v216
    v_exp_f32 v217, v217
    v_mfma_f32_32x32x8_bf16 v[192:207], v[32:33], v[26:27], v[192:207]
    global_load_dwordx4 v[68:71], v8, s[50:51] offset:-4096 sc1
    v_exp_f32 v218, v218
    v_exp_f32 v219, v219
    v_exp_f32 v220, v220
    v_exp_f32 v221, v221
    v_smfmac_f32_32x32x32_bf16 v[240:255], v[36:39], v[208:215], v9
    global_load_dwordx4 v[72:75], v8, s[52:53] offset:-4096 sc1
    v_exp_f32 v222, v222
    v_exp_f32 v223, v223
    s_waitcnt lgkmcnt(0)
    s_setprio 2
    v_exp_f32 v176, v176
    v_exp_f32 v177, v177
    v_smfmac_f32_32x32x32_bf16 v[240:255], v[40:43], v[216:223], v9
    ds_read_b128 v[40:43], v7 offset:44336
    global_load_dwordx4 v[60:63], v8, s[46:47] offset:-4096 sc1
    v_exp_f32 v178, v178
    v_exp_f32 v179, v179
    v_exp_f32 v180, v180
    v_exp_f32 v181, v181
    v_mfma_f32_32x32x16_bf16 v[208:223], v[44:47], v[16:19], 0
    ds_read_b128 v[28:31], v4 offset:44336
    s_add_u32 m0, s72, 20864
    s_add_u32 s74, s74, 10240
    s_addc_u32 s75, s75, 0
    global_load_lds_dwordx4 v8, s[74:75] sc1
    v_exp_f32 v182, v182
    v_exp_f32 v183, v183
    v_exp_f32 v184, v184
    v_exp_f32 v185, v185
    v_mfma_f32_32x32x8_bf16 v[208:223], v[34:35], v[24:25], v[208:223]
    ds_read_b64 v[32:33], v5 offset:44336
    global_load_lds_dwordx4 v8, s[74:75] offset:1024 sc1
    v_exp_f32 v186, v186
    v_exp_f32 v187, v187
    v_exp_f32 v188, v188
    v_exp_f32 v189, v189
    v_smfmac_f32_32x32x32_bf16 v[224:239], v[48:51], v[176:183], v9
    ds_read_b128 v[36:39], v6 offset:44336
    s_mov_b64 exec, s[64:65]
    global_load_lds_dwordx4 v8, s[74:75] offset:2048 sc1
    s_mov_b64 exec, -1
    v_exp_f32 v190, v190
    v_exp_f32 v191, v191
    v_exp_f32 v192, v192
    v_exp_f32 v193, v193
    v_smfmac_f32_32x32x32_bf16 v[224:239], v[52:55], v[184:191], v9
    s_add_u32 m0, s24, 0
    s_nop 0
    global_load_lds_dwordx4 v8, s[12:13] offset:0 sc1
    v_exp_f32 v194, v194
    v_exp_f32 v195, v195
    v_exp_f32 v196, v196
    v_mfma_f32_32x32x16_bf16 v[176:191], v[44:47], v[20:23], 0
    v_exp_f32 v197, v197
    v_exp_f32 v198, v198
    v_exp_f32 v199, v199
    v_mfma_f32_32x32x8_bf16 v[176:191], v[34:35], v[26:27], v[176:191]
    v_exp_f32 v200, v200
    v_exp_f32 v201, v201
    v_exp_f32 v202, v202
    v_exp_f32 v203, v203
    s_waitcnt vmcnt(4)
    v_mfma_f32_32x32x16_bf16 v[96:111], v[64:67], v[56:59], 0
    global_load_dwordx4 v[76:79], v8, s[44:45] offset:-3072 sc1
    v_exp_f32 v204, v204
    v_exp_f32 v205, v205
    v_exp_f32 v206, v206
    v_smfmac_f32_32x32x32_bf16 v[240:255], v[48:51], v[192:199], v9
    global_load_dwordx4 v[84:87], v8, s[48:49] offset:-3072 sc1
    v_exp_f32 v207, v207
    s_waitcnt lgkmcnt(0)
    s_setprio 1
    v_exp_f32 v208, v208
    v_exp_f32 v209, v209
    v_smfmac_f32_32x32x32_bf16 v[240:255], v[52:55], v[200:207], v9
    ds_read_b128 v[52:55], v7 offset:46944
    global_load_dwordx4 v[88:91], v8, s[50:51] offset:-3072 sc1
    v_exp_f32 v210, v210
    v_exp_f32 v211, v211
    v_mfma_f32_32x32x16_bf16 v[192:207], v[28:31], v[16:19], 0
    ds_read_b128 v[44:47], v4 offset:46944
    global_load_dwordx4 v[92:95], v8, s[52:53] offset:-3072 sc1
    v_exp_f32 v212, v212
    v_exp_f32 v213, v213
    v_exp_f32 v214, v214
    v_mfma_f32_32x32x16_bf16 v[112:127], v[68:71], v[56:59], 0
    ds_read_b64 v[34:35], v5 offset:46944
    global_load_dwordx4 v[80:83], v8, s[46:47] offset:-3072 sc1
    v_exp_f32 v215, v215
    v_exp_f32 v216, v216
    v_exp_f32 v217, v217
    v_mfma_f32_32x32x8_bf16 v[192:207], v[32:33], v[24:25], v[192:207]
    ds_read_b128 v[48:51], v6 offset:46944
    v_exp_f32 v218, v218
    v_exp_f32 v219, v219
    v_exp_f32 v220, v220
    v_mfma_f32_32x32x16_bf16 v[128:143], v[72:75], v[56:59], 0
    v_exp_f32 v221, v221
    v_exp_f32 v222, v222
    v_exp_f32 v223, v223
    v_smfmac_f32_32x32x32_bf16 v[224:239], v[36:39], v[208:215], v9
    v_exp_f32 v176, v176
    v_exp_f32 v177, v177
    v_smfmac_f32_32x32x32_bf16 v[224:239], v[40:43], v[216:223], v9
    s_add_u32 m0, s24, 1024
    s_nop 0
    global_load_lds_dwordx4 v8, s[14:15] offset:0 sc1
    v_exp_f32 v178, v178
    v_exp_f32 v179, v179
    v_exp_f32 v180, v180
    v_mfma_f32_32x32x16_bf16 v[208:223], v[28:31], v[20:23], 0
    v_exp_f32 v181, v181
    v_exp_f32 v182, v182
    v_exp_f32 v183, v183
    v_mfma_f32_32x32x8_bf16 v[208:223], v[32:33], v[26:27], v[208:223]
    v_exp_f32 v184, v184
    v_exp_f32 v185, v185
    v_exp_f32 v186, v186
    v_exp_f32 v187, v187
    v_mfma_f32_32x32x16_bf16 v[144:159], v[64:67], v[60:63], 0
    v_exp_f32 v188, v188
    v_exp_f32 v189, v189
    v_exp_f32 v190, v190
    v_smfmac_f32_32x32x32_bf16 v[240:255], v[36:39], v[176:183], v9
    v_exp_f32 v191, v191
    s_waitcnt lgkmcnt(0)
    s_setprio 0
    v_exp_f32 v192, v192
    v_exp_f32 v193, v193
    v_smfmac_f32_32x32x32_bf16 v[240:255], v[40:43], v[184:191], v9
    ds_read_b128 v[40:43], v7 offset:49552
    v_exp_f32 v194, v194
    v_exp_f32 v195, v195
    v_mfma_f32_32x32x16_bf16 v[176:191], v[44:47], v[16:19], 0
    ds_read_b128 v[28:31], v4 offset:49552
    v_exp_f32 v196, v196
    v_exp_f32 v197, v197
    v_exp_f32 v198, v198
    v_mfma_f32_32x32x16_bf16 v[160:175], v[68:71], v[60:63], 0
    ds_read_b64 v[32:33], v5 offset:49552
    v_exp_f32 v199, v199
    v_exp_f32 v200, v200
    v_exp_f32 v201, v201
    v_mfma_f32_32x32x8_bf16 v[176:191], v[34:35], v[24:25], v[176:191]
    ds_read_b128 v[36:39], v6 offset:49552
    v_exp_f32 v202, v202
    v_exp_f32 v203, v203
    v_exp_f32 v204, v204
    s_waitcnt vmcnt(1)
    v_mfma_f32_32x32x16_bf16 v[96:111], v[84:87], v[76:79], v[96:111]
    global_load_dwordx4 v[56:59], v8, s[44:45] offset:-2048 sc1
    v_exp_f32 v205, v205
    v_exp_f32 v206, v206
    v_exp_f32 v207, v207
    v_smfmac_f32_32x32x32_bf16 v[224:239], v[48:51], v[192:199], v9
    global_load_dwordx4 v[64:67], v8, s[48:49] offset:-2048 sc1
    v_exp_f32 v208, v208
    v_exp_f32 v209, v209
    v_smfmac_f32_32x32x32_bf16 v[224:239], v[52:55], v[200:207], v9
    global_load_dwordx4 v[68:71], v8, s[50:51] offset:-2048 sc1
    v_exp_f32 v210, v210
    v_exp_f32 v211, v211
    v_mfma_f32_32x32x16_bf16 v[192:207], v[44:47], v[20:23], 0
    global_load_dwordx4 v[72:75], v8, s[52:53] offset:-2048 sc1
    v_exp_f32 v212, v212
    v_exp_f32 v213, v213
    v_exp_f32 v214, v214
    v_mfma_f32_32x32x16_bf16 v[112:127], v[88:91], v[76:79], v[112:127]
    global_load_dwordx4 v[60:63], v8, s[46:47] offset:-2048 sc1
    v_exp_f32 v215, v215
    v_exp_f32 v216, v216
    v_exp_f32 v217, v217
    v_mfma_f32_32x32x8_bf16 v[192:207], v[34:35], v[26:27], v[192:207]
    s_add_u32 m0, s24, 2048
    s_nop 0
    global_load_lds_dwordx4 v8, s[36:37] offset:0 sc1
    v_exp_f32 v218, v218
    v_exp_f32 v219, v219
    v_exp_f32 v220, v220
    v_mfma_f32_32x32x16_bf16 v[128:143], v[92:95], v[76:79], v[128:143]
    v_exp_f32 v221, v221
    v_exp_f32 v222, v222
    v_exp_f32 v223, v223
    v_smfmac_f32_32x32x32_bf16 v[240:255], v[48:51], v[208:215], v9
    s_waitcnt vmcnt(25) lgkmcnt(0)
    s_barrier
    s_setprio 3
    v_exp_f32 v176, v176
    v_exp_f32 v177, v177
    v_smfmac_f32_32x32x32_bf16 v[240:255], v[52:55], v[216:223], v9
    ds_read_b128 v[52:55], v7 offset:0
    v_exp_f32 v178, v178
    v_exp_f32 v179, v179
    v_exp_f32 v180, v180
    v_mfma_f32_32x32x16_bf16 v[208:223], v[28:31], v[16:19], 0
    ds_read_b128 v[44:47], v4 offset:0
    v_exp_f32 v181, v181
    v_exp_f32 v182, v182
    v_exp_f32 v183, v183
    v_mfma_f32_32x32x8_bf16 v[208:223], v[32:33], v[24:25], v[208:223]
    ds_read_b64 v[34:35], v5 offset:0
    v_exp_f32 v184, v184
    v_exp_f32 v185, v185
    v_exp_f32 v186, v186
    v_exp_f32 v187, v187
    v_mfma_f32_32x32x16_bf16 v[144:159], v[84:87], v[80:83], v[144:159]
    ds_read_b128 v[48:51], v6 offset:0
    v_exp_f32 v188, v188
    v_exp_f32 v189, v189
    v_exp_f32 v190, v190
    v_smfmac_f32_32x32x32_bf16 v[224:239], v[36:39], v[176:183], v9
    v_exp_f32 v191, v191
    v_exp_f32 v192, v192
    v_exp_f32 v193, v193
    v_smfmac_f32_32x32x32_bf16 v[224:239], v[40:43], v[184:191], v9
    s_add_u32 m0, s72, 41728
    s_add_u32 s74, s74, 10240
    s_addc_u32 s75, s75, 0
    global_load_lds_dwordx4 v8, s[74:75] sc1
    v_exp_f32 v194, v194
    v_exp_f32 v195, v195
    v_mfma_f32_32x32x16_bf16 v[176:191], v[28:31], v[20:23], 0
    global_load_lds_dwordx4 v8, s[74:75] offset:1024 sc1
    v_exp_f32 v196, v196
    v_exp_f32 v197, v197
    v_exp_f32 v198, v198
    v_mfma_f32_32x32x16_bf16 v[160:175], v[88:91], v[80:83], v[160:175]
    s_mov_b64 exec, s[64:65]
    global_load_lds_dwordx4 v8, s[74:75] offset:2048 sc1
    s_mov_b64 exec, -1
    v_exp_f32 v199, v199
    v_exp_f32 v200, v200
    v_exp_f32 v201, v201
    v_mfma_f32_32x32x8_bf16 v[176:191], v[32:33], v[26:27], v[176:191]
    v_exp_f32 v202, v202
    v_exp_f32 v203, v203
    v_exp_f32 v204, v204
    s_waitcnt vmcnt(4)
    v_mfma_f32_32x32x16_bf16 v[96:111], v[64:67], v[56:59], v[96:111]
    global_load_dwordx4 v[76:79], v8, s[44:45] offset:-1024 sc1
    v_exp_f32 v205, v205
    v_exp_f32 v206, v206
    v_exp_f32 v207, v207
    v_smfmac_f32_32x32x32_bf16 v[240:255], v[36:39], v[192:199], v9
    global_load_dwordx4 v[84:87], v8, s[48:49] offset:-1024 sc1
    s_waitcnt lgkmcnt(0)
    s_setprio 2
    v_exp_f32 v208, v208
    v_exp_f32 v209, v209
    v_smfmac_f32_32x32x32_bf16 v[240:255], v[40:43], v[200:207], v9
    ds_read_b128 v[40:43], v7 offset:2608
    global_load_dwordx4 v[88:91], v8, s[50:51] offset:-1024 sc1
    v_exp_f32 v210, v210
    v_exp_f32 v211, v211
    v_mfma_f32_32x32x16_bf16 v[192:207], v[44:47], v[16:19], 0
    ds_read_b128 v[28:31], v4 offset:2608
    global_load_dwordx4 v[92:95], v8, s[52:53] offset:-1024 sc1
    v_exp_f32 v212, v212
    v_exp_f32 v213, v213
    v_exp_f32 v214, v214
    v_mfma_f32_32x32x16_bf16 v[112:127], v[68:71], v[56:59], v[112:127]
    ds_read_b64 v[32:33], v5 offset:2608
    global_load_dwordx4 v[80:83], v8, s[46:47] offset:-1024 sc1
    v_exp_f32 v215, v215
    v_exp_f32 v216, v216
    v_exp_f32 v217, v217
    v_mfma_f32_32x32x8_bf16 v[192:207], v[34:35], v[24:25], v[192:207]
    ds_read_b128 v[36:39], v6 offset:2608
    v_exp_f32 v218, v218
    v_exp_f32 v219, v219
    v_exp_f32 v220, v220
    v_mfma_f32_32x32x16_bf16 v[128:143], v[72:75], v[56:59], v[128:143]
    v_exp_f32 v221, v221
    v_exp_f32 v222, v222
    v_exp_f32 v223, v223
    v_smfmac_f32_32x32x32_bf16 v[224:239], v[48:51], v[208:215], v9
    v_exp_f32 v176, v176
    v_exp_f32 v177, v177
    v_smfmac_f32_32x32x32_bf16 v[224:239], v[52:55], v[216:223], v9
    s_add_u32 m0, s24, 2048
    s_nop 0
    global_load_lds_dwordx4 v8, s[12:13] offset:1024 sc1
    v_exp_f32 v178, v178
    v_exp_f32 v179, v179
    v_exp_f32 v180, v180
    v_mfma_f32_32x32x16_bf16 v[208:223], v[44:47], v[20:23], 0
    v_exp_f32 v181, v181
    v_exp_f32 v182, v182
    v_exp_f32 v183, v183
    v_mfma_f32_32x32x8_bf16 v[208:223], v[34:35], v[26:27], v[208:223]
    v_exp_f32 v184, v184
    v_exp_f32 v185, v185
    v_exp_f32 v186, v186
    v_exp_f32 v187, v187
    v_mfma_f32_32x32x16_bf16 v[144:159], v[64:67], v[60:63], v[144:159]
    v_exp_f32 v188, v188
    v_exp_f32 v189, v189
    v_exp_f32 v190, v190
    v_smfmac_f32_32x32x32_bf16 v[240:255], v[48:51], v[176:183], v9
    v_exp_f32 v191, v191
    s_waitcnt lgkmcnt(0)
    s_setprio 1
    v_exp_f32 v192, v192
    v_exp_f32 v193, v193
    v_smfmac_f32_32x32x32_bf16 v[240:255], v[52:55], v[184:191], v9
    ds_read_b128 v[52:55], v7 offset:5216
    v_exp_f32 v194, v194
    v_exp_f32 v195, v195
    v_mfma_f32_32x32x16_bf16 v[176:191], v[28:31], v[16:19], 0
    ds_read_b128 v[44:47], v4 offset:5216
    v_exp_f32 v196, v196
    v_exp_f32 v197, v197
    v_exp_f32 v198, v198
    v_mfma_f32_32x32x16_bf16 v[160:175], v[68:71], v[60:63], v[160:175]
    ds_read_b64 v[34:35], v5 offset:5216
    v_exp_f32 v199, v199
    v_exp_f32 v200, v200
    v_exp_f32 v201, v201
    v_mfma_f32_32x32x8_bf16 v[176:191], v[32:33], v[24:25], v[176:191]
    ds_read_b128 v[48:51], v6 offset:5216
    v_exp_f32 v202, v202
    v_exp_f32 v203, v203
    v_exp_f32 v204, v204
    s_waitcnt vmcnt(1)
    v_mfma_f32_32x32x16_bf16 v[96:111], v[84:87], v[76:79], v[96:111]
    global_load_dwordx4 v[56:59], v8, s[44:45] offset:0 sc1
    v_exp_f32 v205, v205
    v_exp_f32 v206, v206
    v_exp_f32 v207, v207
    v_smfmac_f32_32x32x32_bf16 v[224:239], v[36:39], v[192:199], v9
    global_load_dwordx4 v[64:67], v8, s[48:49] offset:0 sc1
    v_exp_f32 v208, v208
    v_exp_f32 v209, v209
    v_smfmac_f32_32x32x32_bf16 v[224:239], v[40:43], v[200:207], v9
    global_load_dwordx4 v[68:71], v8, s[50:51] offset:0 sc1
    v_exp_f32 v210, v210
    v_exp_f32 v211, v211
    v_exp_f32 v212, v212
    v_mfma_f32_32x32x16_bf16 v[192:207], v[28:31], v[20:23], 0
    global_load_dwordx4 v[72:75], v8, s[52:53] offset:0 sc1
    v_exp_f32 v213, v213
    v_exp_f32 v214, v214
    v_exp_f32 v215, v215
    v_mfma_f32_32x32x8_bf16 v[192:207], v[32:33], v[26:27], v[192:207]
    global_load_dwordx4 v[60:63], v8, s[46:47] offset:0 sc1
    v_exp_f32 v216, v216
    v_exp_f32 v217, v217
    v_exp_f32 v218, v218
    v_exp_f32 v219, v219
    v_mfma_f32_32x32x16_bf16 v[112:127], v[88:91], v[76:79], v[112:127]
    s_add_u32 m0, s28, 97280
    s_nop 0
    global_load_lds_dwordx4 v8, s[14:15] offset:1024 sc1
    v_exp_f32 v220, v220
    v_exp_f32 v221, v221
    v_exp_f32 v222, v222
    v_smfmac_f32_32x32x32_bf16 v[240:255], v[36:39], v[208:215], v9
    v_exp_f32 v223, v223
    s_waitcnt lgkmcnt(0)
    s_setprio 0
    v_exp_f32 v176, v176
    v_exp_f32 v177, v177
    v_smfmac_f32_32x32x32_bf16 v[240:255], v[40:43], v[216:223], v9
    ds_read_b128 v[40:43], v7 offset:7824
    v_exp_f32 v178, v178
    v_exp_f32 v179, v179
    v_mfma_f32_32x32x16_bf16 v[208:223], v[44:47], v[16:19], 0
    ds_read_b128 v[28:31], v4 offset:7824
    v_exp_f32 v180, v180
    v_exp_f32 v181, v181
    v_exp_f32 v182, v182
    v_mfma_f32_32x32x16_bf16 v[128:143], v[92:95], v[76:79], v[128:143]
    ds_read_b64 v[32:33], v5 offset:7824
    v_exp_f32 v183, v183
    v_exp_f32 v184, v184
    v_exp_f32 v185, v185
    v_mfma_f32_32x32x8_bf16 v[208:223], v[34:35], v[24:25], v[208:223]
    ds_read_b128 v[36:39], v6 offset:7824
    v_exp_f32 v186, v186
    v_exp_f32 v187, v187
    v_exp_f32 v188, v188
    v_mfma_f32_32x32x16_bf16 v[144:159], v[84:87], v[80:83], v[144:159]
    v_exp_f32 v189, v189
    v_exp_f32 v190, v190
    v_exp_f32 v191, v191
    v_smfmac_f32_32x32x32_bf16 v[224:239], v[48:51], v[176:183], v9
    v_exp_f32 v192, v192
    v_exp_f32 v193, v193
    v_smfmac_f32_32x32x32_bf16 v[224:239], v[52:55], v[184:191], v9
    s_add_u32 m0, s28, 98304
    s_nop 0
    global_load_lds_dwordx4 v8, s[36:37] offset:1024 sc1
    v_exp_f32 v194, v194
    v_exp_f32 v195, v195
    v_mfma_f32_32x32x16_bf16 v[176:191], v[44:47], v[20:23], 0
    v_exp_f32 v196, v196
    v_exp_f32 v197, v197
    v_exp_f32 v198, v198
    v_mfma_f32_32x32x16_bf16 v[160:175], v[88:91], v[80:83], v[160:175]
    v_exp_f32 v199, v199
    v_exp_f32 v200, v200
    v_exp_f32 v201, v201
    v_mfma_f32_32x32x8_bf16 v[176:191], v[34:35], v[26:27], v[176:191]
    v_exp_f32 v202, v202
    v_exp_f32 v203, v203
    v_exp_f32 v204, v204
    s_waitcnt vmcnt(2)
    v_mfma_f32_32x32x16_bf16 v[96:111], v[64:67], v[56:59], v[96:111]
    global_load_dwordx4 v[76:79], v8, s[44:45] offset:1024 sc1
    v_exp_f32 v205, v205
    v_exp_f32 v206, v206
    v_exp_f32 v207, v207
    v_smfmac_f32_32x32x32_bf16 v[240:255], v[48:51], v[192:199], v9
    global_load_dwordx4 v[84:87], v8, s[48:49] offset:1024 sc1
    s_waitcnt vmcnt(31) lgkmcnt(0)
    s_barrier
    s_setprio 3
    v_exp_f32 v208, v208
    v_exp_f32 v209, v209
    v_smfmac_f32_32x32x32_bf16 v[240:255], v[52:55], v[200:207], v9
    ds_read_b128 v[52:55], v7 offset:20864
    global_load_dwordx4 v[88:91], v8, s[50:51] offset:1024 sc1
    v_exp_f32 v210, v210
    v_exp_f32 v211, v211
    v_exp_f32 v212, v212
    v_mfma_f32_32x32x16_bf16 v[192:207], v[28:31], v[16:19], 0
    ds_read_b128 v[44:47], v4 offset:20864
    global_load_dwordx4 v[92:95], v8, s[52:53] offset:1024 sc1
    v_exp_f32 v213, v213
    v_exp_f32 v214, v214
    v_exp_f32 v215, v215
    v_mfma_f32_32x32x8_bf16 v[192:207], v[32:33], v[24:25], v[192:207]
    ds_read_b64 v[34:35], v5 offset:20864
    global_load_dwordx4 v[80:83], v8, s[46:47] offset:1024 sc1
    v_exp_f32 v216, v216
    v_exp_f32 v217, v217
    v_exp_f32 v218, v218
    v_exp_f32 v219, v219
    v_mfma_f32_32x32x16_bf16 v[112:127], v[68:71], v[56:59], v[112:127]
    ds_read_b128 v[48:51], v6 offset:20864
    v_exp_f32 v220, v220
    v_exp_f32 v221, v221
    v_exp_f32 v222, v222
    v_smfmac_f32_32x32x32_bf16 v[224:239], v[36:39], v[208:215], v9
    v_exp_f32 v223, v223
    v_exp_f32 v176, v176
    v_exp_f32 v177, v177
    v_smfmac_f32_32x32x32_bf16 v[224:239], v[40:43], v[216:223], v9
    s_add_u32 m0, s72, 0
    s_add_u32 s74, s74, 10240
    s_addc_u32 s75, s75, 0
    global_load_lds_dwordx4 v8, s[74:75] sc1
    v_exp_f32 v178, v178
    v_exp_f32 v179, v179
    v_mfma_f32_32x32x16_bf16 v[208:223], v[28:31], v[20:23], 0
    global_load_lds_dwordx4 v8, s[74:75] offset:1024 sc1
    v_exp_f32 v180, v180
    v_exp_f32 v181, v181
    v_exp_f32 v182, v182
    v_mfma_f32_32x32x16_bf16 v[128:143], v[72:75], v[56:59], v[128:143]
    s_mov_b64 exec, s[64:65]
    global_load_lds_dwordx4 v8, s[74:75] offset:2048 sc1
    s_mov_b64 exec, -1
    v_exp_f32 v183, v183
    v_exp_f32 v184, v184
    v_exp_f32 v185, v185
    v_mfma_f32_32x32x8_bf16 v[208:223], v[32:33], v[26:27], v[208:223]
    v_exp_f32 v186, v186
    v_exp_f32 v187, v187
    v_exp_f32 v188, v188
    v_mfma_f32_32x32x16_bf16 v[144:159], v[64:67], v[60:63], v[144:159]
    v_exp_f32 v189, v189
    v_exp_f32 v190, v190
    v_exp_f32 v191, v191
    v_smfmac_f32_32x32x32_bf16 v[240:255], v[36:39], v[176:183], v9
    s_waitcnt lgkmcnt(0)
    s_setprio 2
    v_exp_f32 v192, v192
    v_exp_f32 v193, v193
    v_smfmac_f32_32x32x32_bf16 v[240:255], v[40:43], v[184:191], v9
    ds_read_b128 v[40:43], v7 offset:23472
    v_exp_f32 v194, v194
    v_exp_f32 v195, v195
    v_mfma_f32_32x32x16_bf16 v[176:191], v[44:47], v[16:19], 0
    ds_read_b128 v[28:31], v4 offset:23472
    v_exp_f32 v196, v196
    v_exp_f32 v197, v197
    v_exp_f32 v198, v198
    v_mfma_f32_32x32x16_bf16 v[160:175], v[68:71], v[60:63], v[160:175]
    ds_read_b64 v[32:33], v5 offset:23472
    v_exp_f32 v199, v199
    v_exp_f32 v200, v200
    v_exp_f32 v201, v201
    v_mfma_f32_32x32x8_bf16 v[176:191], v[34:35], v[24:25], v[176:191]
    ds_read_b128 v[36:39], v6 offset:23472
    v_exp_f32 v202, v202
    v_exp_f32 v203, v203
    v_exp_f32 v204, v204
    s_waitcnt vmcnt(3)
    v_mfma_f32_32x32x16_bf16 v[96:111], v[84:87], v[76:79], v[96:111]
    global_load_dwordx4 v[56:59], v8, s[44:45] offset:2048 sc1
    v_exp_f32 v205, v205
    v_exp_f32 v206, v206
    v_exp_f32 v207, v207
    v_smfmac_f32_32x32x32_bf16 v[224:239], v[48:51], v[192:199], v9
    global_load_dwordx4 v[64:67], v8, s[48:49] offset:2048 sc1
    v_exp_f32 v208, v208
    v_exp_f32 v209, v209
    v_smfmac_f32_32x32x32_bf16 v[224:239], v[52:55], v[200:207], v9
    global_load_dwordx4 v[68:71], v8, s[50:51] offset:2048 sc1
    v_exp_f32 v210, v210
    v_exp_f32 v211, v211
    v_exp_f32 v212, v212
    v_mfma_f32_32x32x16_bf16 v[192:207], v[44:47], v[20:23], 0
    global_load_dwordx4 v[72:75], v8, s[52:53] offset:2048 sc1
    v_exp_f32 v213, v213
    v_exp_f32 v214, v214
    v_exp_f32 v215, v215
    v_mfma_f32_32x32x8_bf16 v[192:207], v[34:35], v[26:27], v[192:207]
    global_load_dwordx4 v[60:63], v8, s[46:47] offset:2048 sc1
    v_exp_f32 v216, v216
    v_exp_f32 v217, v217
    v_exp_f32 v218, v218
    v_exp_f32 v219, v219
    v_mfma_f32_32x32x16_bf16 v[112:127], v[88:91], v[76:79], v[112:127]
    s_add_u32 m0, s28, 98304
    s_nop 0
    global_load_lds_dwordx4 v8, s[12:13] offset:2048 sc1
    v_exp_f32 v220, v220
    v_exp_f32 v221, v221
    v_exp_f32 v222, v222
    v_smfmac_f32_32x32x32_bf16 v[240:255], v[48:51], v[208:215], v9
    v_exp_f32 v223, v223
    s_waitcnt lgkmcnt(0)
    s_setprio 1
    v_exp_f32 v176, v176
    v_exp_f32 v177, v177
    v_smfmac_f32_32x32x32_bf16 v[240:255], v[52:55], v[216:223], v9
    ds_read_b128 v[52:55], v7 offset:26080
    v_exp_f32 v178, v178
    v_exp_f32 v179, v179
    v_mfma_f32_32x32x16_bf16 v[208:223], v[28:31], v[16:19], 0
    ds_read_b128 v[44:47], v4 offset:26080
    v_exp_f32 v180, v180
    v_exp_f32 v181, v181
    v_exp_f32 v182, v182
    v_mfma_f32_32x32x16_bf16 v[128:143], v[92:95], v[76:79], v[128:143]
    ds_read_b64 v[34:35], v5 offset:26080
    v_exp_f32 v183, v183
    v_exp_f32 v184, v184
    v_exp_f32 v185, v185
    v_mfma_f32_32x32x8_bf16 v[208:223], v[32:33], v[24:25], v[208:223]
    ds_read_b128 v[48:51], v6 offset:26080
    v_exp_f32 v186, v186
    v_exp_f32 v187, v187
    v_exp_f32 v188, v188
    v_mfma_f32_32x32x16_bf16 v[144:159], v[84:87], v[80:83], v[144:159]
    v_exp_f32 v189, v189
    v_exp_f32 v190, v190
    v_exp_f32 v191, v191
    v_smfmac_f32_32x32x32_bf16 v[224:239], v[36:39], v[176:183], v9
    v_exp_f32 v192, v192
    v_exp_f32 v193, v193
    v_smfmac_f32_32x32x32_bf16 v[224:239], v[40:43], v[184:191], v9
    s_add_u32 m0, s28, 99328
    s_nop 0
    global_load_lds_dwordx4 v8, s[14:15] offset:2048 sc1
    v_exp_f32 v194, v194
    v_exp_f32 v195, v195
    v_exp_f32 v196, v196
    v_mfma_f32_32x32x16_bf16 v[176:191], v[28:31], v[20:23], 0
    v_exp_f32 v197, v197
    v_exp_f32 v198, v198
    v_exp_f32 v199, v199
    v_mfma_f32_32x32x8_bf16 v[176:191], v[32:33], v[26:27], v[176:191]
    v_exp_f32 v200, v200
    v_exp_f32 v201, v201
    v_exp_f32 v202, v202
    v_exp_f32 v203, v203
    v_mfma_f32_32x32x16_bf16 v[160:175], v[88:91], v[80:83], v[160:175]
    v_exp_f32 v204, v204
    v_exp_f32 v205, v205
    v_exp_f32 v206, v206
    v_smfmac_f32_32x32x32_bf16 v[240:255], v[36:39], v[192:199], v9
    v_exp_f32 v207, v207
    s_waitcnt lgkmcnt(0)
    s_setprio 0
    v_exp_f32 v208, v208
    v_exp_f32 v209, v209
    v_smfmac_f32_32x32x32_bf16 v[240:255], v[40:43], v[200:207], v9
    ds_read_b128 v[40:43], v7 offset:28688
    v_exp_f32 v210, v210
    v_exp_f32 v211, v211
    v_mfma_f32_32x32x16_bf16 v[192:207], v[44:47], v[16:19], 0
    ds_read_b128 v[28:31], v4 offset:28688
    v_exp_f32 v212, v212
    v_exp_f32 v213, v213
    v_exp_f32 v214, v214
    s_waitcnt vmcnt(2)
    v_mfma_f32_32x32x16_bf16 v[96:111], v[64:67], v[56:59], v[96:111]
    ds_read_b64 v[32:33], v5 offset:28688
    global_load_dwordx4 v[76:79], v8, s[44:45] offset:3072 sc1
    s_add_u32 s44, s44, 8192
    s_addc_u32 s45, s45, 0
    v_exp_f32 v215, v215
    v_exp_f32 v216, v216
    v_exp_f32 v217, v217
    v_mfma_f32_32x32x8_bf16 v[192:207], v[34:35], v[24:25], v[192:207]
    ds_read_b128 v[36:39], v6 offset:28688
    global_load_dwordx4 v[84:87], v8, s[48:49] offset:3072 sc1
    s_add_u32 s48, s48, 8192
    s_addc_u32 s49, s49, 0
    v_exp_f32 v218, v218
    v_exp_f32 v219, v219
    v_exp_f32 v220, v220
    v_mfma_f32_32x32x16_bf16 v[112:127], v[68:71], v[56:59], v[112:127]
    global_load_dwordx4 v[88:91], v8, s[50:51] offset:3072 sc1
    s_add_u32 s50, s50, 8192
    s_addc_u32 s51, s51, 0
    v_exp_f32 v221, v221
    v_exp_f32 v222, v222
    v_exp_f32 v223, v223
    v_smfmac_f32_32x32x32_bf16 v[224:239], v[48:51], v[208:215], v9
    global_load_dwordx4 v[92:95], v8, s[52:53] offset:3072 sc1
    s_add_u32 s52, s52, 8192
    s_addc_u32 s53, s53, 0
    v_exp_f32 v176, v176
    v_exp_f32 v177, v177
    v_smfmac_f32_32x32x32_bf16 v[224:239], v[52:55], v[216:223], v9
    global_load_dwordx4 v[80:83], v8, s[46:47] offset:3072 sc1
    s_add_u32 s46, s46, 8192
    s_addc_u32 s47, s47, 0
    v_exp_f32 v178, v178
    v_exp_f32 v179, v179
    v_mfma_f32_32x32x16_bf16 v[208:223], v[44:47], v[20:23], 0
    s_add_u32 m0, s28, 100352
    s_nop 0
    global_load_lds_dwordx4 v8, s[36:37] offset:2048 sc1
    v_exp_f32 v180, v180
    v_exp_f32 v181, v181
    v_exp_f32 v182, v182
    v_mfma_f32_32x32x16_bf16 v[128:143], v[72:75], v[56:59], v[128:143]
    v_exp_f32 v183, v183
    v_exp_f32 v184, v184
    v_exp_f32 v185, v185
    v_mfma_f32_32x32x8_bf16 v[208:223], v[34:35], v[26:27], v[208:223]
    v_exp_f32 v186, v186
    v_exp_f32 v187, v187
    v_exp_f32 v188, v188
    v_mfma_f32_32x32x16_bf16 v[144:159], v[64:67], v[60:63], v[144:159]
    v_exp_f32 v189, v189
    v_exp_f32 v190, v190
    v_exp_f32 v191, v191
    v_smfmac_f32_32x32x32_bf16 v[240:255], v[48:51], v[176:183], v9
    s_waitcnt vmcnt(34) lgkmcnt(0)
    s_barrier
    s_setprio 3
    v_exp_f32 v192, v192
    v_exp_f32 v193, v193
    v_smfmac_f32_32x32x32_bf16 v[240:255], v[52:55], v[184:191], v9
    ds_read_b128 v[52:55], v7 offset:41728
    v_exp_f32 v194, v194
    v_exp_f32 v195, v195
    v_exp_f32 v196, v196
    v_mfma_f32_32x32x16_bf16 v[176:191], v[28:31], v[16:19], 0
    ds_read_b128 v[44:47], v4 offset:41728
    v_exp_f32 v197, v197
    v_exp_f32 v198, v198
    v_exp_f32 v199, v199
    v_mfma_f32_32x32x8_bf16 v[176:191], v[32:33], v[24:25], v[176:191]
    ds_read_b64 v[34:35], v5 offset:41728
    v_exp_f32 v200, v200
    v_exp_f32 v201, v201
    v_exp_f32 v202, v202
    v_exp_f32 v203, v203
    v_mfma_f32_32x32x16_bf16 v[160:175], v[68:71], v[60:63], v[160:175]
    ds_read_b128 v[48:51], v6 offset:41728
    v_exp_f32 v204, v204
    v_exp_f32 v205, v205
    v_exp_f32 v206, v206
    v_smfmac_f32_32x32x32_bf16 v[224:239], v[36:39], v[192:199], v9
    v_exp_f32 v207, v207
    v_exp_f32 v208, v208
    v_exp_f32 v209, v209
    v_smfmac_f32_32x32x32_bf16 v[224:239], v[40:43], v[200:207], v9
    s_add_u32 m0, s72, 20864
    s_add_u32 s74, s74, 10240
    s_addc_u32 s75, s75, 0
    global_load_lds_dwordx4 v8, s[74:75] sc1
    v_exp_f32 v210, v210
    v_exp_f32 v211, v211
    v_mfma_f32_32x32x16_bf16 v[192:207], v[28:31], v[20:23], 0
    global_load_lds_dwordx4 v8, s[74:75] offset:1024 sc1
    v_exp_f32 v212, v212
    v_exp_f32 v213, v213
    v_exp_f32 v214, v214
    s_waitcnt vmcnt(3)
    v_mfma_f32_32x32x16_bf16 v[96:111], v[84:87], v[76:79], v[96:111]
    s_mov_b64 exec, s[64:65]
    global_load_lds_dwordx4 v8, s[74:75] offset:2048 sc1
    s_mov_b64 exec, -1
    v_exp_f32 v215, v215
    v_exp_f32 v216, v216
    v_exp_f32 v217, v217
    v_mfma_f32_32x32x8_bf16 v[192:207], v[32:33], v[26:27], v[192:207]
    global_load_dwordx4 v[56:59], v8, s[44:45] offset:-4096 sc1
    v_exp_f32 v218, v218
    v_exp_f32 v219, v219
    v_exp_f32 v220, v220
    v_mfma_f32_32x32x16_bf16 v[112:127], v[88:91], v[76:79], v[112:127]
    global_load_dwordx4 v[64:67], v8, s[48:49] offset:-4096 sc1
    v_exp_f32 v221, v221
    v_exp_f32 v222, v222
    v_exp_f32 v223, v223
    v_smfmac_f32_32x32x32_bf16 v[240:255], v[36:39], v[208:215], v9
    global_load_dwordx4 v[68:71], v8, s[50:51] offset:-4096 sc1
    s_waitcnt lgkmcnt(0)
    s_setprio 2
    v_exp_f32 v176, v176
    v_exp_f32 v177, v177
    v_smfmac_f32_32x32x32_bf16 v[240:255], v[40:43], v[216:223], v9
    ds_read_b128 v[40:43], v7 offset:44336
    global_load_dwordx4 v[72:75], v8, s[52:53] offset:-4096 sc1
    v_exp_f32 v178, v178
    v_exp_f32 v179, v179
    v_mfma_f32_32x32x16_bf16 v[208:223], v[44:47], v[16:19], 0
    ds_read_b128 v[28:31], v4 offset:44336
    global_load_dwordx4 v[60:63], v8, s[46:47] offset:-4096 sc1
    v_exp_f32 v180, v180
    v_exp_f32 v181, v181
    v_exp_f32 v182, v182
    v_mfma_f32_32x32x16_bf16 v[128:143], v[92:95], v[76:79], v[128:143]
    ds_read_b64 v[32:33], v5 offset:44336
    v_exp_f32 v183, v183
    v_exp_f32 v184, v184
    v_exp_f32 v185, v185
    v_mfma_f32_32x32x8_bf16 v[208:223], v[34:35], v[24:25], v[208:223]
    ds_read_b128 v[36:39], v6 offset:44336
    v_exp_f32 v186, v186
    v_exp_f32 v187, v187
    v_exp_f32 v188, v188
    v_mfma_f32_32x32x16_bf16 v[144:159], v[84:87], v[80:83], v[144:159]
    v_exp_f32 v189, v189
    v_exp_f32 v190, v190
    v_exp_f32 v191, v191
    v_smfmac_f32_32x32x32_bf16 v[224:239], v[48:51], v[176:183], v9
    v_exp_f32 v192, v192
    v_exp_f32 v193, v193
    v_smfmac_f32_32x32x32_bf16 v[224:239], v[52:55], v[184:191], v9
    s_add_u32 m0, s28, 100352
    s_nop 0
    global_load_lds_dwordx4 v8, s[12:13] offset:3072 sc1
    v_exp_f32 v194, v194
    v_exp_f32 v195, v195
    v_exp_f32 v196, v196
    v_mfma_f32_32x32x16_bf16 v[176:191], v[44:47], v[20:23], 0
    v_exp_f32 v197, v197
    v_exp_f32 v198, v198
    v_exp_f32 v199, v199
    v_mfma_f32_32x32x8_bf16 v[176:191], v[34:35], v[26:27], v[176:191]
    v_exp_f32 v200, v200
    v_exp_f32 v201, v201
    v_exp_f32 v202, v202
    v_exp_f32 v203, v203
    v_mfma_f32_32x32x16_bf16 v[160:175], v[88:91], v[80:83], v[160:175]
    v_exp_f32 v204, v204
    v_exp_f32 v205, v205
    v_exp_f32 v206, v206
    v_smfmac_f32_32x32x32_bf16 v[240:255], v[48:51], v[192:199], v9
    v_exp_f32 v207, v207
    s_waitcnt lgkmcnt(0)
    s_setprio 1
    v_exp_f32 v208, v208
    v_exp_f32 v209, v209
    v_smfmac_f32_32x32x32_bf16 v[240:255], v[52:55], v[200:207], v9
    ds_read_b128 v[52:55], v7 offset:46944
    v_exp_f32 v210, v210
    v_exp_f32 v211, v211
    v_mfma_f32_32x32x16_bf16 v[192:207], v[28:31], v[16:19], 0
    ds_read_b128 v[44:47], v4 offset:46944
    v_exp_f32 v212, v212
    v_exp_f32 v213, v213
    v_exp_f32 v214, v214
    s_waitcnt vmcnt(1)
    v_mfma_f32_32x32x16_bf16 v[96:111], v[64:67], v[56:59], v[96:111]
    ds_read_b64 v[34:35], v5 offset:46944
    global_load_dwordx4 v[76:79], v8, s[44:45] offset:-3072 sc1
    v_exp_f32 v215, v215
    v_exp_f32 v216, v216
    v_exp_f32 v217, v217
    v_mfma_f32_32x32x8_bf16 v[192:207], v[32:33], v[24:25], v[192:207]
    ds_read_b128 v[48:51], v6 offset:46944
    global_load_dwordx4 v[84:87], v8, s[48:49] offset:-3072 sc1
    v_exp_f32 v218, v218
    v_exp_f32 v219, v219
    v_exp_f32 v220, v220
    v_mfma_f32_32x32x16_bf16 v[112:127], v[68:71], v[56:59], v[112:127]
    global_load_dwordx4 v[88:91], v8, s[50:51] offset:-3072 sc1
    v_exp_f32 v221, v221
    v_exp_f32 v222, v222
    v_exp_f32 v223, v223
    v_smfmac_f32_32x32x32_bf16 v[224:239], v[36:39], v[208:215], v9
    global_load_dwordx4 v[92:95], v8, s[52:53] offset:-3072 sc1
    v_exp_f32 v176, v176
    v_exp_f32 v177, v177
    v_smfmac_f32_32x32x32_bf16 v[224:239], v[40:43], v[216:223], v9
    global_load_dwordx4 v[80:83], v8, s[46:47] offset:-3072 sc1
    v_exp_f32 v178, v178
    v_exp_f32 v179, v179
    v_exp_f32 v180, v180
    v_mfma_f32_32x32x16_bf16 v[208:223], v[28:31], v[20:23], 0
    s_add_u32 m0, s28, 101376
    s_nop 0
    global_load_lds_dwordx4 v8, s[14:15] offset:3072 sc1
    v_exp_f32 v181, v181
    v_exp_f32 v182, v182
    v_exp_f32 v183, v183
    v_mfma_f32_32x32x8_bf16 v[208:223], v[32:33], v[26:27], v[208:223]
    v_exp_f32 v184, v184
    v_exp_f32 v185, v185
    v_exp_f32 v186, v186
    v_exp_f32 v187, v187
    v_mfma_f32_32x32x16_bf16 v[128:143], v[72:75], v[56:59], v[128:143]
    v_exp_f32 v188, v188
    v_exp_f32 v189, v189
    v_exp_f32 v190, v190
    v_smfmac_f32_32x32x32_bf16 v[240:255], v[36:39], v[176:183], v9
    v_exp_f32 v191, v191
    s_waitcnt lgkmcnt(0)
    s_setprio 0
    v_exp_f32 v192, v192
    v_exp_f32 v193, v193
    v_smfmac_f32_32x32x32_bf16 v[240:255], v[40:43], v[184:191], v9
    ds_read_b128 v[40:43], v7 offset:49552
    v_exp_f32 v194, v194
    v_exp_f32 v195, v195
    v_mfma_f32_32x32x16_bf16 v[176:191], v[44:47], v[16:19], 0
    ds_read_b128 v[28:31], v4 offset:49552
    v_exp_f32 v196, v196
    v_exp_f32 v197, v197
    v_exp_f32 v198, v198
    v_mfma_f32_32x32x16_bf16 v[144:159], v[64:67], v[60:63], v[144:159]
    ds_read_b64 v[32:33], v5 offset:49552
    v_exp_f32 v199, v199
    v_exp_f32 v200, v200
    v_exp_f32 v201, v201
    v_mfma_f32_32x32x8_bf16 v[176:191], v[34:35], v[24:25], v[176:191]
    ds_read_b128 v[36:39], v6 offset:49552
    v_exp_f32 v202, v202
    v_exp_f32 v203, v203
    v_exp_f32 v204, v204
    v_mfma_f32_32x32x16_bf16 v[160:175], v[68:71], v[60:63], v[160:175]
    v_exp_f32 v205, v205
    v_exp_f32 v206, v206
    v_exp_f32 v207, v207
    v_smfmac_f32_32x32x32_bf16 v[224:239], v[48:51], v[192:199], v9
    v_exp_f32 v208, v208
    v_exp_f32 v209, v209
    v_smfmac_f32_32x32x32_bf16 v[224:239], v[52:55], v[200:207], v9
    s_add_u32 m0, s28, 102400
    s_nop 0
    global_load_lds_dwordx4 v8, s[36:37] offset:3072 sc1
    v_exp_f32 v210, v210
    v_exp_f32 v211, v211
    v_mfma_f32_32x32x16_bf16 v[192:207], v[44:47], v[20:23], 0
    v_exp_f32 v212, v212
    v_exp_f32 v213, v213
    v_exp_f32 v214, v214
    s_waitcnt vmcnt(2)
    v_mfma_f32_32x32x16_bf16 v[96:111], v[84:87], v[76:79], v[96:111]
    global_load_dwordx4 v[56:59], v8, s[44:45] offset:-2048 sc1
    v_exp_f32 v215, v215
    v_exp_f32 v216, v216
    v_exp_f32 v217, v217
    v_mfma_f32_32x32x8_bf16 v[192:207], v[34:35], v[26:27], v[192:207]
    global_load_dwordx4 v[64:67], v8, s[48:49] offset:-2048 sc1
    v_exp_f32 v218, v218
    v_exp_f32 v219, v219
    v_exp_f32 v220, v220
    v_mfma_f32_32x32x16_bf16 v[112:127], v[88:91], v[76:79], v[112:127]
    global_load_dwordx4 v[68:71], v8, s[50:51] offset:-2048 sc1
    v_exp_f32 v221, v221
    v_exp_f32 v222, v222
    v_exp_f32 v223, v223
    v_smfmac_f32_32x32x32_bf16 v[240:255], v[48:51], v[208:215], v9
    global_load_dwordx4 v[72:75], v8, s[52:53] offset:-2048 sc1
    s_waitcnt vmcnt(33) lgkmcnt(0)
    s_barrier
    s_setprio 3
    v_exp_f32 v176, v176
    v_exp_f32 v177, v177
    v_smfmac_f32_32x32x32_bf16 v[240:255], v[52:55], v[216:223], v9
    ds_read_b128 v[52:55], v7 offset:0
    global_load_dwordx4 v[60:63], v8, s[46:47] offset:-2048 sc1
    v_exp_f32 v178, v178
    v_exp_f32 v179, v179
    v_exp_f32 v180, v180
    v_mfma_f32_32x32x16_bf16 v[208:223], v[28:31], v[16:19], 0
    ds_read_b128 v[44:47], v4 offset:0
    s_and_b32 s23, s3, 1
    s_lshl_b32 s23, s23, 13
    s_add_u32 s23, s23, L_tail-L_pc0
    v_lshl_add_u32 v3, v0, 7, s23
    v_min_u32 v3, L_tab-L_pc0, v3
    global_load_dword v13, v3, s[58:59]
    v_exp_f32 v181, v181
    v_exp_f32 v182, v182
    v_exp_f32 v183, v183
    v_mfma_f32_32x32x8_bf16 v[208:223], v[32:33], v[24:25], v[208:223]
    ds_read_b64 v[34:35], v5 offset:0
    v_exp_f32 v184, v184
    v_exp_f32 v185, v185
    v_exp_f32 v186, v186
    v_exp_f32 v187, v187
    v_mfma_f32_32x32x16_bf16 v[128:143], v[92:95], v[76:79], v[128:143]
    ds_read_b128 v[48:51], v6 offset:0
    v_exp_f32 v188, v188
    v_exp_f32 v189, v189
    v_exp_f32 v190, v190
    v_smfmac_f32_32x32x32_bf16 v[224:239], v[36:39], v[176:183], v9
    v_exp_f32 v191, v191
    v_exp_f32 v192, v192
    v_exp_f32 v193, v193
    v_smfmac_f32_32x32x32_bf16 v[224:239], v[40:43], v[184:191], v9
    s_add_u32 m0, s29, 74496
    s_add_u32 s12, s12, 4096
    s_addc_u32 s13, s13, 0
    global_load_lds_dwordx4 v8, s[12:13] offset:0 sc1
    v_exp_f32 v194, v194
    v_exp_f32 v195, v195
    v_mfma_f32_32x32x16_bf16 v[176:191], v[28:31], v[20:23], 0
    s_add_u32 m0, s29, 75520
    s_add_u32 s14, s14, 4096
    s_addc_u32 s15, s15, 0
    global_load_lds_dwordx4 v8, s[14:15] offset:0 sc1
    v_exp_f32 v196, v196
    v_exp_f32 v197, v197
    v_exp_f32 v198, v198
    v_mfma_f32_32x32x16_bf16 v[144:159], v[84:87], v[80:83], v[144:159]
    v_exp_f32 v199, v199
    v_exp_f32 v200, v200
    v_exp_f32 v201, v201
    v_mfma_f32_32x32x8_bf16 v[176:191], v[32:33], v[26:27], v[176:191]
    v_exp_f32 v202, v202
    v_exp_f32 v203, v203
    v_exp_f32 v204, v204
    v_mfma_f32_32x32x16_bf16 v[160:175], v[88:91], v[80:83], v[160:175]
    v_exp_f32 v205, v205
    v_exp_f32 v206, v206
    v_exp_f32 v207, v207
    v_smfmac_f32_32x32x32_bf16 v[240:255], v[36:39], v[192:199], v9
    s_waitcnt lgkmcnt(0)
    s_setprio 2
    v_exp_f32 v208, v208
    v_exp_f32 v209, v209
    v_smfmac_f32_32x32x32_bf16 v[240:255], v[40:43], v[200:207], v9
    ds_read_b128 v[40:43], v7 offset:2608
    v_exp_f32 v210, v210
    v_exp_f32 v211, v211
    v_mfma_f32_32x32x16_bf16 v[192:207], v[44:47], v[16:19], 0
    ds_read_b128 v[28:31], v4 offset:2608
    v_exp_f32 v212, v212
    v_exp_f32 v213, v213
    v_exp_f32 v214, v214
    s_waitcnt vmcnt(3)
    v_mfma_f32_32x32x16_bf16 v[96:111], v[64:67], v[56:59], v[96:111]
    ds_read_b64 v[32:33], v5 offset:2608
    global_load_dwordx4 v[76:79], v8, s[44:45] offset:-1024 sc1
    v_exp_f32 v215, v215
    v_exp_f32 v216, v216
    v_exp_f32 v217, v217
    v_mfma_f32_32x32x8_bf16 v[192:207], v[34:35], v[24:25], v[192:207]
    ds_read_b128 v[36:39], v6 offset:2608
    global_load_dwordx4 v[84:87], v8, s[48:49] offset:-1024 sc1
    v_exp_f32 v218, v218
    v_exp_f32 v219, v219
    v_exp_f32 v220, v220
    v_mfma_f32_32x32x16_bf16 v[112:127], v[68:71], v[56:59], v[112:127]
    global_load_dwordx4 v[88:91], v8, s[50:51] offset:-1024 sc1
    v_exp_f32 v221, v221
    v_exp_f32 v222, v222
    v_exp_f32 v223, v223
    v_smfmac_f32_32x32x32_bf16 v[224:239], v[48:51], v[208:215], v9
    global_load_dwordx4 v[92:95], v8, s[52:53] offset:-1024 sc1
    v_exp_f32 v176, v176
    v_exp_f32 v177, v177
    v_smfmac_f32_32x32x32_bf16 v[224:239], v[52:55], v[216:223], v9
    global_load_dwordx4 v[80:83], v8, s[46:47] offset:-1024 sc1
    v_exp_f32 v178, v178
    v_exp_f32 v179, v179
    v_exp_f32 v180, v180
    v_mfma_f32_32x32x16_bf16 v[208:223], v[44:47], v[20:23], 0
    v_exp_f32 v181, v181
    v_exp_f32 v182, v182
    v_exp_f32 v183, v183
    v_mfma_f32_32x32x8_bf16 v[208:223], v[34:35], v[26:27], v[208:223]
    v_exp_f32 v184, v184
    v_exp_f32 v185, v185
    v_exp_f32 v186, v186
    v_exp_f32 v187, v187
    v_mfma_f32_32x32x16_bf16 v[128:143], v[72:75], v[56:59], v[128:143]
    v_exp_f32 v188, v188
    v_exp_f32 v189, v189
    v_exp_f32 v190, v190
    v_smfmac_f32_32x32x32_bf16 v[240:255], v[48:51], v[176:183], v9
    v_exp_f32 v191, v191
    s_waitcnt lgkmcnt(0)
    s_setprio 1
    v_exp_f32 v192, v192
    v_exp_f32 v193, v193
    v_smfmac_f32_32x32x32_bf16 v[240:255], v[52:55], v[184:191], v9
    ds_read_b128 v[52:55], v7 offset:5216
    v_exp_f32 v194, v194
    v_exp_f32 v195, v195
    v_mfma_f32_32x32x16_bf16 v[176:191], v[28:31], v[16:19], 0
    ds_read_b128 v[44:47], v4 offset:5216
    v_exp_f32 v196, v196
    v_exp_f32 v197, v197
    v_exp_f32 v198, v198
    v_mfma_f32_32x32x16_bf16 v[144:159], v[64:67], v[60:63], v[144:159]
    ds_read_b64 v[34:35], v5 offset:5216
    v_exp_f32 v199, v199
    v_exp_f32 v200, v200
    v_exp_f32 v201, v201
    v_mfma_f32_32x32x8_bf16 v[176:191], v[32:33], v[24:25], v[176:191]
    ds_read_b128 v[48:51], v6 offset:5216
    v_exp_f32 v202, v202
    v_exp_f32 v203, v203
    v_exp_f32 v204, v204
    v_mfma_f32_32x32x16_bf16 v[160:175], v[68:71], v[60:63], v[160:175]
    v_exp_f32 v205, v205
    v_exp_f32 v206, v206
    v_exp_f32 v207, v207
    v_smfmac_f32_32x32x32_bf16 v[224:239], v[36:39], v[192:199], v9
    v_exp_f32 v208, v208
    v_exp_f32 v209, v209
    v_smfmac_f32_32x32x32_bf16 v[224:239], v[40:43], v[200:207], v9
    v_exp_f32 v210, v210
    v_exp_f32 v211, v211
    v_exp_f32 v212, v212
    v_mfma_f32_32x32x16_bf16 v[192:207], v[28:31], v[20:23], 0
    v_exp_f32 v213, v213
    v_exp_f32 v214, v214
    v_exp_f32 v215, v215
    v_mfma_f32_32x32x8_bf16 v[192:207], v[32:33], v[26:27], v[192:207]
    v_exp_f32 v216, v216
    v_exp_f32 v217, v217
    v_exp_f32 v218, v218
    v_exp_f32 v219, v219
    s_waitcnt vmcnt(0)
    v_mfma_f32_32x32x16_bf16 v[96:111], v[84:87], v[76:79], v[96:111]
    global_load_dwordx4 v[56:59], v8, s[44:45] offset:0 sc1
    v_exp_f32 v220, v220
    v_exp_f32 v221, v221
    v_exp_f32 v222, v222
    v_smfmac_f32_32x32x32_bf16 v[240:255], v[36:39], v[208:215], v9
    global_load_dwordx4 v[64:67], v8, s[48:49] offset:0 sc1
    v_exp_f32 v223, v223
    s_waitcnt lgkmcnt(0)
    s_setprio 0
    v_exp_f32 v176, v176
    v_exp_f32 v177, v177
    v_smfmac_f32_32x32x32_bf16 v[240:255], v[40:43], v[216:223], v9
    ds_read_b128 v[40:43], v7 offset:7824
    global_load_dwordx4 v[68:71], v8, s[50:51] offset:0 sc1
    v_exp_f32 v178, v178
    v_exp_f32 v179, v179
    v_mfma_f32_32x32x16_bf16 v[208:223], v[44:47], v[16:19], 0
    ds_read_b128 v[28:31], v4 offset:7824
    global_load_dwordx4 v[72:75], v8, s[52:53] offset:0 sc1
    v_exp_f32 v180, v180
    v_exp_f32 v181, v181
    v_exp_f32 v182, v182
    v_mfma_f32_32x32x16_bf16 v[112:127], v[88:91], v[76:79], v[112:127]
    ds_read_b64 v[32:33], v5 offset:7824
    global_load_dwordx4 v[60:63], v8, s[46:47] offset:0 sc1
    v_exp_f32 v183, v183
    v_exp_f32 v184, v184
    v_exp_f32 v185, v185
    v_mfma_f32_32x32x8_bf16 v[208:223], v[34:35], v[24:25], v[208:223]
    ds_read_b128 v[36:39], v6 offset:7824
    v_exp_f32 v186, v186
    v_exp_f32 v187, v187
    v_exp_f32 v188, v188
    v_mfma_f32_32x32x16_bf16 v[128:143], v[92:95], v[76:79], v[128:143]
    v_exp_f32 v189, v189
    v_exp_f32 v190, v190
    v_exp_f32 v191, v191
    v_smfmac_f32_32x32x32_bf16 v[224:239], v[48:51], v[176:183], v9
    v_exp_f32 v192, v192
    v_exp_f32 v193, v193
    v_smfmac_f32_32x32x32_bf16 v[224:239], v[52:55], v[184:191], v9
    v_exp_f32 v194, v194
    v_exp_f32 v195, v195
    v_mfma_f32_32x32x16_bf16 v[176:191], v[44:47], v[20:23], 0
    v_exp_f32 v196, v196
    v_exp_f32 v197, v197
    v_exp_f32 v198, v198
    v_mfma_f32_32x32x16_bf16 v[144:159], v[84:87], v[80:83], v[144:159]
    v_exp_f32 v199, v199
    v_exp_f32 v200, v200
    v_exp_f32 v201, v201
    v_mfma_f32_32x32x8_bf16 v[176:191], v[34:35], v[26:27], v[176:191]
    v_exp_f32 v202, v202
    v_exp_f32 v203, v203
    v_exp_f32 v204, v204
    v_mfma_f32_32x32x16_bf16 v[160:175], v[88:91], v[80:83], v[160:175]
    v_exp_f32 v205, v205
    v_exp_f32 v206, v206
    v_exp_f32 v207, v207
    v_smfmac_f32_32x32x32_bf16 v[240:255], v[48:51], v[192:199], v9
    s_waitcnt vmcnt(10) lgkmcnt(0)
    s_barrier
    s_setprio 3
    v_exp_f32 v208, v208
    v_exp_f32 v209, v209
    v_smfmac_f32_32x32x32_bf16 v[240:255], v[52:55], v[200:207], v9
    ds_read_b128 v[52:55], v7 offset:20864
    v_exp_f32 v210, v210
    v_exp_f32 v211, v211
    v_exp_f32 v212, v212
    v_mfma_f32_32x32x16_bf16 v[192:207], v[28:31], v[16:19], 0
    ds_read_b128 v[44:47], v4 offset:20864
    v_exp_f32 v213, v213
    v_exp_f32 v214, v214
    v_exp_f32 v215, v215
    v_mfma_f32_32x32x8_bf16 v[192:207], v[32:33], v[24:25], v[192:207]
    ds_read_b64 v[34:35], v5 offset:20864
    v_exp_f32 v216, v216
    v_exp_f32 v217, v217
    v_exp_f32 v218, v218
    v_exp_f32 v219, v219
    s_waitcnt vmcnt(0)
    v_mfma_f32_32x32x16_bf16 v[96:111], v[64:67], v[56:59], v[96:111]
    ds_read_b128 v[48:51], v6 offset:20864
    s_cmp_eq_u32 s7, 1
    s_cbranch_scc1 L_gated_mix__softmax_full_mha__glu_gated_glu__prompt_sk_42
    global_load_dwordx4 v[76:79], v8, s[44:45] offset:1024 sc1
L_gated_mix__softmax_full_mha__glu_gated_glu__prompt_sk_42:
    v_exp_f32 v220, v220
    v_exp_f32 v221, v221
    v_exp_f32 v222, v222
    v_smfmac_f32_32x32x32_bf16 v[224:239], v[36:39], v[208:215], v9
    s_cmp_eq_u32 s7, 1
    s_cbranch_scc1 L_gated_mix__softmax_full_mha__glu_gated_glu__prompt_sk_43
    global_load_dwordx4 v[84:87], v8, s[48:49] offset:1024 sc1
L_gated_mix__softmax_full_mha__glu_gated_glu__prompt_sk_43:
    v_exp_f32 v223, v223
    v_exp_f32 v176, v176
    v_exp_f32 v177, v177
    v_smfmac_f32_32x32x32_bf16 v[224:239], v[40:43], v[216:223], v9
    s_cmp_eq_u32 s7, 1
    s_cbranch_scc1 L_gated_mix__softmax_full_mha__glu_gated_glu__prompt_sk_44
    global_load_dwordx4 v[88:91], v8, s[50:51] offset:1024 sc1
L_gated_mix__softmax_full_mha__glu_gated_glu__prompt_sk_44:
    v_exp_f32 v178, v178
    v_exp_f32 v179, v179
    v_mfma_f32_32x32x16_bf16 v[208:223], v[28:31], v[20:23], 0
    s_cmp_eq_u32 s7, 1
    s_cbranch_scc1 L_gated_mix__softmax_full_mha__glu_gated_glu__prompt_sk_45
    global_load_dwordx4 v[92:95], v8, s[52:53] offset:1024 sc1
L_gated_mix__softmax_full_mha__glu_gated_glu__prompt_sk_45:
    v_exp_f32 v180, v180
    v_exp_f32 v181, v181
    v_exp_f32 v182, v182
    v_mfma_f32_32x32x16_bf16 v[112:127], v[68:71], v[56:59], v[112:127]
    s_cmp_eq_u32 s7, 1
    s_cbranch_scc1 L_gated_mix__softmax_full_mha__glu_gated_glu__prompt_sk_46
    global_load_dwordx4 v[80:83], v8, s[46:47] offset:1024 sc1
L_gated_mix__softmax_full_mha__glu_gated_glu__prompt_sk_46:
    v_exp_f32 v183, v183
    v_exp_f32 v184, v184
    v_exp_f32 v185, v185
    v_mfma_f32_32x32x8_bf16 v[208:223], v[32:33], v[26:27], v[208:223]
    s_add_u32 m0, s30, 32768
    s_add_u32 s36, s36, 4096
    s_addc_u32 s37, s37, 0
    global_load_lds_dwordx4 v8, s[36:37] offset:0 sc1
    v_exp_f32 v186, v186
    v_exp_f32 v187, v187
    v_exp_f32 v188, v188
    v_mfma_f32_32x32x16_bf16 v[128:143], v[72:75], v[56:59], v[128:143]
    v_exp_f32 v189, v189
    v_exp_f32 v190, v190
    v_exp_f32 v191, v191
    v_smfmac_f32_32x32x32_bf16 v[240:255], v[36:39], v[176:183], v9
    s_waitcnt lgkmcnt(0)
    v_exp_f32 v192, v192
    v_exp_f32 v193, v193
    v_smfmac_f32_32x32x32_bf16 v[240:255], v[40:43], v[184:191], v9
    ds_read_b128 v[40:43], v7 offset:23472
    s_mov_b64 exec, 1
    buffer_load_dword v12, v14, s[16:19], s33 offen offset:2560 sc1
    s_mov_b64 exec, -1
    v_exp_f32 v194, v194
    v_exp_f32 v195, v195
    v_mfma_f32_32x32x16_bf16 v[176:191], v[44:47], v[16:19], 0
    ds_read_b128 v[28:31], v4 offset:23472
    v_exp_f32 v196, v196
    v_exp_f32 v197, v197
    v_exp_f32 v198, v198
    v_mfma_f32_32x32x16_bf16 v[144:159], v[64:67], v[60:63], v[144:159]
    ds_read_b64 v[32:33], v5 offset:23472
    v_exp_f32 v199, v199
    v_exp_f32 v200, v200
    v_exp_f32 v201, v201
    v_mfma_f32_32x32x8_bf16 v[176:191], v[34:35], v[24:25], v[176:191]
    ds_read_b128 v[36:39], v6 offset:23472
    v_exp_f32 v202, v202
    v_exp_f32 v203, v203
    v_exp_f32 v204, v204
    v_mfma_f32_32x32x16_bf16 v[160:175], v[68:71], v[60:63], v[160:175]
    v_exp_f32 v205, v205
    v_exp_f32 v206, v206
    v_exp_f32 v207, v207
    v_smfmac_f32_32x32x32_bf16 v[224:239], v[48:51], v[192:199], v9
    v_exp_f32 v208, v208
    v_exp_f32 v209, v209
    v_smfmac_f32_32x32x32_bf16 v[224:239], v[52:55], v[200:207], v9
    s_cmp_eq_u32 s7, 0
    s_cselect_b32 s22, s26, s27
    s_mul_i32 s31, s22, 40960
    s_add_u32 s31, s31, 18874368
    s_lshl_b32 s23, s6, 11
    s_add_u32 s38, s31, s23
    s_add_u32 s38, s38, 32768
    v_exp_f32 v210, v210
    v_exp_f32 v211, v211
    v_exp_f32 v212, v212
    v_mfma_f32_32x32x16_bf16 v[192:207], v[44:47], v[20:23], 0
    s_lshl_b32 s23, s6, 10
    s_add_u32 s44, s31, s23
    s_add_u32 s45, s44, 4096
    s_add_u32 s46, s44, 8192
    s_add_u32 s47, s44, 12288
    s_add_u32 s48, s44, 16384
    s_add_u32 s49, s44, 20480
    s_add_u32 s50, s44, 24576
    s_add_u32 s51, s44, 28672
    v_exp_f32 v213, v213
    v_exp_f32 v214, v214
    v_exp_f32 v215, v215
    v_mfma_f32_32x32x8_bf16 v[192:207], v[34:35], v[26:27], v[192:207]
    v_lshlrev_b32 v15, 12, v0
    s_add_u32 s23, s44, 1020
    v_add_u32 v15, s23, v15
    v_lshlrev_b32 v13, 8, v0
    s_sub_u32 s23, s38, 1796
    v_cmp_gt_u32 vcc, 8, v0
    v_add_u32 v13, s23, v13
    s_nop 0
    v_cndmask_b32 v15, v13, v15, vcc
    v_exp_f32 v216, v216
    v_exp_f32 v217, v217
    v_exp_f32 v218, v218
    v_exp_f32 v219, v219
    s_waitcnt vmcnt(2)
    s_cmp_eq_u32 s7, 1
    s_cbranch_scc1 L_gated_mix__softmax_full_mha__glu_gated_glu__prompt_sk_47
    v_mfma_f32_32x32x16_bf16 v[96:111], v[84:87], v[76:79], v[96:111]
L_gated_mix__softmax_full_mha__glu_gated_glu__prompt_sk_47:
    v_lshlrev_b32 v3, 3, v1
    v_lshl_add_u32 v3, v2, 9, v3
    s_mul_i32 s28, s3, 3072
    v_add_u32 v13, s28, v8
    s_xor_b32 s29, s3, 4
    s_mul_i32 s29, s29, 3072
    s_sub_u32 s29, s29, s28
    v_exp_f32 v220, v220
    v_exp_f32 v221, v221
    v_exp_f32 v222, v222
    v_smfmac_f32_32x32x32_bf16 v[240:255], v[48:51], v[208:215], v9
    v_exp_f32 v223, v223
    s_waitcnt lgkmcnt(0)
    s_setprio 2
    v_exp_f32 v176, v176
    v_exp_f32 v177, v177
    v_smfmac_f32_32x32x32_bf16 v[240:255], v[52:55], v[216:223], v9
    ds_read_b128 v[52:55], v7 offset:26080
    v_exp_f32 v178, v178
    v_exp_f32 v179, v179
    v_mfma_f32_32x32x16_bf16 v[208:223], v[28:31], v[16:19], 0
    ds_read_b128 v[48:51], v6 offset:26080
    v_exp_f32 v180, v180
    v_exp_f32 v181, v181
    v_exp_f32 v182, v182
    s_cmp_eq_u32 s7, 1
    s_cbranch_scc1 L_gated_mix__softmax_full_mha__glu_gated_glu__prompt_sk_48
    v_mfma_f32_32x32x16_bf16 v[112:127], v[88:91], v[76:79], v[112:127]
L_gated_mix__softmax_full_mha__glu_gated_glu__prompt_sk_48:
    v_exp_f32 v183, v183
    v_exp_f32 v184, v184
    v_exp_f32 v185, v185
    v_mfma_f32_32x32x8_bf16 v[208:223], v[32:33], v[24:25], v[208:223]
    v_exp_f32 v186, v186
    v_exp_f32 v187, v187
    v_exp_f32 v188, v188
    s_cmp_eq_u32 s7, 1
    s_cbranch_scc1 L_gated_mix__softmax_full_mha__glu_gated_glu__prompt_sk_49
    v_mfma_f32_32x32x16_bf16 v[128:143], v[92:95], v[76:79], v[128:143]
L_gated_mix__softmax_full_mha__glu_gated_glu__prompt_sk_49:
    v_exp_f32 v189, v189
    v_exp_f32 v190, v190
    v_exp_f32 v191, v191
    v_smfmac_f32_32x32x32_bf16 v[224:239], v[36:39], v[176:183], v9
    v_exp_f32 v192, v192
    v_exp_f32 v193, v193
    v_smfmac_f32_32x32x32_bf16 v[224:239], v[40:43], v[184:191], v9
    s_mul_i32 s23, s6, 8192
    s_add_u32 s23, s23, 0
    v_add_u32 v4, s23, v8
    v_exp_f32 v194, v194
    v_exp_f32 v195, v195
    v_mfma_f32_32x32x16_bf16 v[176:191], v[28:31], v[20:23], 0
    s_mul_i32 s23, s6, 16384
    s_add_u32 s23, s23, 98304
    v_add_u32 v5, s23, v8
    v_exp_f32 v196, v196
    v_exp_f32 v197, v197
    v_exp_f32 v198, v198
    s_cmp_eq_u32 s7, 1
    s_cbranch_scc1 L_gated_mix__softmax_full_mha__glu_gated_glu__prompt_sk_50
    v_mfma_f32_32x32x16_bf16 v[144:159], v[84:87], v[80:83], v[144:159]
L_gated_mix__softmax_full_mha__glu_gated_glu__prompt_sk_50:
    s_mul_i32 s23, s6, 4096
    s_add_u32 s23, s23, 74496
    v_add_u32 v6, s23, v8
    v_exp_f32 v199, v199
    v_exp_f32 v200, v200
    v_exp_f32 v201, v201
    v_mfma_f32_32x32x8_bf16 v[176:191], v[32:33], v[26:27], v[176:191]
    s_mul_i32 s23, s6, 2048
    s_add_u32 s23, s23, 32768
    v_add_u32 v7, s23, v8
    v_exp_f32 v202, v202
    v_exp_f32 v203, v203
    v_exp_f32 v204, v204
    s_cmp_eq_u32 s7, 1
    s_cbranch_scc1 L_gated_mix__softmax_full_mha__glu_gated_glu__prompt_sk_51
    v_mfma_f32_32x32x16_bf16 v[160:175], v[88:91], v[80:83], v[160:175]
L_gated_mix__softmax_full_mha__glu_gated_glu__prompt_sk_51:
    v_exp_f32 v205, v205
    v_exp_f32 v206, v206
    v_exp_f32 v207, v207
    v_smfmac_f32_32x32x32_bf16 v[240:255], v[36:39], v[192:199], v9
    s_waitcnt lgkmcnt(0)
    s_setprio 1
    v_exp_f32 v208, v208
    v_exp_f32 v209, v209
    v_smfmac_f32_32x32x32_bf16 v[240:255], v[40:43], v[200:207], v9
    s_waitcnt vmcnt(0)
    s_mov_b64 exec, 1
    s_mov_b32 s21, 400000
L_gated_mix__softmax_full_mha__glu_gated_glu__prompt_pm_68:
    v_cmp_ne_u32 vcc, 32, v12
    s_cbranch_vccz L_gated_mix__softmax_full_mha__glu_gated_glu__prompt_om_69
    s_sleep 4
    buffer_load_dword v12, v14, s[16:19], s33 offen offset:2560 sc1
    s_sub_u32 s21, s21, 1
    s_waitcnt vmcnt(0)
    s_cbranch_scc0 L_gated_mix__softmax_full_mha__glu_gated_glu__prompt_pm_68
L_gated_mix__softmax_full_mha__glu_gated_glu__prompt_om_69:
    s_mov_b64 exec, 0xffff
    buffer_load_dword v14, v15, s[16:19], 0 offen sc1
    s_mov_b64 exec, -1
    ds_read_b128 v[56:59], v4 offset:0
    ds_read_b128 v[60:63], v4 offset:1024
    ds_read_b128 v[64:67], v4 offset:3072
    ds_read_b128 v[68:71], v5 offset:0
    v_exp_f32 v210, v210
    v_exp_f32 v211, v211
    v_exp_f32 v212, v212
    v_exp_f32 v213, v213
    ds_read_b128 v[72:75], v5 offset:2048
    ds_read_b128 v[76:79], v5 offset:3072
    ds_read_b128 v[80:83], v5 offset:5120
    ds_read_b128 v[84:87], v5 offset:6144
    v_exp_f32 v214, v214
    v_exp_f32 v215, v215
    v_exp_f32 v216, v216
    v_exp_f32 v217, v217
    ds_read_b128 v[88:91], v6 offset:0
    ds_read_b128 v[92:95], v6 offset:1024
    ds_read_b128 v[192:195], v4 offset:4096
    v_exp_f32 v218, v218
    v_exp_f32 v219, v219
    v_exp_f32 v220, v220
    v_exp_f32 v221, v221
    v_smfmac_f32_32x32x32_bf16 v[224:239], v[48:51], v[208:215], v9
    ds_read_b128 v[196:199], v4 offset:5120
    ds_read_b128 v[200:203], v4 offset:7168
    ds_read_b128 v[204:207], v5 offset:8192
    v_exp_f32 v222, v222
    v_exp_f32 v223, v223
    s_setprio 0
    v_exp_f32 v176, v176
    v_exp_f32 v177, v177
    v_smfmac_f32_32x32x32_bf16 v[224:239], v[52:55], v[216:223], v9
    s_waitcnt lgkmcnt(8)
    ds_read_b128 v[208:211], v5 offset:10240
    ds_read_b128 v[212:215], v5 offset:11264
    v_exp_f32 v178, v178
    v_exp_f32 v179, v179
    v_exp_f32 v180, v180
    v_exp_f32 v181, v181
    ds_read_b128 v[216:219], v5 offset:13312
    ds_read_b128 v[220:223], v5 offset:14336
    v_exp_f32 v182, v182
    v_exp_f32 v183, v183
    v_exp_f32 v184, v184
    v_exp_f32 v185, v185
    v_exp_f32 v186, v186
    v_exp_f32 v187, v187
    v_exp_f32 v188, v188
    v_exp_f32 v189, v189
    v_smfmac_f32_32x32x32_bf16 v[240:255], v[48:51], v[176:183], v9
    v_exp_f32 v190, v190
    v_exp_f32 v191, v191
L_tail:
    s_setprio 0
    s_nop 0
    v_smfmac_f32_32x32x32_bf16 v[240:255], v[52:55], v[184:191], v9
    s_barrier
    s_cmp_eq_u32 s7, 1
    s_cbranch_scc1 L_gated_mix__softmax_full_mha__glu_gated_glu__prompt_h1_70
    s_nop 8
    ds_write_b128 v13, v[240:243] offset:40960
    ds_write_b128 v13, v[244:247] offset:41984
    ds_write_b128 v13, v[248:251] offset:43008
    s_branch L_gated_mix__softmax_full_mha__glu_gated_glu__prompt_hj_71
L_gated_mix__softmax_full_mha__glu_gated_glu__prompt_h1_70:
    ds_write_b128 v13, v[224:227] offset:40960
    ds_write_b128 v13, v[228:231] offset:41984
    ds_write_b128 v13, v[232:235] offset:43008
    s_nop 5
    v_pk_mov_b32 v[224:225], v[240:241], v[240:241] op_sel:[0,1]
    v_pk_mov_b32 v[226:227], v[242:243], v[242:243] op_sel:[0,1]
    v_pk_mov_b32 v[228:229], v[244:245], v[244:245] op_sel:[0,1]
    v_pk_mov_b32 v[230:231], v[246:247], v[246:247] op_sel:[0,1]
    v_pk_mov_b32 v[232:233], v[248:249], v[248:249] op_sel:[0,1]
    v_pk_mov_b32 v[234:235], v[250:251], v[250:251] op_sel:[0,1]
L_gated_mix__softmax_full_mha__glu_gated_glu__prompt_hj_71:
    s_mov_b32 s30, 0x5f800000
    v_add_u32 v13, s29, v13
    s_waitcnt vmcnt(1) lgkmcnt(0)
    s_barrier
    ds_read_b128 v[176:179], v13 offset:40960
    ds_read_b128 v[180:183], v13 offset:41984
    ds_read_b128 v[184:187], v13 offset:43008
    s_waitcnt lgkmcnt(0)
    v_pk_add_f32 v[224:225], v[224:225], v[176:177]
    v_pk_add_f32 v[226:227], v[226:227], v[178:179]
    v_pk_add_f32 v[228:229], v[228:229], v[180:181]
    v_pk_add_f32 v[230:231], v[230:231], v[182:183]
    v_pk_add_f32 v[232:233], v[232:233], v[184:185]
    v_pk_add_f32 v[234:235], v[234:235], v[186:187]
    v_mov_b32 v12, v232
    v_mov_b32 v13, v232
    s_nop 1
    v_permlane32_swap_b32 v12, v13
    s_nop 1
    v_cmp_nle_f32 vcc, v13, s30
    s_nop 1
    s_cmp_lg_u64 vcc, 0
    s_cbranch_scc1 L_gated_mix__softmax_full_mha__glu_gated_glu__prompt_slow_73
L_gated_mix__softmax_full_mha__glu_gated_glu__prompt_norm_72:
    v_rcp_f32 v12, v13
    s_nop 0
    v_mul_f32 v12, v12, v10
    v_pk_mul_f32 v[224:225], v[224:225], v[12:13] op_sel_hi:[1,0]
    v_pk_mul_f32 v[226:227], v[226:227], v[12:13] op_sel_hi:[1,0]
    v_pk_mul_f32 v[228:229], v[228:229], v[12:13] op_sel_hi:[1,0]
    v_pk_mul_f32 v[230:231], v[230:231], v[12:13] op_sel_hi:[1,0]
    v_pk_mul_f32 v[232:233], v[232:233], v[12:13] op_sel_hi:[1,0]
    v_pk_mul_f32 v[234:235], v[234:235], v[12:13] op_sel_hi:[1,0]
    v_cvt_pk_bf16_f32 v176, v224, v225
    v_cvt_pk_bf16_f32 v177, v226, v227
    v_cvt_pk_bf16_f32 v178, v228, v229
    v_cvt_pk_bf16_f32 v179, v230, v231
    v_cvt_pk_bf16_f32 v180, v232, v233
    v_cvt_pk_bf16_f32 v181, v234, v235
    v_min_u32 v176, -2, v176
    v_min_u32 v177, -2, v177
    v_min_u32 v178, -2, v178
    v_min_u32 v179, -2, v179
    v_min_u32 v180, -2, v180
    v_min_u32 v181, -2, v181
    buffer_store_dwordx4 v[176:179], v8, s[16:19], s54 offen sc1
    s_mov_b64 exec, s[64:65]
    buffer_store_dwordx2 v[180:181], v3, s[16:19], s55 offen sc1
    s_mov_b64 exec, -1
    s_waitcnt vmcnt(2)
    s_mov_b64 exec, 0xffff
    v_cmp_ne_u32 vcc, -1, v14
    s_mov_b64 exec, -1
    s_bfe_u32 s22, vcc_lo, 0x40008
    s_cmp_eq_u32 s22, 15
    s_cselect_b32 s22, 0x100, 0
    s_bfe_u32 s23, vcc_lo, 0x4000c
    s_cmp_eq_u32 s23, 15
    s_cselect_b32 s23, 0x200, 0
    s_or_b32 s22, s22, s23
    s_and_b32 s23, vcc_lo, 0xff
    s_or_b32 s22, s22, s23
    s_mov_b32 s31, s22
    s_mov_b32 s53, 0
    v_sub_f32 v12, 1.0, v11
    v_sub_f32 v13, 1.0, v11
    s_mov_b32 s21, 400000
    s_bitcmp1_b32 s26, 0
    v_permlane32_swap_b32 v12, v13
    s_cselect_b64 vcc, -1, 0
    s_nop 0
    v_cndmask_b32 v11, v12, v13, vcc
    v_cndmask_b32 v12, v13, v12, vcc
    s_mul_i32 s24, s3, 4096
    s_cmp_eq_u32 s7, 1
    s_cbranch_scc1 L_gated_mix__softmax_full_mha__glu_gated_glu__prompt_o1_74
    s_bitcmp0_b32 s31, 0
    s_cbranch_scc1 L_gated_mix__softmax_full_mha__glu_gated_glu__prompt_sk_76
    buffer_load_dwordx4 v[16:19], v8, s[16:19], s44 offen sc1
L_gated_mix__softmax_full_mha__glu_gated_glu__prompt_sk_76:
    ds_read_b128 v[240:243], v6 offset:2048
    v_pk_mul_f32 v[144:145], v[144:145], v[12:13] op_sel_hi:[1,0]
    v_pk_mul_f32 v[146:147], v[146:147], v[12:13] op_sel_hi:[1,0]
    v_pk_mul_f32 v[148:149], v[148:149], v[12:13] op_sel_hi:[1,0]
    v_pk_mul_f32 v[150:151], v[150:151], v[12:13] op_sel_hi:[1,0]
    s_bitcmp0_b32 s31, 1
    s_cbranch_scc1 L_gated_mix__softmax_full_mha__glu_gated_glu__prompt_sk_77
    buffer_load_dwordx4 v[20:23], v8, s[16:19], s45 offen sc1
L_gated_mix__softmax_full_mha__glu_gated_glu__prompt_sk_77:
    ds_read_b128 v[244:247], v6 offset:3072
    v_pk_mul_f32 v[152:153], v[152:153], v[12:13] op_sel_hi:[1,0]
    v_pk_mul_f32 v[154:155], v[154:155], v[12:13] op_sel_hi:[1,0]
    v_pk_mul_f32 v[156:157], v[156:157], v[12:13] op_sel_hi:[1,0]
    v_pk_mul_f32 v[158:159], v[158:159], v[12:13] op_sel_hi:[1,0]
    s_bitcmp0_b32 s31, 2
    s_cbranch_scc1 L_gated_mix__softmax_full_mha__glu_gated_glu__prompt_sk_78
    buffer_load_dwordx4 v[24:27], v8, s[16:19], s46 offen sc1
L_gated_mix__softmax_full_mha__glu_gated_glu__prompt_sk_78:
    ds_read_b128 v[248:251], v4 offset:2048
    v_pk_mul_f32 v[160:161], v[160:161], v[12:13] op_sel_hi:[1,0]
    v_pk_mul_f32 v[162:163], v[162:163], v[12:13] op_sel_hi:[1,0]
    v_pk_mul_f32 v[164:165], v[164:165], v[12:13] op_sel_hi:[1,0]
    v_pk_mul_f32 v[166:167], v[166:167], v[12:13] op_sel_hi:[1,0]
    s_bitcmp0_b32 s31, 3
    s_cbranch_scc1 L_gated_mix__softmax_full_mha__glu_gated_glu__prompt_sk_79
    buffer_load_dwordx4 v[28:31], v8, s[16:19], s47 offen sc1
L_gated_mix__softmax_full_mha__glu_gated_glu__prompt_sk_79:
    ds_read_b128 v[252:255], v5 offset:1024
    v_pk_mul_f32 v[168:169], v[168:169], v[12:13] op_sel_hi:[1,0]
    v_pk_mul_f32 v[170:171], v[170:171], v[12:13] op_sel_hi:[1,0]
    v_pk_mul_f32 v[172:173], v[172:173], v[12:13] op_sel_hi:[1,0]
    v_pk_mul_f32 v[174:175], v[174:175], v[12:13] op_sel_hi:[1,0]
    s_bitcmp0_b32 s31, 4
    s_cbranch_scc1 L_gated_mix__softmax_full_mha__glu_gated_glu__prompt_sk_80
    buffer_load_dwordx4 v[32:35], v8, s[16:19], s48 offen sc1
L_gated_mix__softmax_full_mha__glu_gated_glu__prompt_sk_80:
    ds_read_b128 v[224:227], v5 offset:4096
    ds_read_b128 v[228:231], v5 offset:7168
    v_pk_mul_f32 v[96:97], v[96:97], v[10:11] op_sel:[0,1]
    v_pk_mul_f32 v[98:99], v[98:99], v[10:11] op_sel:[0,1]
    v_pk_mul_f32 v[100:101], v[100:101], v[10:11] op_sel:[0,1]
    v_pk_mul_f32 v[102:103], v[102:103], v[10:11] op_sel:[0,1]
    s_bitcmp0_b32 s31, 5
    s_cbranch_scc1 L_gated_mix__softmax_full_mha__glu_gated_glu__prompt_sk_81
    buffer_load_dwordx4 v[36:39], v8, s[16:19], s49 offen sc1
L_gated_mix__softmax_full_mha__glu_gated_glu__prompt_sk_81:
    ds_read_b128 v[232:235], v7 offset:0
    v_pk_mul_f32 v[104:105], v[104:105], v[10:11] op_sel:[0,1]
    v_pk_mul_f32 v[106:107], v[106:107], v[10:11] op_sel:[0,1]
    v_pk_mul_f32 v[108:109], v[108:109], v[10:11] op_sel:[0,1]
    v_pk_mul_f32 v[110:111], v[110:111], v[10:11] op_sel:[0,1]
    s_bitcmp0_b32 s31, 6
    s_cbranch_scc1 L_gated_mix__softmax_full_mha__glu_gated_glu__prompt_sk_82
    buffer_load_dwordx4 v[40:43], v8, s[16:19], s50 offen sc1
L_gated_mix__softmax_full_mha__glu_gated_glu__prompt_sk_82:
    ds_read_b128 v[236:239], v4 offset:6144
    v_pk_mul_f32 v[112:113], v[112:113], v[10:11] op_sel:[0,1]
    v_pk_mul_f32 v[114:115], v[114:115], v[10:11] op_sel:[0,1]
    v_pk_mul_f32 v[116:117], v[116:117], v[10:11] op_sel:[0,1]
    v_pk_mul_f32 v[118:119], v[118:119], v[10:11] op_sel:[0,1]
    s_bitcmp0_b32 s31, 7
    s_cbranch_scc1 L_gated_mix__softmax_full_mha__glu_gated_glu__prompt_sk_83
    buffer_load_dwordx4 v[44:47], v8, s[16:19], s51 offen sc1
L_gated_mix__softmax_full_mha__glu_gated_glu__prompt_sk_83:
    ds_read_b128 v[176:179], v5 offset:9216
    v_pk_mul_f32 v[120:121], v[120:121], v[10:11] op_sel:[0,1]
    v_pk_mul_f32 v[122:123], v[122:123], v[10:11] op_sel:[0,1]
    v_pk_mul_f32 v[124:125], v[124:125], v[10:11] op_sel:[0,1]
    v_pk_mul_f32 v[126:127], v[126:127], v[10:11] op_sel:[0,1]
    s_bitcmp0_b32 s31, 8
    s_cbranch_scc1 L_gated_mix__softmax_full_mha__glu_gated_glu__prompt_sk_84
    buffer_load_dwordx2 v[48:49], v3, s[16:19], s38 offen offset:0 sc1
    buffer_load_dwordx2 v[50:51], v3, s[16:19], s38 offen offset:256 sc1
L_gated_mix__softmax_full_mha__glu_gated_glu__prompt_sk_84:
    ds_read_b128 v[180:183], v5 offset:12288
    v_pk_mul_f32 v[128:129], v[128:129], v[10:11] op_sel:[0,1]
    v_pk_mul_f32 v[130:131], v[130:131], v[10:11] op_sel:[0,1]
    v_pk_mul_f32 v[132:133], v[132:133], v[10:11] op_sel:[0,1]
    v_pk_mul_f32 v[134:135], v[134:135], v[10:11] op_sel:[0,1]
    s_bitcmp0_b32 s31, 9
    s_cbranch_scc1 L_gated_mix__softmax_full_mha__glu_gated_glu__prompt_sk_85
    buffer_load_dwordx2 v[52:53], v3, s[16:19], s38 offen offset:1024 sc1
    buffer_load_dwordx2 v[54:55], v3, s[16:19], s38 offen offset:1280 sc1
L_gated_mix__softmax_full_mha__glu_gated_glu__prompt_sk_85:
    ds_read_b128 v[184:187], v5 offset:15360
    ds_read_b128 v[188:191], v7 offset:1024
    v_pk_mul_f32 v[136:137], v[136:137], v[10:11] op_sel:[0,1]
    v_pk_mul_f32 v[138:139], v[138:139], v[10:11] op_sel:[0,1]
    v_pk_mul_f32 v[140:141], v[140:141], v[10:11] op_sel:[0,1]
    v_pk_mul_f32 v[142:143], v[142:143], v[10:11] op_sel:[0,1]
    s_waitcnt lgkmcnt(0)
    s_add_u32 s24, s24, 65536
    v_xor_b32 v4, 0, v8
    v_add_u32 v4, s24, v4
    v_xor_b32 v5, 64, v8
    v_add_u32 v5, s24, v5
    v_xor_b32 v6, 128, v8
    v_add_u32 v6, s24, v6
    v_xor_b32 v7, 192, v8
    v_add_u32 v7, s24, v7
    s_barrier
    ds_write_b128 v4, v[144:147] offset:32768
    v_and_b32 v12, 3, v0
    v_lshrrev_b32 v13, 2, v0
    v_lshlrev_b32 v9, 2, v12
    ds_write_b128 v5, v[148:151] offset:33792
    v_xor_b32 v9, v9, v13
    v_lshlrev_b32 v9, 4, v9
    v_lshl_add_u32 v9, v12, 10, v9
    v_mul_u32_u24 v10, 1280, v13
    ds_write_b128 v6, v[152:155] offset:34816
    v_lshl_add_u32 v10, v12, 4, v10
    s_lshr_b32 s23, s3, 1
    s_and_b32 s22, s3, 1
    s_mul_i32 s25, s23, 32768
    ds_write_b128 v7, v[156:159] offset:35840
    s_lshl_b32 s28, s22, 8
    s_add_u32 s25, s25, s28
    v_add_u32 v9, s25, v9
    v_add_u32 v4, 65536, v4
    s_cmp_ge_u32 s23, 3
    s_cselect_b32 s28, s27, s26
    s_cselect_b32 s29, 3, 0
    s_sub_u32 s29, s23, s29
    v_add_u32 v5, 65536, v5
    s_add_u32 s29, s29, s78
    s_cmp_eq_u32 s23, 2
    s_cselect_b32 s29, s79, s29
    s_lshl_b32 s28, s28, 1
    v_add_u32 v6, 65536, v6
    s_add_u32 s28, s28, s22
    s_mul_i32 s28, s28, 20480
    s_lshl_b32 s29, s29, 6
    v_add_u32 v7, 65536, v7
    s_add_u32 s28, s28, s29
    s_lshl_b32 s23, s6, 3
    v_lshrrev_b32 v15, 3, v0
    v_add_u32 v15, s23, v15
    ds_write_b128 v4, v[160:163] offset:0
    v_bfe_u32 v13, v0, 1, 2
    v_lshlrev_b32 v14, 2, v13
    v_xor_b32 v14, v14, v15
    v_lshlrev_b32 v14, 4, v14
    ds_write_b128 v5, v[164:167] offset:1024
    v_lshl_add_u32 v14, v13, 10, v14
    v_and_b32 v13, 1, v0
    v_lshl_add_u32 v14, v13, 9, v14
    ds_write_b128 v6, v[168:171] offset:2048
    v_add_u32 v14, 131072, v14
    v_and_b32 v13, 7, v0
    v_mul_u32_u24 v15, 1280, v15
    v_lshl_add_u32 v15, v13, 3, v15
    ds_write_b128 v7, v[172:175] offset:3072
    s_mul_i32 s29, s27, 40960
    s_lshl_b32 s23, s78, 6
    s_add_u32 s29, s29, s23
    s_nop 0
L_gated_mix__softmax_full_mha__glu_gated_glu__prompt_lp_86:
    s_sub_u32 s21, s21, 1
    s_cbranch_scc1 L_gated_mix__softmax_full_mha__glu_gated_glu__prompt_ex_87
    s_mov_b32 s30, s31
    s_or_b32 s23, s53, s30
    s_waitcnt vmcnt(0)
    s_andn2_b32 s31, 0x3ff, s23
    s_cbranch_scc0 L_gated_mix__softmax_full_mha__glu_gated_glu__prompt_nl_88
    s_bitcmp0_b32 s31, 0
    s_cbranch_scc1 L_gated_mix__softmax_full_mha__glu_gated_glu__prompt_sk_89
    buffer_load_dwordx4 v[16:19], v8, s[16:19], s44 offen sc1
L_gated_mix__softmax_full_mha__glu_gated_glu__prompt_sk_89:
    s_bitcmp0_b32 s31, 1
    s_cbranch_scc1 L_gated_mix__softmax_full_mha__glu_gated_glu__prompt_sk_90
    buffer_load_dwordx4 v[20:23], v8, s[16:19], s45 offen sc1
L_gated_mix__softmax_full_mha__glu_gated_glu__prompt_sk_90:
    s_bitcmp0_b32 s31, 2
    s_cbranch_scc1 L_gated_mix__softmax_full_mha__glu_gated_glu__prompt_sk_91
    buffer_load_dwordx4 v[24:27], v8, s[16:19], s46 offen sc1
L_gated_mix__softmax_full_mha__glu_gated_glu__prompt_sk_91:
    s_bitcmp0_b32 s31, 3
    s_cbranch_scc1 L_gated_mix__softmax_full_mha__glu_gated_glu__prompt_sk_92
    buffer_load_dwordx4 v[28:31], v8, s[16:19], s47 offen sc1
L_gated_mix__softmax_full_mha__glu_gated_glu__prompt_sk_92:
    s_bitcmp0_b32 s31, 4
    s_cbranch_scc1 L_gated_mix__softmax_full_mha__glu_gated_glu__prompt_sk_93
    buffer_load_dwordx4 v[32:35], v8, s[16:19], s48 offen sc1
L_gated_mix__softmax_full_mha__glu_gated_glu__prompt_sk_93:
    s_bitcmp0_b32 s31, 5
    s_cbranch_scc1 L_gated_mix__softmax_full_mha__glu_gated_glu__prompt_sk_94
    buffer_load_dwordx4 v[36:39], v8, s[16:19], s49 offen sc1
L_gated_mix__softmax_full_mha__glu_gated_glu__prompt_sk_94:
    s_bitcmp0_b32 s31, 6
    s_cbranch_scc1 L_gated_mix__softmax_full_mha__glu_gated_glu__prompt_sk_95
    buffer_load_dwordx4 v[40:43], v8, s[16:19], s50 offen sc1
L_gated_mix__softmax_full_mha__glu_gated_glu__prompt_sk_95:
    s_bitcmp0_b32 s31, 7
    s_cbranch_scc1 L_gated_mix__softmax_full_mha__glu_gated_glu__prompt_sk_96
    buffer_load_dwordx4 v[44:47], v8, s[16:19], s51 offen sc1
L_gated_mix__softmax_full_mha__glu_gated_glu__prompt_sk_96:
    s_bitcmp0_b32 s31, 8
    s_cbranch_scc1 L_gated_mix__softmax_full_mha__glu_gated_glu__prompt_sk_97
    buffer_load_dwordx2 v[48:49], v3, s[16:19], s38 offen offset:0 sc1
    buffer_load_dwordx2 v[50:51], v3, s[16:19], s38 offen offset:256 sc1
L_gated_mix__softmax_full_mha__glu_gated_glu__prompt_sk_97:
    s_bitcmp0_b32 s31, 9
    s_cbranch_scc1 L_gated_mix__softmax_full_mha__glu_gated_glu__prompt_sk_98
    buffer_load_dwordx2 v[52:53], v3, s[16:19], s38 offen offset:1024 sc1
    buffer_load_dwordx2 v[54:55], v3, s[16:19], s38 offen offset:1280 sc1
L_gated_mix__softmax_full_mha__glu_gated_glu__prompt_sk_98:
L_gated_mix__softmax_full_mha__glu_gated_glu__prompt_nl_88:
    s_bitcmp0_b32 s30, 0
    s_cbranch_scc1 L_gated_mix__softmax_full_mha__glu_gated_glu__prompt_sk_99
    v_max3_u32 v13, v16, v17, v18
    v_max_u32 v13, v13, v19
    v_cmp_eq_u32 vcc, -1, v13
    s_cbranch_vccnz L_gated_mix__softmax_full_mha__glu_gated_glu__prompt_sk_99
    v_mfma_f32_32x32x16_bf16 v[96:111], v[56:59], v[16:19], v[96:111]
    v_mfma_f32_32x32x16_bf16 v[112:127], v[60:63], v[16:19], v[112:127]
    v_mfma_f32_32x32x16_bf16 v[128:143], v[248:251], v[16:19], v[128:143]
    s_bitset1_b32 s53, 0
L_gated_mix__softmax_full_mha__glu_gated_glu__prompt_sk_99:
    s_bitcmp0_b32 s30, 1
    s_cbranch_scc1 L_gated_mix__softmax_full_mha__glu_gated_glu__prompt_sk_100
    v_max3_u32 v13, v20, v21, v22
    v_max_u32 v13, v13, v23
    v_cmp_eq_u32 vcc, -1, v13
    s_cbranch_vccnz L_gated_mix__softmax_full_mha__glu_gated_glu__prompt_sk_100
    v_mfma_f32_32x32x16_bf16 v[96:111], v[64:67], v[20:23], v[96:111]
    v_mfma_f32_32x32x16_bf16 v[112:127], v[68:71], v[20:23], v[112:127]
    v_mfma_f32_32x32x16_bf16 v[128:143], v[252:255], v[20:23], v[128:143]
    s_bitset1_b32 s53, 1
L_gated_mix__softmax_full_mha__glu_gated_glu__prompt_sk_100:
    s_bitcmp0_b32 s30, 2
    s_cbranch_scc1 L_gated_mix__softmax_full_mha__glu_gated_glu__prompt_sk_101
    v_max3_u32 v13, v24, v25, v26
    v_max_u32 v13, v13, v27
    v_cmp_eq_u32 vcc, -1, v13
    s_cbranch_vccnz L_gated_mix__softmax_full_mha__glu_gated_glu__prompt_sk_101
    v_mfma_f32_32x32x16_bf16 v[96:111], v[72:75], v[24:27], v[96:111]
    v_mfma_f32_32x32x16_bf16 v[112:127], v[76:79], v[24:27], v[112:127]
    v_mfma_f32_32x32x16_bf16 v[128:143], v[224:227], v[24:27], v[128:143]
    s_bitset1_b32 s53, 2
L_gated_mix__softmax_full_mha__glu_gated_glu__prompt_sk_101:
    s_bitcmp0_b32 s30, 3
    s_cbranch_scc1 L_gated_mix__softmax_full_mha__glu_gated_glu__prompt_sk_102
    v_max3_u32 v13, v28, v29, v30
    v_max_u32 v13, v13, v31
    v_cmp_eq_u32 vcc, -1, v13
    s_cbranch_vccnz L_gated_mix__softmax_full_mha__glu_gated_glu__prompt_sk_102
    v_mfma_f32_32x32x16_bf16 v[96:111], v[80:83], v[28:31], v[96:111]
    v_mfma_f32_32x32x16_bf16 v[112:127], v[84:87], v[28:31], v[112:127]
    v_mfma_f32_32x32x16_bf16 v[128:143], v[228:231], v[28:31], v[128:143]
    s_bitset1_b32 s53, 3
L_gated_mix__softmax_full_mha__glu_gated_glu__prompt_sk_102:
    s_bitcmp0_b32 s30, 4
    s_cbranch_scc1 L_gated_mix__softmax_full_mha__glu_gated_glu__prompt_sk_103
    v_max3_u32 v13, v32, v33, v34
    v_max_u32 v13, v13, v35
    v_cmp_eq_u32 vcc, -1, v13
    s_cbranch_vccnz L_gated_mix__softmax_full_mha__glu_gated_glu__prompt_sk_103
    v_mfma_f32_32x32x16_bf16 v[96:111], v[192:195], v[32:35], v[96:111]
    v_mfma_f32_32x32x16_bf16 v[112:127], v[196:199], v[32:35], v[112:127]
    v_mfma_f32_32x32x16_bf16 v[128:143], v[236:239], v[32:35], v[128:143]
    s_bitset1_b32 s53, 4
L_gated_mix__softmax_full_mha__glu_gated_glu__prompt_sk_103:
    s_bitcmp0_b32 s30, 5
    s_cbranch_scc1 L_gated_mix__softmax_full_mha__glu_gated_glu__prompt_sk_104
    v_max3_u32 v13, v36, v37, v38
    v_max_u32 v13, v13, v39
    v_cmp_eq_u32 vcc, -1, v13
    s_cbranch_vccnz L_gated_mix__softmax_full_mha__glu_gated_glu__prompt_sk_104
    v_mfma_f32_32x32x16_bf16 v[96:111], v[200:203], v[36:39], v[96:111]
    v_mfma_f32_32x32x16_bf16 v[112:127], v[204:207], v[36:39], v[112:127]
    v_mfma_f32_32x32x16_bf16 v[128:143], v[176:179], v[36:39], v[128:143]
    s_bitset1_b32 s53, 5
L_gated_mix__softmax_full_mha__glu_gated_glu__prompt_sk_104:
    s_bitcmp0_b32 s30, 6
    s_cbranch_scc1 L_gated_mix__softmax_full_mha__glu_gated_glu__prompt_sk_105
    v_max3_u32 v13, v40, v41, v42
    v_max_u32 v13, v13, v43
    v_cmp_eq_u32 vcc, -1, v13
    s_cbranch_vccnz L_gated_mix__softmax_full_mha__glu_gated_glu__prompt_sk_105
    v_mfma_f32_32x32x16_bf16 v[96:111], v[208:211], v[40:43], v[96:111]
    v_mfma_f32_32x32x16_bf16 v[112:127], v[212:215], v[40:43], v[112:127]
    v_mfma_f32_32x32x16_bf16 v[128:143], v[180:183], v[40:43], v[128:143]
    s_bitset1_b32 s53, 6
L_gated_mix__softmax_full_mha__glu_gated_glu__prompt_sk_105:
    s_bitcmp0_b32 s30, 7
    s_cbranch_scc1 L_gated_mix__softmax_full_mha__glu_gated_glu__prompt_sk_106
    v_max3_u32 v13, v44, v45, v46
    v_max_u32 v13, v13, v47
    v_cmp_eq_u32 vcc, -1, v13
    s_cbranch_vccnz L_gated_mix__softmax_full_mha__glu_gated_glu__prompt_sk_106
    v_mfma_f32_32x32x16_bf16 v[96:111], v[216:219], v[44:47], v[96:111]
    v_mfma_f32_32x32x16_bf16 v[112:127], v[220:223], v[44:47], v[112:127]
    v_mfma_f32_32x32x16_bf16 v[128:143], v[184:187], v[44:47], v[128:143]
    s_bitset1_b32 s53, 7
L_gated_mix__softmax_full_mha__glu_gated_glu__prompt_sk_106:
    s_bitcmp0_b32 s30, 8
    s_cbranch_scc1 L_gated_mix__softmax_full_mha__glu_gated_glu__prompt_sk_107
    v_max3_u32 v13, v48, v49, v50
    v_max_u32 v13, v13, v51
    v_cmp_eq_u32 vcc, -1, v13
    s_cbranch_vccnz L_gated_mix__softmax_full_mha__glu_gated_glu__prompt_sk_107
    v_mfma_f32_32x32x16_bf16 v[96:111], v[88:91], v[48:51], v[96:111]
    v_mfma_f32_32x32x16_bf16 v[112:127], v[92:95], v[48:51], v[112:127]
    v_mfma_f32_32x32x16_bf16 v[128:143], v[232:235], v[48:51], v[128:143]
    s_bitset1_b32 s53, 8
L_gated_mix__softmax_full_mha__glu_gated_glu__prompt_sk_107:
    s_bitcmp0_b32 s30, 9
    s_cbranch_scc1 L_gated_mix__softmax_full_mha__glu_gated_glu__prompt_sk_108
    v_max3_u32 v13, v52, v53, v54
    v_max_u32 v13, v13, v55
    v_cmp_eq_u32 vcc, -1, v13
    s_cbranch_vccnz L_gated_mix__softmax_full_mha__glu_gated_glu__prompt_sk_108
    v_mfma_f32_32x32x16_bf16 v[96:111], v[240:243], v[52:55], v[96:111]
    v_mfma_f32_32x32x16_bf16 v[112:127], v[244:247], v[52:55], v[112:127]
    v_mfma_f32_32x32x16_bf16 v[128:143], v[188:191], v[52:55], v[128:143]
    s_bitset1_b32 s53, 9
L_gated_mix__softmax_full_mha__glu_gated_glu__prompt_sk_108:
    s_cmp_lg_u32 s53, 0x3ff
    s_cbranch_scc1 L_gated_mix__softmax_full_mha__glu_gated_glu__prompt_lp_86
L_gated_mix__softmax_full_mha__glu_gated_glu__prompt_ex_87:
    s_waitcnt vmcnt(0)
    s_nop 8
    v_add_u32 v4, 4294836224, v4
    v_add_u32 v5, 4294836224, v5
    v_add_u32 v6, 4294836224, v6
    v_add_u32 v7, 4294836224, v7
    ds_write_b128 v4, v[96:99] offset:0
    ds_write_b128 v5, v[100:103] offset:1024
    ds_write_b128 v6, v[104:107] offset:2048
    ds_write_b128 v7, v[108:111] offset:3072
    ds_write_b128 v4, v[112:115] offset:32768
    ds_write_b128 v5, v[116:119] offset:33792
    ds_write_b128 v6, v[120:123] offset:34816
    ds_write_b128 v7, v[124:127] offset:35840
    v_add_u32 v4, 65536, v4
    v_add_u32 v5, 65536, v5
    v_add_u32 v6, 65536, v6
    v_add_u32 v7, 65536, v7
    ds_write_b128 v4, v[128:131] offset:0
    ds_write_b128 v5, v[132:135] offset:1024
    ds_write_b128 v6, v[136:139] offset:2048
    ds_write_b128 v7, v[140:143] offset:3072
    s_branch L_gated_mix__softmax_full_mha__glu_gated_glu__prompt_of_75
L_gated_mix__softmax_full_mha__glu_gated_glu__prompt_o1_74:
    s_bitcmp0_b32 s31, 0
    s_cbranch_scc1 L_gated_mix__softmax_full_mha__glu_gated_glu__prompt_sk_109
    buffer_load_dwordx4 v[16:19], v8, s[16:19], s44 offen sc1
L_gated_mix__softmax_full_mha__glu_gated_glu__prompt_sk_109:
    v_pk_mul_f32 v[96:97], v[96:97], v[10:11] op_sel:[0,1]
    v_pk_mul_f32 v[98:99], v[98:99], v[10:11] op_sel:[0,1]
    v_pk_mul_f32 v[100:101], v[100:101], v[10:11] op_sel:[0,1]
    v_pk_mul_f32 v[102:103], v[102:103], v[10:11] op_sel:[0,1]
    s_bitcmp0_b32 s31, 1
    s_cbranch_scc1 L_gated_mix__softmax_full_mha__glu_gated_glu__prompt_sk_110
    buffer_load_dwordx4 v[20:23], v8, s[16:19], s45 offen sc1
L_gated_mix__softmax_full_mha__glu_gated_glu__prompt_sk_110:
    v_pk_mul_f32 v[104:105], v[104:105], v[10:11] op_sel:[0,1]
    v_pk_mul_f32 v[106:107], v[106:107], v[10:11] op_sel:[0,1]
    v_pk_mul_f32 v[108:109], v[108:109], v[10:11] op_sel:[0,1]
    v_pk_mul_f32 v[110:111], v[110:111], v[10:11] op_sel:[0,1]
    s_bitcmp0_b32 s31, 2
    s_cbranch_scc1 L_gated_mix__softmax_full_mha__glu_gated_glu__prompt_sk_111
    buffer_load_dwordx4 v[24:27], v8, s[16:19], s46 offen sc1
L_gated_mix__softmax_full_mha__glu_gated_glu__prompt_sk_111:
    v_pk_mul_f32 v[112:113], v[112:113], v[10:11] op_sel:[0,1]
    v_pk_mul_f32 v[114:115], v[114:115], v[10:11] op_sel:[0,1]
    v_pk_mul_f32 v[116:117], v[116:117], v[10:11] op_sel:[0,1]
    v_pk_mul_f32 v[118:119], v[118:119], v[10:11] op_sel:[0,1]
    s_bitcmp0_b32 s31, 3
    s_cbranch_scc1 L_gated_mix__softmax_full_mha__glu_gated_glu__prompt_sk_112
    buffer_load_dwordx4 v[28:31], v8, s[16:19], s47 offen sc1
L_gated_mix__softmax_full_mha__glu_gated_glu__prompt_sk_112:
    v_pk_mul_f32 v[120:121], v[120:121], v[10:11] op_sel:[0,1]
    v_pk_mul_f32 v[122:123], v[122:123], v[10:11] op_sel:[0,1]
    v_pk_mul_f32 v[124:125], v[124:125], v[10:11] op_sel:[0,1]
    v_pk_mul_f32 v[126:127], v[126:127], v[10:11] op_sel:[0,1]
    s_bitcmp0_b32 s31, 4
    s_cbranch_scc1 L_gated_mix__softmax_full_mha__glu_gated_glu__prompt_sk_113
    buffer_load_dwordx4 v[32:35], v8, s[16:19], s48 offen sc1
L_gated_mix__softmax_full_mha__glu_gated_glu__prompt_sk_113:
    ds_read_b128 v[240:243], v6 offset:2048
    v_pk_mul_f32 v[128:129], v[128:129], v[10:11] op_sel:[0,1]
    v_pk_mul_f32 v[130:131], v[130:131], v[10:11] op_sel:[0,1]
    v_pk_mul_f32 v[132:133], v[132:133], v[10:11] op_sel:[0,1]
    v_pk_mul_f32 v[134:135], v[134:135], v[10:11] op_sel:[0,1]
    s_bitcmp0_b32 s31, 5
    s_cbranch_scc1 L_gated_mix__softmax_full_mha__glu_gated_glu__prompt_sk_114
    buffer_load_dwordx4 v[36:39], v8, s[16:19], s49 offen sc1
L_gated_mix__softmax_full_mha__glu_gated_glu__prompt_sk_114:
    v_pk_mul_f32 v[136:137], v[136:137], v[10:11] op_sel:[0,1]
    v_pk_mul_f32 v[138:139], v[138:139], v[10:11] op_sel:[0,1]
    v_pk_mul_f32 v[140:141], v[140:141], v[10:11] op_sel:[0,1]
    v_pk_mul_f32 v[142:143], v[142:143], v[10:11] op_sel:[0,1]
    s_bitcmp0_b32 s31, 6
    s_cbranch_scc1 L_gated_mix__softmax_full_mha__glu_gated_glu__prompt_sk_115
    buffer_load_dwordx4 v[40:43], v8, s[16:19], s50 offen sc1
L_gated_mix__softmax_full_mha__glu_gated_glu__prompt_sk_115:
    v_pk_mul_f32 v[144:145], v[144:145], v[12:13] op_sel_hi:[1,0]
    v_pk_mul_f32 v[146:147], v[146:147], v[12:13] op_sel_hi:[1,0]
    v_pk_mul_f32 v[148:149], v[148:149], v[12:13] op_sel_hi:[1,0]
    v_pk_mul_f32 v[150:151], v[150:151], v[12:13] op_sel_hi:[1,0]
    s_bitcmp0_b32 s31, 7
    s_cbranch_scc1 L_gated_mix__softmax_full_mha__glu_gated_glu__prompt_sk_116
    buffer_load_dwordx4 v[44:47], v8, s[16:19], s51 offen sc1
L_gated_mix__softmax_full_mha__glu_gated_glu__prompt_sk_116:
    v_pk_mul_f32 v[152:153], v[152:153], v[12:13] op_sel_hi:[1,0]
    v_pk_mul_f32 v[154:155], v[154:155], v[12:13] op_sel_hi:[1,0]
    v_pk_mul_f32 v[156:157], v[156:157], v[12:13] op_sel_hi:[1,0]
    v_pk_mul_f32 v[158:159], v[158:159], v[12:13] op_sel_hi:[1,0]
    s_bitcmp0_b32 s31, 8
    s_cbranch_scc1 L_gated_mix__softmax_full_mha__glu_gated_glu__prompt_sk_117
    buffer_load_dwordx2 v[48:49], v3, s[16:19], s38 offen offset:0 sc1
    buffer_load_dwordx2 v[50:51], v3, s[16:19], s38 offen offset:256 sc1
L_gated_mix__softmax_full_mha__glu_gated_glu__prompt_sk_117:
    v_pk_mul_f32 v[160:161], v[160:161], v[12:13] op_sel_hi:[1,0]
    v_pk_mul_f32 v[162:163], v[162:163], v[12:13] op_sel_hi:[1,0]
    v_pk_mul_f32 v[164:165], v[164:165], v[12:13] op_sel_hi:[1,0]
    v_pk_mul_f32 v[166:167], v[166:167], v[12:13] op_sel_hi:[1,0]
    s_bitcmp0_b32 s31, 9
    s_cbranch_scc1 L_gated_mix__softmax_full_mha__glu_gated_glu__prompt_sk_118
    buffer_load_dwordx2 v[52:53], v3, s[16:19], s38 offen offset:1024 sc1
    buffer_load_dwordx2 v[54:55], v3, s[16:19], s38 offen offset:1280 sc1
L_gated_mix__softmax_full_mha__glu_gated_glu__prompt_sk_118:
    ds_read_b128 v[244:247], v6 offset:3072
    v_pk_mul_f32 v[168:169], v[168:169], v[12:13] op_sel_hi:[1,0]
    v_pk_mul_f32 v[170:171], v[170:171], v[12:13] op_sel_hi:[1,0]
    v_pk_mul_f32 v[172:173], v[172:173], v[12:13] op_sel_hi:[1,0]
    v_pk_mul_f32 v[174:175], v[174:175], v[12:13] op_sel_hi:[1,0]
    s_waitcnt lgkmcnt(0)
    s_add_u32 s24, s24, 0
    v_xor_b32 v4, 0, v8
    v_add_u32 v4, s24, v4
    v_xor_b32 v5, 64, v8
    v_add_u32 v5, s24, v5
    v_xor_b32 v6, 128, v8
    v_add_u32 v6, s24, v6
    v_xor_b32 v7, 192, v8
    v_add_u32 v7, s24, v7
    s_barrier
    ds_write_b128 v4, v[96:99] offset:0
    v_and_b32 v12, 3, v0
    v_lshrrev_b32 v13, 2, v0
    ds_write_b128 v5, v[100:103] offset:1024
    v_lshlrev_b32 v9, 2, v12
    v_xor_b32 v9, v9, v13
    v_lshlrev_b32 v9, 4, v9
    ds_write_b128 v6, v[104:107] offset:2048
    v_lshl_add_u32 v9, v12, 10, v9
    v_mul_u32_u24 v10, 1280, v13
    v_lshl_add_u32 v10, v12, 4, v10
    ds_write_b128 v7, v[108:111] offset:3072
    s_lshr_b32 s23, s3, 1
    s_and_b32 s22, s3, 1
    s_mul_i32 s25, s23, 32768
    ds_write_b128 v4, v[112:115] offset:32768
    s_lshl_b32 s28, s22, 8
    s_add_u32 s25, s25, s28
    ds_write_b128 v5, v[116:119] offset:33792
    v_add_u32 v9, s25, v9
    s_cmp_ge_u32 s23, 3
    s_cselect_b32 s28, s27, s26
    ds_write_b128 v6, v[120:123] offset:34816
    s_cselect_b32 s29, 3, 0
    s_sub_u32 s29, s23, s29
    s_add_u32 s29, s29, s78
    ds_write_b128 v7, v[124:127] offset:35840
    s_cmp_eq_u32 s23, 2
    s_cselect_b32 s29, s79, s29
    s_lshl_b32 s28, s28, 1
    v_add_u32 v4, 65536, v4
    s_add_u32 s28, s28, s22
    s_mul_i32 s28, s28, 20480
    v_add_u32 v5, 65536, v5
    s_lshl_b32 s29, s29, 6
    s_add_u32 s28, s28, s29
    s_lshl_b32 s23, s6, 3
    v_add_u32 v6, 65536, v6
    v_lshrrev_b32 v15, 3, v0
    v_add_u32 v15, s23, v15
    v_bfe_u32 v13, v0, 1, 2
    v_add_u32 v7, 65536, v7
    v_lshlrev_b32 v14, 2, v13
    v_xor_b32 v14, v14, v15
    v_lshlrev_b32 v14, 4, v14
    ds_write_b128 v4, v[128:131] offset:0
    v_lshl_add_u32 v14, v13, 10, v14
    v_and_b32 v13, 1, v0
    ds_write_b128 v5, v[132:135] offset:1024
    v_lshl_add_u32 v14, v13, 9, v14
    v_add_u32 v14, 131072, v14
    v_and_b32 v13, 7, v0
    ds_write_b128 v6, v[136:139] offset:2048
    v_mul_u32_u24 v15, 1280, v15
    v_lshl_add_u32 v15, v13, 3, v15
    s_mul_i32 s29, s27, 40960
    ds_write_b128 v7, v[140:143] offset:3072
    s_lshl_b32 s23, s78, 6
    s_add_u32 s29, s29, s23
    s_nop 0
L_gated_mix__softmax_full_mha__glu_gated_glu__prompt_lp_119:
    s_sub_u32 s21, s21, 1
    s_cbranch_scc1 L_gated_mix__softmax_full_mha__glu_gated_glu__prompt_ex_120
    s_mov_b32 s30, s31
    s_or_b32 s23, s53, s30
    s_waitcnt vmcnt(0)
    s_andn2_b32 s31, 0x3ff, s23
    s_cbranch_scc0 L_gated_mix__softmax_full_mha__glu_gated_glu__prompt_nl_121
    s_bitcmp0_b32 s31, 0
    s_cbranch_scc1 L_gated_mix__softmax_full_mha__glu_gated_glu__prompt_sk_122
    buffer_load_dwordx4 v[16:19], v8, s[16:19], s44 offen sc1
L_gated_mix__softmax_full_mha__glu_gated_glu__prompt_sk_122:
    s_bitcmp0_b32 s31, 1
    s_cbranch_scc1 L_gated_mix__softmax_full_mha__glu_gated_glu__prompt_sk_123
    buffer_load_dwordx4 v[20:23], v8, s[16:19], s45 offen sc1
L_gated_mix__softmax_full_mha__glu_gated_glu__prompt_sk_123:
    s_bitcmp0_b32 s31, 2
    s_cbranch_scc1 L_gated_mix__softmax_full_mha__glu_gated_glu__prompt_sk_124
    buffer_load_dwordx4 v[24:27], v8, s[16:19], s46 offen sc1
L_gated_mix__softmax_full_mha__glu_gated_glu__prompt_sk_124:
    s_bitcmp0_b32 s31, 3
    s_cbranch_scc1 L_gated_mix__softmax_full_mha__glu_gated_glu__prompt_sk_125
    buffer_load_dwordx4 v[28:31], v8, s[16:19], s47 offen sc1
L_gated_mix__softmax_full_mha__glu_gated_glu__prompt_sk_125:
    s_bitcmp0_b32 s31, 4
    s_cbranch_scc1 L_gated_mix__softmax_full_mha__glu_gated_glu__prompt_sk_126
    buffer_load_dwordx4 v[32:35], v8, s[16:19], s48 offen sc1
L_gated_mix__softmax_full_mha__glu_gated_glu__prompt_sk_126:
    s_bitcmp0_b32 s31, 5
    s_cbranch_scc1 L_gated_mix__softmax_full_mha__glu_gated_glu__prompt_sk_127
    buffer_load_dwordx4 v[36:39], v8, s[16:19], s49 offen sc1
L_gated_mix__softmax_full_mha__glu_gated_glu__prompt_sk_127:
    s_bitcmp0_b32 s31, 6
    s_cbranch_scc1 L_gated_mix__softmax_full_mha__glu_gated_glu__prompt_sk_128
    buffer_load_dwordx4 v[40:43], v8, s[16:19], s50 offen sc1
L_gated_mix__softmax_full_mha__glu_gated_glu__prompt_sk_128:
    s_bitcmp0_b32 s31, 7
    s_cbranch_scc1 L_gated_mix__softmax_full_mha__glu_gated_glu__prompt_sk_129
    buffer_load_dwordx4 v[44:47], v8, s[16:19], s51 offen sc1
L_gated_mix__softmax_full_mha__glu_gated_glu__prompt_sk_129:
    s_bitcmp0_b32 s31, 8
    s_cbranch_scc1 L_gated_mix__softmax_full_mha__glu_gated_glu__prompt_sk_130
    buffer_load_dwordx2 v[48:49], v3, s[16:19], s38 offen offset:0 sc1
    buffer_load_dwordx2 v[50:51], v3, s[16:19], s38 offen offset:256 sc1
L_gated_mix__softmax_full_mha__glu_gated_glu__prompt_sk_130:
    s_bitcmp0_b32 s31, 9
    s_cbranch_scc1 L_gated_mix__softmax_full_mha__glu_gated_glu__prompt_sk_131
    buffer_load_dwordx2 v[52:53], v3, s[16:19], s38 offen offset:1024 sc1
    buffer_load_dwordx2 v[54:55], v3, s[16:19], s38 offen offset:1280 sc1
L_gated_mix__softmax_full_mha__glu_gated_glu__prompt_sk_131:
L_gated_mix__softmax_full_mha__glu_gated_glu__prompt_nl_121:
    s_bitcmp0_b32 s30, 0
    s_cbranch_scc1 L_gated_mix__softmax_full_mha__glu_gated_glu__prompt_sk_132
    v_max3_u32 v13, v16, v17, v18
    v_max_u32 v13, v13, v19
    v_cmp_eq_u32 vcc, -1, v13
    s_cbranch_vccnz L_gated_mix__softmax_full_mha__glu_gated_glu__prompt_sk_132
    v_mfma_f32_32x32x16_bf16 v[144:159], v[56:59], v[16:19], v[144:159]
    v_mfma_f32_32x32x16_bf16 v[160:175], v[60:63], v[16:19], v[160:175]
    s_bitset1_b32 s53, 0
L_gated_mix__softmax_full_mha__glu_gated_glu__prompt_sk_132:
    s_bitcmp0_b32 s30, 1
    s_cbranch_scc1 L_gated_mix__softmax_full_mha__glu_gated_glu__prompt_sk_133
    v_max3_u32 v13, v20, v21, v22
    v_max_u32 v13, v13, v23
    v_cmp_eq_u32 vcc, -1, v13
    s_cbranch_vccnz L_gated_mix__softmax_full_mha__glu_gated_glu__prompt_sk_133
    v_mfma_f32_32x32x16_bf16 v[144:159], v[64:67], v[20:23], v[144:159]
    v_mfma_f32_32x32x16_bf16 v[160:175], v[68:71], v[20:23], v[160:175]
    s_bitset1_b32 s53, 1
L_gated_mix__softmax_full_mha__glu_gated_glu__prompt_sk_133:
    s_bitcmp0_b32 s30, 2
    s_cbranch_scc1 L_gated_mix__softmax_full_mha__glu_gated_glu__prompt_sk_134
    v_max3_u32 v13, v24, v25, v26
    v_max_u32 v13, v13, v27
    v_cmp_eq_u32 vcc, -1, v13
    s_cbranch_vccnz L_gated_mix__softmax_full_mha__glu_gated_glu__prompt_sk_134
    v_mfma_f32_32x32x16_bf16 v[144:159], v[72:75], v[24:27], v[144:159]
    v_mfma_f32_32x32x16_bf16 v[160:175], v[76:79], v[24:27], v[160:175]
    s_bitset1_b32 s53, 2
L_gated_mix__softmax_full_mha__glu_gated_glu__prompt_sk_134:
    s_bitcmp0_b32 s30, 3
    s_cbranch_scc1 L_gated_mix__softmax_full_mha__glu_gated_glu__prompt_sk_135
    v_max3_u32 v13, v28, v29, v30
    v_max_u32 v13, v13, v31
    v_cmp_eq_u32 vcc, -1, v13
    s_cbranch_vccnz L_gated_mix__softmax_full_mha__glu_gated_glu__prompt_sk_135
    v_mfma_f32_32x32x16_bf16 v[144:159], v[80:83], v[28:31], v[144:159]
    v_mfma_f32_32x32x16_bf16 v[160:175], v[84:87], v[28:31], v[160:175]
    s_bitset1_b32 s53, 3
L_gated_mix__softmax_full_mha__glu_gated_glu__prompt_sk_135:
    s_bitcmp0_b32 s30, 4
    s_cbranch_scc1 L_gated_mix__softmax_full_mha__glu_gated_glu__prompt_sk_136
    v_max3_u32 v13, v32, v33, v34
    v_max_u32 v13, v13, v35
    v_cmp_eq_u32 vcc, -1, v13
    s_cbranch_vccnz L_gated_mix__softmax_full_mha__glu_gated_glu__prompt_sk_136
    v_mfma_f32_32x32x16_bf16 v[144:159], v[192:195], v[32:35], v[144:159]
    v_mfma_f32_32x32x16_bf16 v[160:175], v[196:199], v[32:35], v[160:175]
    s_bitset1_b32 s53, 4
L_gated_mix__softmax_full_mha__glu_gated_glu__prompt_sk_136:
    s_bitcmp0_b32 s30, 5
    s_cbranch_scc1 L_gated_mix__softmax_full_mha__glu_gated_glu__prompt_sk_137
    v_max3_u32 v13, v36, v37, v38
    v_max_u32 v13, v13, v39
    v_cmp_eq_u32 vcc, -1, v13
    s_cbranch_vccnz L_gated_mix__softmax_full_mha__glu_gated_glu__prompt_sk_137
    v_mfma_f32_32x32x16_bf16 v[144:159], v[200:203], v[36:39], v[144:159]
    v_mfma_f32_32x32x16_bf16 v[160:175], v[204:207], v[36:39], v[160:175]
    s_bitset1_b32 s53, 5
L_gated_mix__softmax_full_mha__glu_gated_glu__prompt_sk_137:
    s_bitcmp0_b32 s30, 6
    s_cbranch_scc1 L_gated_mix__softmax_full_mha__glu_gated_glu__prompt_sk_138
    v_max3_u32 v13, v40, v41, v42
    v_max_u32 v13, v13, v43
    v_cmp_eq_u32 vcc, -1, v13
    s_cbranch_vccnz L_gated_mix__softmax_full_mha__glu_gated_glu__prompt_sk_138
    v_mfma_f32_32x32x16_bf16 v[144:159], v[208:211], v[40:43], v[144:159]
    v_mfma_f32_32x32x16_bf16 v[160:175], v[212:215], v[40:43], v[160:175]
    s_bitset1_b32 s53, 6
L_gated_mix__softmax_full_mha__glu_gated_glu__prompt_sk_138:
    s_bitcmp0_b32 s30, 7
    s_cbranch_scc1 L_gated_mix__softmax_full_mha__glu_gated_glu__prompt_sk_139
    v_max3_u32 v13, v44, v45, v46
    v_max_u32 v13, v13, v47
    v_cmp_eq_u32 vcc, -1, v13
    s_cbranch_vccnz L_gated_mix__softmax_full_mha__glu_gated_glu__prompt_sk_139
    v_mfma_f32_32x32x16_bf16 v[144:159], v[216:219], v[44:47], v[144:159]
    v_mfma_f32_32x32x16_bf16 v[160:175], v[220:223], v[44:47], v[160:175]
    s_bitset1_b32 s53, 7
L_gated_mix__softmax_full_mha__glu_gated_glu__prompt_sk_139:
    s_bitcmp0_b32 s30, 8
    s_cbranch_scc1 L_gated_mix__softmax_full_mha__glu_gated_glu__prompt_sk_140
    v_max3_u32 v13, v48, v49, v50
    v_max_u32 v13, v13, v51
    v_cmp_eq_u32 vcc, -1, v13
    s_cbranch_vccnz L_gated_mix__softmax_full_mha__glu_gated_glu__prompt_sk_140
    v_mfma_f32_32x32x16_bf16 v[144:159], v[88:91], v[48:51], v[144:159]
    v_mfma_f32_32x32x16_bf16 v[160:175], v[92:95], v[48:51], v[160:175]
    s_bitset1_b32 s53, 8
L_gated_mix__softmax_full_mha__glu_gated_glu__prompt_sk_140:
    s_bitcmp0_b32 s30, 9
    s_cbranch_scc1 L_gated_mix__softmax_full_mha__glu_gated_glu__prompt_sk_141
    v_max3_u32 v13, v52, v53, v54
    v_max_u32 v13, v13, v55
    v_cmp_eq_u32 vcc, -1, v13
    s_cbranch_vccnz L_gated_mix__softmax_full_mha__glu_gated_glu__prompt_sk_141
    v_mfma_f32_32x32x16_bf16 v[144:159], v[240:243], v[52:55], v[144:159]
    v_mfma_f32_32x32x16_bf16 v[160:175], v[244:247], v[52:55], v[160:175]
    s_bitset1_b32 s53, 9
L_gated_mix__softmax_full_mha__glu_gated_glu__prompt_sk_141:
    s_cmp_lg_u32 s53, 0x3ff
    s_cbranch_scc1 L_gated_mix__softmax_full_mha__glu_gated_glu__prompt_lp_119
L_gated_mix__softmax_full_mha__glu_gated_glu__prompt_ex_120:
    s_waitcnt vmcnt(0)
    s_nop 8
    ds_write_b128 v4, v[144:147] offset:32768
    ds_write_b128 v5, v[148:151] offset:33792
    ds_write_b128 v6, v[152:155] offset:34816
    ds_write_b128 v7, v[156:159] offset:35840
    v_add_u32 v4, 65536, v4
    v_add_u32 v5, 65536, v5
    v_add_u32 v6, 65536, v6
    v_add_u32 v7, 65536, v7
    ds_write_b128 v4, v[160:163] offset:0
    ds_write_b128 v5, v[164:167] offset:1024
    ds_write_b128 v6, v[168:171] offset:2048
    ds_write_b128 v7, v[172:175] offset:3072
L_gated_mix__softmax_full_mha__glu_gated_glu__prompt_of_75:
    s_waitcnt lgkmcnt(0)
    s_barrier
    ds_read_b128 v[16:19], v9 offset:0
    ds_read_b128 v[20:23], v9 offset:512
    ds_read_b128 v[24:27], v9 offset:4096
    ds_read_b128 v[28:31], v9 offset:4608
    ds_read_b128 v[32:35], v9 offset:8192
    ds_read_b128 v[36:39], v9 offset:8704
    ds_read_b128 v[40:43], v9 offset:12288
    ds_read_b128 v[44:47], v9 offset:12800
    ds_read_b128 v[48:51], v9 offset:16384
    ds_read_b128 v[52:55], v9 offset:16896
    ds_read_b128 v[56:59], v9 offset:20480
    ds_read_b128 v[60:63], v9 offset:20992
    s_waitcnt lgkmcnt(8)
    ds_read_b128 v[64:67], v9 offset:24576
    ds_read_b128 v[68:71], v9 offset:25088
    ds_read_b128 v[72:75], v9 offset:28672
    ds_read_b128 v[76:79], v9 offset:29184
    s_waitcnt lgkmcnt(12)
    v_pk_add_f32 v[16:17], v[16:17], v[24:25]
    v_pk_add_f32 v[18:19], v[18:19], v[26:27]
    v_pk_add_f32 v[20:21], v[20:21], v[28:29]
    v_pk_add_f32 v[22:23], v[22:23], v[30:31]
    s_waitcnt lgkmcnt(8)
    v_pk_add_f32 v[16:17], v[16:17], v[32:33]
    v_pk_add_f32 v[18:19], v[18:19], v[34:35]
    v_pk_add_f32 v[20:21], v[20:21], v[36:37]
    v_pk_add_f32 v[22:23], v[22:23], v[38:39]
    v_pk_add_f32 v[16:17], v[16:17], v[40:41]
    v_pk_add_f32 v[18:19], v[18:19], v[42:43]
    v_pk_add_f32 v[20:21], v[20:21], v[44:45]
    v_pk_add_f32 v[22:23], v[22:23], v[46:47]
    s_waitcnt lgkmcnt(4)
    v_pk_add_f32 v[16:17], v[16:17], v[48:49]
    v_pk_add_f32 v[18:19], v[18:19], v[50:51]
    v_pk_add_f32 v[20:21], v[20:21], v[52:53]
    v_pk_add_f32 v[22:23], v[22:23], v[54:55]
    v_pk_add_f32 v[16:17], v[16:17], v[56:57]
    v_pk_add_f32 v[18:19], v[18:19], v[58:59]
    v_pk_add_f32 v[20:21], v[20:21], v[60:61]
    v_pk_add_f32 v[22:23], v[22:23], v[62:63]
    s_waitcnt lgkmcnt(2)
    v_pk_add_f32 v[16:17], v[16:17], v[64:65]
    v_pk_add_f32 v[18:19], v[18:19], v[66:67]
    v_pk_add_f32 v[20:21], v[20:21], v[68:69]
    v_pk_add_f32 v[22:23], v[22:23], v[70:71]
    s_waitcnt lgkmcnt(0)
    s_cmp_eq_u32 s7, 0
    s_cbranch_scc1 L_gated_mix__softmax_full_mha__glu_gated_glu__prompt_n4_142_a
    ds_read_b128 v[80:83], v14 offset:0
    ds_read_b128 v[84:87], v14 offset:4096
    ds_read_b128 v[88:91], v14 offset:8192
    ds_read_b128 v[92:95], v14 offset:12288
    ds_read_b128 v[96:99], v14 offset:16384
    ds_read_b128 v[100:103], v14 offset:20480
    ds_read_b128 v[104:107], v14 offset:24576
    ds_read_b128 v[108:111], v14 offset:28672
L_gated_mix__softmax_full_mha__glu_gated_glu__prompt_n4_142_a:
    v_pk_add_f32 v[16:17], v[16:17], v[72:73]
    v_pk_add_f32 v[18:19], v[18:19], v[74:75]
    v_pk_add_f32 v[20:21], v[20:21], v[76:77]
    v_pk_add_f32 v[22:23], v[22:23], v[78:79]
    v_cvt_pk_bf16_f32 v24, v16, v17
    v_cvt_pk_bf16_f32 v25, v18, v19
    v_cvt_pk_bf16_f32 v26, v20, v21
    v_cvt_pk_bf16_f32 v27, v22, v23
    buffer_store_dwordx4 v[24:27], v10, s[8:11], s28 offen sc1
    s_cmp_eq_u32 s7, 0
    s_cbranch_scc1 L_gated_mix__softmax_full_mha__glu_gated_glu__prompt_n4_142
    s_waitcnt lgkmcnt(4)
    v_pk_add_f32 v[80:81], v[80:81], v[84:85]
    v_pk_add_f32 v[82:83], v[82:83], v[86:87]
    v_pk_add_f32 v[80:81], v[80:81], v[88:89]
    v_pk_add_f32 v[82:83], v[82:83], v[90:91]
    v_pk_add_f32 v[80:81], v[80:81], v[92:93]
    v_pk_add_f32 v[82:83], v[82:83], v[94:95]
    s_waitcnt lgkmcnt(1)
    v_pk_add_f32 v[80:81], v[80:81], v[96:97]
    v_pk_add_f32 v[82:83], v[82:83], v[98:99]
    v_pk_add_f32 v[80:81], v[80:81], v[100:101]
    v_pk_add_f32 v[82:83], v[82:83], v[102:103]
    v_pk_add_f32 v[80:81], v[80:81], v[104:105]
    v_pk_add_f32 v[82:83], v[82:83], v[106:107]
    s_waitcnt lgkmcnt(0)
    v_pk_add_f32 v[80:81], v[80:81], v[108:109]
    v_pk_add_f32 v[82:83], v[82:83], v[110:111]
    v_cvt_pk_bf16_f32 v84, v80, v81
    v_cvt_pk_bf16_f32 v85, v82, v83
    buffer_store_dwordx2 v[84:85], v15, s[8:11], s29 offen offset:64 sc1
L_gated_mix__softmax_full_mha__glu_gated_glu__prompt_n4_142:
L_gated_mix__softmax_full_mha__glu_gated_glu__prompt_end_1:
    s_endpgm
L_gated_mix__softmax_full_mha__glu_gated_glu__prompt_slow_73:
    s_cmp_eq_u32 s7, 0
    s_cbranch_scc1 L_gated_mix__softmax_full_mha__glu_gated_glu__prompt_sq_143
    v_mov_b32 v16, v20
    v_mov_b32 v17, v21
    v_mov_b32 v18, v22
    v_mov_b32 v19, v23
    v_mov_b32 v24, v26
    v_mov_b32 v25, v27
L_gated_mix__softmax_full_mha__glu_gated_glu__prompt_sq_143:
    s_mov_b32 s66, 0x000fffff
    s_mov_b32 s67, 0x000fffff
    v_and_b32 v12, 3, v1
    v_lshlrev_b32 v12, 4, v12
    v_lshl_add_u32 v12, v2, 6, v12
    v_lshrrev_b32 v48, 2, v1
    v_lshl_add_u32 v48, v48, 7, v12
    v_cmp_eq_u32 vcc, 0, v2
    v_mov_b32 v12, 0
    s_nop 1
    v_cndmask_b32 v24, v12, v24, vcc
    v_cndmask_b32 v25, v12, v25, vcc
    v_mov_b32 v32, s68
    v_mov_b32 v33, s69
    v_mov_b32 v36, s68
    v_mov_b32 v40, s68
    v_mov_b32 v37, s68
    v_mov_b32 v41, s68
    v_mov_b32 v38, s68
    v_mov_b32 v42, s68
    v_mov_b32 v39, s68
    v_mov_b32 v43, s68
    v_mov_b32 v44, 0xff800000
    s_mov_b32 s73, 0
L_gated_mix__softmax_full_mha__glu_gated_glu__prompt_p1_144:
    s_sub_u32 s22, s73, 2
    s_and_b32 s22, s22, 31
    s_and_b32 s23, s73, 32
    s_or_b32 s22, s22, s23
    s_mul_i32 s22, s22, 2560
    s_add_u32 s22, s22, s70
    buffer_load_dwordx4 v[28:31], v8, s[16:19], s22 offen sc1
    s_mov_b64 exec, s[64:65]
    buffer_load_dwordx2 v[32:33], v3, s[16:19], s22 offen offset:1024 sc1
    s_mov_b64 exec, -1
    s_waitcnt vmcnt(0)
    v_mfma_f32_32x32x16_bf16 v[176:191], v[28:31], v[16:19], 0
    v_mfma_f32_32x32x8_bf16 v[176:191], v[32:33], v[24:25], v[176:191]
    s_nop 11
    v_max3_f32 v44, v44, v176, v177
    v_max3_f32 v44, v44, v178, v179
    v_max3_f32 v44, v44, v180, v181
    v_max3_f32 v44, v44, v182, v183
    v_max3_f32 v44, v44, v184, v185
    v_max3_f32 v44, v44, v186, v187
    v_max3_f32 v44, v44, v188, v189
    v_max3_f32 v44, v44, v190, v191
    s_add_u32 s73, s73, 1
    s_cmp_lg_u32 s73, 64
    s_cbranch_scc1 L_gated_mix__softmax_full_mha__glu_gated_glu__prompt_p1_144
    v_mov_b32 v45, v44
    s_nop 1
    v_permlane32_swap_b32 v44, v45
    s_nop 1
    v_max_f32 v44, v44, v45
    v_xor_b32 v44, 0x80000000, v44
    v_and_b32 v45, 0xffff0000, v44
    v_sub_f32 v46, v44, v45
    v_and_b32 v47, 0xffff0000, v46
    v_sub_f32 v46, v46, v47
    v_lshrrev_b32 v45, 16, v45
    v_or_b32 v45, v45, v47
    v_lshrrev_b32 v46, 16, v46
    v_cndmask_b32 v24, v45, v24, vcc
    v_cndmask_b32 v25, v46, v25, vcc
    v_mov_b32 v224, 0
    v_mov_b32 v225, 0
    v_mov_b32 v226, 0
    v_mov_b32 v227, 0
    v_mov_b32 v228, 0
    v_mov_b32 v229, 0
    v_mov_b32 v230, 0
    v_mov_b32 v231, 0
    v_mov_b32 v232, 0
    v_mov_b32 v233, 0
    v_mov_b32 v234, 0
    v_mov_b32 v235, 0
    v_mov_b32 v236, 0
    v_mov_b32 v237, 0
    v_mov_b32 v238, 0
    v_mov_b32 v239, 0
    s_mov_b32 s73, 0
L_gated_mix__softmax_full_mha__glu_gated_glu__prompt_p2_145:
    s_sub_u32 s22, s73, 2
    s_and_b32 s22, s22, 31
    s_and_b32 s23, s73, 32
    s_or_b32 s22, s22, s23
    s_mul_i32 s22, s22, 2560
    s_add_u32 s22, s22, s70
    buffer_load_dwordx4 v[28:31], v8, s[16:19], s22 offen sc1
    s_mov_b64 exec, s[64:65]
    buffer_load_dwordx2 v[32:33], v3, s[16:19], s22 offen offset:1024 sc1
    s_mov_b64 exec, -1
    s_sub_u32 s21, s73, 1
    s_and_b32 s21, s21, 31
    s_and_b32 s23, s73, 32
    s_or_b32 s21, s21, s23
    s_mul_i32 s21, s21, 2560
    s_add_u32 s21, s21, s70
    s_mov_b64 exec, s[66:67]
    buffer_load_dwordx4 v[36:39], v48, s[16:19], s21 offen offset:1280 sc1
    buffer_load_dwordx4 v[40:43], v48, s[16:19], s21 offen offset:1920 sc1
    s_mov_b64 exec, -1
    s_waitcnt vmcnt(0)
    v_mfma_f32_32x32x16_bf16 v[176:191], v[28:31], v[16:19], 0
    v_mfma_f32_32x32x8_bf16 v[176:191], v[32:33], v[24:25], v[176:191]
    s_nop 11
    v_exp_f32 v176, v176
    v_exp_f32 v177, v177
    v_exp_f32 v178, v178
    v_exp_f32 v179, v179
    v_exp_f32 v180, v180
    v_exp_f32 v181, v181
    v_exp_f32 v182, v182
    v_exp_f32 v183, v183
    v_exp_f32 v184, v184
    v_exp_f32 v185, v185
    v_exp_f32 v186, v186
    v_exp_f32 v187, v187
    v_exp_f32 v188, v188
    v_exp_f32 v189, v189
    v_exp_f32 v190, v190
    v_exp_f32 v191, v191
    s_nop 1
    v_smfmac_f32_32x32x32_bf16 v[224:239], v[36:39], v[176:183], v9
    v_smfmac_f32_32x32x32_bf16 v[224:239], v[40:43], v[184:191], v9
    s_add_u32 s73, s73, 1
    s_cmp_lg_u32 s73, 64
    s_cbranch_scc1 L_gated_mix__softmax_full_mha__glu_gated_glu__prompt_p2_145
    s_nop 11
    v_mov_b32 v12, v232
    v_mov_b32 v13, v232
    s_nop 1
    v_permlane32_swap_b32 v12, v13
    s_nop 1
    s_branch L_gated_mix__softmax_full_mha__glu_gated_glu__prompt_norm_72
.p2align 6
.type L_tab,@object
L_tab:
.long 0, 0, 0, 0
.long 0, 0, 4, 260
.long 0, 4, 2, 512
.long 0, 4, 6, 772
.long 0, 9, 0, 1024
.long 0, 9, 4, 1284
.long 0, 13, 2, 1536
.long 0, 13, 6, 1796
.long 0, 0, 1, 2048
.long 0, 0, 5, 2308
.long 0, 4, 3, 2560
.long 0, 4, 7, 2820
.long 0, 9, 1, 3072
.long 0, 9, 5, 3332
.long 0, 13, 3, 3584
.long 0, 13, 7, 3844
.long 0, 0, 2, 4096
.long 0, 0, 6, 4356
.long 0, 5, 0, 4608
.long 0, 5, 4, 4868
.long 0, 9, 2, 5120
.long 0, 9, 6, 5380
.long 0, 14, 0, 5632
.long 0, 14, 4, 5892
.long 0, 0, 3, 6144
.long 0, 0, 7, 6404
.long 0, 5, 1, 6656
.long 0, 5, 5, 6916
.long 0, 9, 3, 7168
.long 0, 9, 7, 7428
.long 0, 14, 1, 7680
.long 0, 14, 5, 7940
.long 0, 1, 0, 8192
.long 0, 1, 4, 8452
.long 0, 5, 2, 8704
.long 0, 5, 6, 8964
.long 0, 10, 0, 9216
.long 0, 10, 4, 9476
.long 0, 14, 2, 9728
.long 0, 14, 6, 9988
.long 0, 1, 1, 10240
.long 0, 1, 5, 10500
.long 0, 5, 3, 10752
.long 0, 5, 7, 11012
.long 0, 10, 1, 11264
.long 0, 10, 5, 11524
.long 0, 14, 3, 11776
.long 0, 14, 7, 12036
.long 0, 1, 2, 12288
.long 0, 1, 6, 12548
.long 0, 6, 0, 12800
.long 0, 6, 4, 13060
.long 0, 10, 2, 13312
.long 0, 10, 6, 13572
.long 0, 15, 0, 13824
.long 0, 15, 4, 14084
.long 0, 1, 3, 14336
.long 0, 1, 7, 14596
.long 0, 6, 1, 14848
.long 0, 6, 5, 15108
.long 0, 10, 3, 15360
.long 0, 10, 7, 15620
.long 0, 15, 1, 15872
.long 0, 15, 5, 16132
.long 0, 2, 0, 16384
.long 0, 2, 4, 16644
.long 0, 6, 2, 16896
.long 0, 6, 6, 17156
.long 0, 11, 0, 17408
.long 0, 11, 4, 17668
.long 0, 15, 2, 17920
.long 0, 15, 6, 18180
.long 0, 2, 1, 18432
.long 0, 2, 5, 18692
.long 0, 6, 3, 18944
.long 0, 6, 7, 19204
.long 0, 11, 1, 19456
.long 0, 11, 5, 19716
.long 0, 15, 3, 19968
.long 0, 15, 7, 20228
.long 1, 0, 0, 40960
.long 1, 0, 4, 41220
.long 1, 3, 0, 41472
.long 1, 3, 4, 41732
.long 1, 6, 0, 41984
.long 1, 6, 4, 42244
.long 2, 9, 0, 42496
.long 2, 9, 4, 42756
.long 1, 0, 1, 43008
.long 1, 0, 5, 43268
.long 1, 3, 1, 43520
.long 1, 3, 5, 43780
.long 1, 6, 1, 44032
.long 1, 6, 5, 44292
.long 2, 9, 1, 44544
.long 2, 9, 5, 44804
.long 1, 0, 2, 45056
.long 1, 0, 6, 45316
.long 1, 3, 2, 45568
.long 1, 3, 6, 45828
.long 1, 6, 2, 46080
.long 1, 6, 6, 46340
.long 2, 9, 2, 46592
.long 2, 9, 6, 46852
.long 1, 0, 3, 47104
.long 1, 0, 7, 47364
.long 1, 3, 3, 47616
.long 1, 3, 7, 47876
.long 1, 6, 3, 48128
.long 1, 6, 7, 48388
.long 2, 9, 3, 48640
.long 2, 9, 7, 48900
.long 1, 1, 0, 49152
.long 1, 1, 4, 49412
.long 1, 4, 0, 49664
.long 1, 4, 4, 49924
.long 1, 7, 0, 50176
.long 1, 7, 4, 50436
.long 2, 10, 0, 50688
.long 2, 10, 4, 50948
.long 1, 1, 1, 51200
.long 1, 1, 5, 51460
.long 1, 4, 1, 51712
.long 1, 4, 5, 51972
.long 1, 7, 1, 52224
.long 1, 7, 5, 52484
.long 2, 10, 1, 52736
.long 2, 10, 5, 52996
.long 1, 1, 2, 53248
.long 1, 1, 6, 53508
.long 1, 4, 2, 53760
.long 1, 4, 6, 54020
.long 1, 7, 2, 54272
.long 1, 7, 6, 54532
.long 2, 10, 2, 54784
.long 2, 10, 6, 55044
.long 1, 1, 3, 55296
.long 1, 1, 7, 55556
.long 1, 4, 3, 55808
.long 1, 4, 7, 56068
.long 1, 7, 3, 56320
.long 1, 7, 7, 56580
.long 2, 10, 3, 56832
.long 2, 10, 7, 57092
.long 1, 2, 0, 57344
.long 1, 2, 4, 57604
.long 1, 5, 0, 57856
.long 1, 5, 4, 58116
.long 2, 8, 0, 58368
.long 2, 8, 4, 58628
.long 2, 11, 0, 58880
.long 2, 11, 4, 59140
.long 1, 2, 1, 59392
.long 1, 2, 5, 59652
.long 1, 5, 1, 59904
.long 1, 5, 5, 60164
.long 2, 8, 1, 60416
.long 2, 8, 5, 60676
.long 2, 11, 1, 60928
.long 2, 11, 5, 61188
.long 1, 2, 2, 61440
.long 1, 2, 6, 61700
.long 1, 5, 2, 61952
.long 1, 5, 6, 62212
.long 2, 8, 2, 62464
.long 2, 8, 6, 62724
.long 2, 11, 2, 62976
.long 2, 11, 6, 63236
.long 1, 2, 3, 63488
.long 1, 2, 7, 63748
.long 1, 5, 3, 64000
.long 1, 5, 7, 64260
.long 2, 8, 3, 64512
.long 2, 8, 7, 64772
.long 2, 11, 3, 65024
.long 2, 11, 7, 65284
.long 0, 2, 2, 20480
.long 0, 2, 6, 20740
.long 0, 7, 0, 20992
.long 0, 7, 4, 21252
.long 0, 11, 2, 21504
.long 0, 11, 6, 21764
.long 0, 16, 0, 22016
.long 0, 16, 4, 22276
.long 0, 2, 3, 22528
.long 0, 2, 7, 22788
.long 0, 7, 1, 23040
.long 0, 7, 5, 23300
.long 0, 11, 3, 23552
.long 0, 11, 7, 23812
.long 0, 16, 1, 24064
.long 0, 16, 5, 24324
.long 0, 3, 0, 24576
.long 0, 3, 4, 24836
.long 0, 7, 2, 25088
.long 0, 7, 6, 25348
.long 0, 12, 0, 25600
.long 0, 12, 4, 25860
.long 0, 16, 2, 26112
.long 0, 16, 6, 26372
.long 0, 3, 1, 26624
.long 0, 3, 5, 26884
.long 0, 7, 3, 27136
.long 0, 7, 7, 27396
.long 0, 12, 1, 27648
.long 0, 12, 5, 27908
.long 0, 16, 3, 28160
.long 0, 16, 7, 28420
.long 0, 3, 2, 28672
.long 0, 3, 6, 28932
.long 0, 8, 0, 29184
.long 0, 8, 4, 29444
.long 0, 12, 2, 29696
.long 0, 12, 6, 29956
.long 0, 17, 0, 30208
.long 0, 17, 4, 30468
.long 0, 3, 3, 30720
.long 0, 3, 7, 30980
.long 0, 8, 1, 31232
.long 0, 8, 5, 31492
.long 0, 12, 3, 31744
.long 0, 12, 7, 32004
.long 0, 17, 1, 32256
.long 0, 17, 5, 32516
.long 0, 4, 0, 32768
.long 0, 4, 4, 33028
.long 0, 8, 2, 33280
.long 0, 8, 6, 33540
.long 0, 13, 0, 33792
.long 0, 13, 4, 34052
.long 0, 17, 2, 34304
.long 0, 17, 6, 34564
.long 0, 4, 1, 34816
.long 0, 4, 5, 35076
.long 0, 8, 3, 35328
.long 0, 8, 7, 35588
.long 0, 13, 1, 35840
.long 0, 13, 5, 36100
.long 0, 17, 3, 36352
.long 0, 17, 7, 36612
.long 3, 0, 0, 36864
.long 3, 0, 4, 37120
.long 3, 0, 1, 37376
.long 3, 0, 5, 37632
.long 3, 0, 2, 37888
.long 3, 0, 6, 38144
.long 3, 0, 3, 38400
.long 3, 0, 7, 38656
.long 4, 0, 0, 38912
.long 4, 1, 0, 39168
.long 4, 2, 0, 39424
.long 4, 3, 0, 39680
.long 4, 4, 0, 39936
.long 4, 5, 0, 40192
.long 4, 6, 0, 40448
.long 4, 7, 0, 40704
.section .rodata,"a"
.p2align 6
.amdhsa_kernel gated_mix__softmax_full_mha__glu_gated_glu__prompt_kernel
  .amdhsa_next_free_vgpr 256
  .amdhsa_next_free_sgpr 102
  .amdhsa_accum_offset 256
  .amdhsa_group_segment_fixed_size 0
  .amdhsa_kernarg_size 88
  .amdhsa_user_sgpr_count 2
  .amdhsa_user_sgpr_kernarg_segment_ptr 1
  .amdhsa_system_sgpr_workgroup_id_x 1
.end_amdhsa_kernel
```
